```python
import torch

def _softmax(x, axis=-1):
    return torch.softmax(x, dim=axis)

def _gelu(x):
    return torch.nn.functional.gelu(x, approximate='tanh')

def _silu(x):
    return torch.nn.functional.silu(x)

def _sigmoid(x):
    return torch.sigmoid(x)

def _layernorm(x, axis=-1, eps=1e-05):
    m = x.mean(dim=axis, keepdim=True)
    v = x.var(dim=axis, keepdim=True, unbiased=False)
    return (x - m) / torch.sqrt(v + eps)

def _scatter_add(tgt, idx, src, axis=0):
    return tgt.clone().index_add_(axis, idx, src)

def _segment_sum(src, seg, n):
    out = torch.zeros((n,) + src.shape[1:], dtype=src.dtype)
    return out.index_add_(0, seg, src)

def _pad(x, pw):
    flat = tuple((v for pair in reversed(pw) for v in pair))
    return torch.nn.functional.pad(x, flat)
kernel_name = 'parallel_sum__sliding_local_dilated__mixer_gmlp__prompt'

def setup_inputs():

    _w = lambda a: (lambda t: t.to(torch.bfloat16) if t.is_floating_point() else t)(torch.as_tensor(a))

    def _A_setup():
        B, S, D = (1, 2048, 512)
        return {'x': _w((lambda *s: torch.randn(*s, dtype=torch.bfloat16) * 0.05)(B, S, D)), 'wqkv': _w((lambda *s: torch.randn(*s, dtype=torch.bfloat16) * 0.1)(D, 3 * D)), 'wo': _w((lambda *s: torch.randn(*s, dtype=torch.bfloat16) * 0.05)(D, D))}
    _A_in = _A_setup()

    def _B_setup():
        B, S, D, F = (1, 2048, 512, 1792)
        Fh = F // 2
        return {'x': _w((lambda *s: torch.randn(*s, dtype=torch.bfloat16) * 0.05)(B, S, D)), 'w_in': _w((lambda *s: torch.randn(*s, dtype=torch.bfloat16) * 0.4)(D, 2 * Fh)), 'w_sp': _w(0.01 * (lambda *s: torch.randn(*s, dtype=torch.bfloat16) * 0.4)(S, S)), 'b_sp': _w(1.0 + 0.01 * (lambda *s: torch.randn(*s, dtype=torch.bfloat16) * 0.05)(S)), 'w_out': _w((lambda *s: torch.randn(*s, dtype=torch.bfloat16) * 0.05)(Fh, D))}
    _B_in = _B_setup()
    return {'A_x': _A_in['x'], 'A_wqkv': _A_in['wqkv'], 'A_wo': _A_in['wo'], 'B_x': _B_in['x'], 'B_w_in': _B_in['w_in'], 'B_w_sp': _B_in['w_sp'], 'B_b_sp': _B_in['b_sp'], 'B_w_out': _B_in['w_out']}

def reference(A_x, A_wqkv, A_wo, B_x, B_w_in, B_w_sp, B_b_sp, B_w_out):

    def _A_ref(x, wqkv, wo):
        B, S, D = x.shape
        H = 32
        Dh = D // H
        W, dil = (8, 2)
        qkv = (lambda x, *d: x.permute(*d))((x @ wqkv).reshape(B, S, 3, H, Dh), 2, 0, 3, 1, 4)
        q, k, v = (qkv[0], qkv[1], qkv[2])
        scale = Dh ** (-0.5)
        pos = torch.arange(S)
        off = torch.arange(W) * dil
        idx = pos[:, None] - off[None, :]
        mask = idx >= 0
        idx_c = torch.where(mask, idx, 0).reshape(-1)
        kg = k[:, :, idx_c, :].reshape(B, H, S, W, Dh)
        vg = v[:, :, idx_c, :].reshape(B, H, S, W, Dh)
        logits = torch.einsum('bhsd,bhswd->bhsw', q, kg) * scale
        logits = torch.where(mask[None, None, :, :], logits, -1000000000.0)
        attn = _softmax(logits, axis=-1)
        o = torch.einsum('bhsw,bhswd->bhsd', attn, vg)
        return (lambda x, *d: x.permute(*d))(o, 0, 2, 1, 3).reshape(B, S, D) @ wo

    def _B_ref(x, w_in, w_sp, b_sp, w_out):
        B, S, D = x.shape
        F = w_in.shape[-1]
        Fh = F // 2
        z = _gelu(torch.einsum('bsd,df->bsf', x, w_in))
        z1 = z[..., :Fh].clone()
        z2 = _layernorm(z[..., Fh:], axis=-1)
        g = torch.einsum('ts,bsf->btf', w_sp, z2) + b_sp[None, :, None]
        return torch.einsum('bsf,fd->bsd', z1 * g, w_out)
    x = A_x
    xn = _layernorm(x, axis=-1)
    return x + _A_ref(xn, A_wqkv, A_wo) + _B_ref(xn, B_w_in, B_w_sp, B_b_sp, B_w_out)
```

```asm
; @launch grid=(256,1,1) block=(256,1,1) lds=163840
.amdgcn_target "amdgcn-amd-amdhsa--gfx950"
.text
.globl parallel_sum__sliding_local_dilated__mixer_gmlp__prompt_kernel
.p2align 8
.type parallel_sum__sliding_local_dilated__mixer_gmlp__prompt_kernel,@function
parallel_sum__sliding_local_dilated__mixer_gmlp__prompt_kernel:
L_F_code:
    s_cmp_ge_u32 s2, 256
    s_cbranch_scc1 L_F_end
    s_load_dwordx16 s[4:19], s[0:1], 0
    s_load_dwordx4 s[20:23], s[0:1], 64
    s_load_dwordx2 s[24:25], s[0:1], 80
    s_getpc_b64 s[40:41]
L_F_pc:
    s_mov_b32 s42, L_F_end - L_F_pc
    s_mov_b32 s43, 0x20000
    s_lshr_b32 s60, s2, 3
    s_mul_i32 s60, s60, 2560
    v_lshlrev_b32 v3, 7, v0
    v_cmp_gt_u32 vcc, 20, v0
    s_nop 0
    s_and_saveexec_b64 s[50:51], vcc
    s_cbranch_execz L_F_nocpf
    buffer_load_dword v28, v3, s[40:43], s60 offen
L_F_nocpf:
    s_mov_b64 exec, -1
    v_lshrrev_b32 v1, 6, v0
    v_and_b32 v0, 63, v0
    v_readfirstlane_b32 s48, v1
    v_lshrrev_b32 v1, 4, v0
    v_and_b32 v2, 15, v0
    v_lshlrev_b32 v20, 4, v0
    s_and_b32 s60, s2, 7
    s_lshr_b32 s61, s2, 3
    s_lshr_b32 s76, s60, 2
    s_lshl_b32 s76, s76, 3
    s_lshr_b32 s62, s61, 2
    s_add_u32 s76, s76, s62
    s_and_b32 s77, s60, 3
    s_and_b32 s78, s61, 3
    v_and_b32 v3, 7, v0
    v_xor_b32 v144, v3, v1
    v_lshlrev_b32 v144, 4, v144
    v_lshrrev_b32 v145, 3, v0
    v_lshl_add_u32 v4, v145, 10, v144
    v_xor_b32 v5, 64, v4
    v_add_u32 v5, 8192, v5
    v_lshrrev_b32 v144, 5, v0
    v_lshlrev_b32 v144, 1, v144
    v_and_b32 v146, 3, v0
    v_xor_b32 v144, v144, v146
    v_lshlrev_b32 v144, 4, v144
    v_lshrrev_b32 v146, 2, v0
    s_lshl_b32 s81, s76, 2
    s_add_u32 s81, s81, s48
    s_lshl_b32 s81, s81, 15
    s_add_u32 s82, s81, 16384
    s_lshl_b32 s3, s48, 12
    s_mov_b32 s100, 0
    s_cmp_lt_u32 s78, 2
    s_cbranch_scc1 L_F_A
    v_mul_u32_u24 v146, 3584, v146
    v_add_u32 v6, v146, v144
    s_mul_i32 s65, s48, 57344
    s_mul_i32 s66, s77, 448
    s_add_u32 s65, s65, s66
    s_and_b32 s79, s48, 1
    s_lshr_b32 s80, s48, 1
    s_mov_b32 s73, 32768
    s_cmp_eq_u32 s78, 2
    s_cselect_b32 s67, 0, 256
    s_add_u32 s83, s65, s67
    s_add_u32 s83, s83, 1792
    s_cmp_eq_u32 s78, 2
    s_cselect_b32 s68, 1, 0
    s_mul_i32 s67, s68, -64
    s_add_u32 s67, s67, 320
    s_add_u32 s26, s65, s67
    s_waitcnt lgkmcnt(0)
    s_mov_b32 s28, s4
    s_mov_b32 s29, s5
    s_mov_b32 s30, 2097152
    s_mov_b32 s31, 0x20000
    s_mov_b32 s32, s12
    s_mov_b32 s33, s13
    s_mov_b32 s34, 1835008
    s_mov_b32 s35, 0x20000
    s_cmp_eq_u32 s78, 3
    s_cbranch_scc1 L_F_B34
    s_lshl_b32 s10, s48, 10
    s_mov_b32 s73, 47104
    s_add_u32 s74, s100, s3
    s_add_u32 s75, s100, s10
    s_add_u32 m0, s75, 18432
    s_nop 0
    buffer_load_dwordx4 v6, s[32:35], s83 offen offset:0 lds
    s_add_u32 m0, s75, 22464
    s_nop 0
    buffer_load_dwordx4 v6, s[32:35], s83 offen offset:64 lds
    s_add_u32 m0, s75, 26496
    s_nop 0
    buffer_load_dwordx4 v6, s[32:35], s83 offen offset:128 lds
    s_add_u32 m0, s75, 30528
    s_nop 0
    buffer_load_dwordx4 v6, s[32:35], s83 offen offset:192 lds
    s_add_u32 s83, s83, 229376
    s_add_u32 m0, s75, 34816
    s_nop 0
    buffer_load_dwordx4 v6, s[32:35], s26 offen offset:0 lds
    s_add_u32 s26, s26, 229376
    s_add_u32 m0, s74, 2048
    s_nop 0
    buffer_load_dwordx4 v4, s[28:31], s81 offen lds
    s_add_u32 m0, s74, 3072
    s_nop 0
    buffer_load_dwordx4 v5, s[28:31], s81 offen lds
    s_add_u32 s81, s81, 128
    s_add_u32 m0, s74, 4096
    s_nop 0
    buffer_load_dwordx4 v4, s[28:31], s82 offen lds
    s_add_u32 m0, s74, 5120
    s_nop 0
    buffer_load_dwordx4 v5, s[28:31], s82 offen lds
    s_add_u32 s82, s82, 128
    s_add_u32 s100, s100, 47104
    v_lshrrev_b32 v144, 1, v2
    v_xor_b32 v144, v144, v1
    v_lshlrev_b32 v144, 4, v144
    v_lshl_add_u32 v144, v2, 7, v144
    v_and_b32 v146, 1, v1
    v_lshlrev_b32 v146, 1, v146
    v_bfe_u32 v145, v0, 1, 1
    v_xor_b32 v146, v146, v145
    v_lshlrev_b32 v146, 4, v146
    v_bfe_u32 v145, v0, 2, 2
    v_lshl_add_u32 v145, v1, 3, v145
    v_lshl_add_u32 v146, v145, 6, v146
    v_and_b32 v145, 1, v0
    v_lshl_add_u32 v146, v145, 3, v146
    v_mov_b32 v22, 0
    v_and_b32 v148, 7, v0
    v_xor_b32 v148, v148, v1
    v_lshlrev_b32 v148, 4, v148
    v_lshrrev_b32 v149, 3, v0
    v_lshl_add_u32 v23, v149, 12, v148
    v_xor_b32 v31, 64, v23
    v_add_u32 v31, 0x8000, v31
    s_lshl_b32 s60, s79, 6
    v_xor_b32 v144, s60, v144
    s_lshl_b32 s60, s79, 12
    s_add_u32 s60, s60, 2048
    v_add_u32 v8, s60, v144
    s_lshl_b32 s62, s80, 13
    v_add_u32 v9, s62, v8
    v_xor_b32 v14, 64, v8
    v_xor_b32 v15, 64, v9
    s_lshl_b32 s61, s80, 12
    s_lshl_b32 s60, s79, 11
    s_add_u32 s60, s60, 18432
    s_add_u32 s63, s60, s62
    s_add_u32 s65, s60, s61
    s_lshl_b32 s64, s80, 5
    v_xor_b32 v145, s64, v146
    v_add_u32 v10, s63, v146
    v_xor_b32 v11, 32, v10
    v_add_u32 v12, s60, v145
    s_lshl_b32 s60, s79, 12
    s_sub_u32 s60, 2048, s60
    v_add_u32 v16, s60, v10
    v_add_u32 v17, s60, v11
    v_add_u32 v29, s60, v12
    s_add_u32 s74, s100, s3
    s_add_u32 s75, s100, s10
    s_add_u32 m0, s75, 18432
    s_nop 0
    buffer_load_dwordx4 v6, s[32:35], s83 offen offset:0 lds
    s_add_u32 m0, s75, 22464
    s_nop 0
    buffer_load_dwordx4 v6, s[32:35], s83 offen offset:64 lds
    s_add_u32 m0, s75, 26496
    s_nop 0
    buffer_load_dwordx4 v6, s[32:35], s83 offen offset:128 lds
    s_add_u32 m0, s75, 30528
    s_nop 0
    buffer_load_dwordx4 v6, s[32:35], s83 offen offset:192 lds
    s_add_u32 s83, s83, 229376
    s_add_u32 m0, s75, 34816
    s_nop 0
    buffer_load_dwordx4 v6, s[32:35], s26 offen offset:0 lds
    s_add_u32 s26, s26, 229376
    s_add_u32 m0, s74, 2048
    s_nop 0
    buffer_load_dwordx4 v4, s[28:31], s81 offen lds
    s_add_u32 m0, s74, 3072
    s_nop 0
    buffer_load_dwordx4 v5, s[28:31], s81 offen lds
    s_add_u32 s81, s81, 128
    s_add_u32 m0, s74, 4096
    s_nop 0
    buffer_load_dwordx4 v4, s[28:31], s82 offen lds
    s_add_u32 m0, s74, 5120
    s_nop 0
    buffer_load_dwordx4 v5, s[28:31], s82 offen lds
    s_add_u32 s82, s82, 128
    s_add_u32 s100, s100, 47104
    v_mov_b32 v24, 0x3f803f80
    v_mov_b32 v25, 0x3f803f80
    v_mov_b32 v26, 0x3f803f80
    v_mov_b32 v27, 0x3f803f80
    v_mov_b32 v32, 0
    v_mov_b32 v33, 0
    v_mov_b32 v34, 0
    v_mov_b32 v35, 0
    v_mov_b32 v36, 0
    v_mov_b32 v37, 0
    v_mov_b32 v38, 0
    v_mov_b32 v39, 0
    v_mov_b32 v40, 0
    v_mov_b32 v41, 0
    v_mov_b32 v42, 0
    v_mov_b32 v43, 0
    v_mov_b32 v44, 0
    v_mov_b32 v45, 0
    v_mov_b32 v46, 0
    v_mov_b32 v47, 0
    v_mov_b32 v48, 0
    v_mov_b32 v49, 0
    v_mov_b32 v50, 0
    v_mov_b32 v51, 0
    v_mov_b32 v52, 0
    v_mov_b32 v53, 0
    v_mov_b32 v54, 0
    v_mov_b32 v55, 0
    v_mov_b32 v56, 0
    v_mov_b32 v57, 0
    v_mov_b32 v58, 0
    v_mov_b32 v59, 0
    v_mov_b32 v60, 0
    v_mov_b32 v61, 0
    v_mov_b32 v62, 0
    v_mov_b32 v63, 0
    v_mov_b32 v64, 0
    v_mov_b32 v65, 0
    v_mov_b32 v66, 0
    v_mov_b32 v67, 0
    v_mov_b32 v68, 0
    v_mov_b32 v69, 0
    v_mov_b32 v70, 0
    v_mov_b32 v71, 0
    v_mov_b32 v72, 0
    v_mov_b32 v73, 0
    v_mov_b32 v74, 0
    v_mov_b32 v75, 0
    v_mov_b32 v76, 0
    v_mov_b32 v77, 0
    v_mov_b32 v78, 0
    v_mov_b32 v79, 0
    v_mov_b32 v80, 0
    v_mov_b32 v81, 0
    v_mov_b32 v82, 0
    v_mov_b32 v83, 0
    v_mov_b32 v84, 0
    v_mov_b32 v85, 0
    v_mov_b32 v86, 0
    v_mov_b32 v87, 0
    v_mov_b32 v88, 0
    v_mov_b32 v89, 0
    v_mov_b32 v90, 0
    v_mov_b32 v91, 0
    v_mov_b32 v92, 0
    v_mov_b32 v93, 0
    v_mov_b32 v94, 0
    v_mov_b32 v95, 0
    v_mov_b32 v96, 0
    v_mov_b32 v97, 0
    v_mov_b32 v98, 0
    v_mov_b32 v99, 0
    v_mov_b32 v100, 0
    v_mov_b32 v101, 0
    v_mov_b32 v102, 0
    v_mov_b32 v103, 0
    v_mov_b32 v104, 0
    v_mov_b32 v105, 0
    v_mov_b32 v106, 0
    v_mov_b32 v107, 0
    v_mov_b32 v108, 0
    v_mov_b32 v109, 0
    v_mov_b32 v110, 0
    v_mov_b32 v111, 0
    v_accvgpr_write_b32 a112, 0
    v_accvgpr_write_b32 a113, 0
    v_accvgpr_write_b32 a114, 0
    v_accvgpr_write_b32 a115, 0
    v_accvgpr_write_b32 a116, 0
    v_accvgpr_write_b32 a117, 0
    v_accvgpr_write_b32 a118, 0
    v_accvgpr_write_b32 a119, 0
    v_accvgpr_write_b32 a120, 0
    v_accvgpr_write_b32 a121, 0
    v_accvgpr_write_b32 a122, 0
    v_accvgpr_write_b32 a123, 0
    v_accvgpr_write_b32 a124, 0
    v_accvgpr_write_b32 a125, 0
    v_accvgpr_write_b32 a126, 0
    v_accvgpr_write_b32 a127, 0
    v_accvgpr_write_b32 a128, 0
    v_accvgpr_write_b32 a129, 0
    v_accvgpr_write_b32 a130, 0
    v_accvgpr_write_b32 a131, 0
    v_accvgpr_write_b32 a132, 0
    v_accvgpr_write_b32 a133, 0
    v_accvgpr_write_b32 a134, 0
    v_accvgpr_write_b32 a135, 0
    v_accvgpr_write_b32 a136, 0
    v_accvgpr_write_b32 a137, 0
    v_accvgpr_write_b32 a138, 0
    v_accvgpr_write_b32 a139, 0
    v_accvgpr_write_b32 a140, 0
    v_accvgpr_write_b32 a141, 0
    v_accvgpr_write_b32 a142, 0
    v_accvgpr_write_b32 a143, 0
    v_accvgpr_write_b32 a144, 0
    v_accvgpr_write_b32 a145, 0
    v_accvgpr_write_b32 a146, 0
    v_accvgpr_write_b32 a147, 0
    s_add_u32 s74, s100, s3
    s_add_u32 s75, s100, s10
    s_add_u32 m0, s75, 18432
    s_nop 0
    buffer_load_dwordx4 v6, s[32:35], s83 offen offset:0 lds
    s_add_u32 m0, s75, 22464
    s_nop 0
    buffer_load_dwordx4 v6, s[32:35], s83 offen offset:64 lds
    s_add_u32 m0, s75, 26496
    s_nop 0
    buffer_load_dwordx4 v6, s[32:35], s83 offen offset:128 lds
    s_add_u32 m0, s75, 30528
    s_nop 0
    buffer_load_dwordx4 v6, s[32:35], s83 offen offset:192 lds
    s_add_u32 s83, s83, 229376
    s_add_u32 m0, s75, 34816
    s_nop 0
    buffer_load_dwordx4 v6, s[32:35], s26 offen offset:0 lds
    s_add_u32 s26, s26, 229376
    s_mov_b32 s100, 0
    s_lshr_b32 s60, s2, 3
    s_lshl_b32 s61, s60, 2
    s_add_u32 s66, s61, s48
    v_lshlrev_b32 v18, 10, v0
    s_and_b32 s61, s66, 15
    s_lshl_b32 s61, s61, 13
    s_lshl_b32 s58, s76, 17
    s_add_u32 s58, s58, s61
    s_add_u32 s58, s58, 384
    v_mul_u32_u24 v145, 86, v0
    v_lshrrev_b32 v145, 8, v145
    v_mul_u32_u24 v146, 3, v145
    v_sub_u32 v146, v0, v146
    v_and_b32 v147, 1, v145
    v_mul_u32_u24 v147, 3584, v147
    s_and_b32 s61, s76, 7
    s_lshl_b32 s61, s61, 3
    s_mul_i32 s62, s48, -14
    s_add_u32 s61, s61, s62
    s_mul_i32 s61, s61, 3584
    v_lshlrev_b32 v146, 7, v146
    v_min_u32 v146, 192, v146
    v_add_u32 v147, v147, v146
    s_add_u32 s62, s61, s83
    s_add_u32 s63, s61, s26
    s_sub_u32 s63, s63, 0
    v_mov_b32 v146, s63
    v_mov_b32 v148, s62
    v_cmp_gt_u32 vcc, 6, v0
    s_nop 1
    v_cndmask_b32 v146, v146, v148, vcc
    v_add_u32 v19, v147, v146
    s_mov_b32 s72, 0
    s_mov_b64 exec, 0xff
    buffer_load_dword v28, v18, s[28:31], s58 offen
    s_mov_b64 exec, -1
    s_add_u32 s58, s58, 128
    s_mov_b64 exec, 4095
    buffer_load_dword v28, v19, s[32:35], s72 offen
    s_mov_b64 exec, -1
    s_add_u32 s72, s72, 229376
    s_mov_b64 exec, 0xff
    buffer_load_dword v28, v18, s[28:31], s58 offen
    s_mov_b64 exec, -1
    s_add_u32 s58, s58, 128
    s_mov_b64 exec, 4095
    buffer_load_dword v28, v19, s[32:35], s72 offen
    s_mov_b64 exec, -1
    s_add_u32 s72, s72, 229376
    s_mov_b32 s40, s14
    s_mov_b32 s41, s15
    s_mov_b32 s42, 8388608
    s_mov_b32 s43, 0x20000
    v_lshrrev_b32 v3, 2, v0
    v_and_b32 v145, 3, v0
    v_lshlrev_b32 v145, 10, v145
    v_lshl_add_u32 v3, v3, 12, v145
    s_bfe_u32 s59, s2, 0x20001
    s_lshl_b32 s59, s59, 21
    s_lshr_b32 s60, s2, 5
    s_lshl_b32 s60, s60, 1
    s_bfe_u32 s61, s2, 0x10003
    s_add_u32 s60, s60, s61
    s_lshl_b32 s60, s60, 2
    s_add_u32 s66, s60, s48
    s_lshl_b32 s66, s66, 15
    s_add_u32 s59, s59, s66
    s_mul_i32 s71, s48, 33792
    v_lshlrev_b32 v147, 2, v2
    v_add_u32 v147, 135168, v147
    v_lshlrev_b32 v151, 4, v1
    v_add_u32 v151, 135168, v151
    s_lshl_b32 s60, s80, 8
    s_lshl_b32 s63, s79, 7
    s_add_u32 s60, s60, s63
    s_add_u32 s60, s60, 64
    s_mul_i32 s61, s80, 256
    s_mul_i32 s64, s80, 64
    s_lshl_b32 s65, s79, 10
    s_add_u32 s62, s61, s65
    s_add_u32 s65, s64, s65
    v_add_u32 v148, s60, v147
    v_add_u32 v149, s62, v147
    v_add_u32 v150, s65, v147
    s_sub_u32 s59, s60, 64
    s_add_u32 s60, s63, 64
    v_add_u32 v240, s60, v151
    v_add_u32 v242, s60, v147
    v_add_u32 v244, s61, v147
    v_add_u32 v245, s64, v151
    v_xor_b32 v3, v2, v1
    v_lshrrev_b32 v3, 1, v3
    v_lshlrev_b32 v3, 4, v3
    v_lshl_add_u32 v3, v2, 7, v3
    v_and_b32 v7, 1, v1
    v_lshl_add_u32 v3, v7, 3, v3
    v_add_u32 v252, s71, v3
    v_xor_b32 v253, 32, v252
    v_xor_b32 v254, 64, v252
    v_xor_b32 v255, 96, v252
    s_lshl_b32 s56, s76, 2
    s_add_u32 s56, s56, s77
    s_lshl_b32 s56, s56, 3
    s_add_u32 s56, s56, s48
    s_lshl_b32 s56, s56, 6
    s_add_u32 s56, s56, 0
    s_lshl_b32 s57, s76, 2
    s_add_u32 s57, s57, s77
    s_lshl_b32 s57, s57, 3
    s_add_u32 s57, s57, s48
    s_lshl_b32 s57, s57, 2
    s_add_u32 s57, s57, 32768
    v_mov_b32 v250, 0xc0135761
    v_mov_b32 v251, 0xbdd2d3e8
    v_bfe_u32 v224, v2, 2, 1
    v_lshlrev_b32 v224, 8, v224
    v_lshrrev_b32 v225, 3, v2
    v_lshl_add_u32 v224, v225, 6, v224
    v_add_u32 v224, v224, v151
    s_lshl_b32 s66, s80, 9
    s_add_u32 s66, s66, s63
    v_add_u32 v241, s66, v224
    s_lshl_b32 s66, s48, 6
    v_add_u32 v243, s66, v147
    s_lshl_b32 s66, s48, 9
    v_add_u32 v133, s66, v151
    s_add_u32 s66, s66, 135168
    v_and_b32 v224, 31, v0
    v_lshl_add_u32 v132, v224, 2, s66
    v_lshrrev_b32 v134, 5, v0
    v_lshlrev_b32 v134, 11, v134
    v_lshl_add_u32 v134, v224, 4, v134
    s_mov_b32 s40, s24
    s_mov_b32 s41, s25
    s_mov_b32 s42, 3670016
    s_mov_b32 s43, 0x20000
    s_add_u32 s36, s24, 10485760
    s_addc_u32 s37, s25, 0
    s_mov_b32 s38, 3670016
    s_mov_b32 s39, 0x20000
    s_lshl_b32 s68, s76, 14
    s_lshl_b32 s66, s79, 9
    s_add_u32 s66, s66, s68
    s_lshl_b32 s63, s77, 12
    s_add_u32 s63, s63, 0
    s_add_u32 s63, s63, s68
    s_lshl_b32 s67, s48, 8
    s_add_u32 s63, s63, s67
    s_add_u32 s67, s66, 4096
    s_add_u32 s68, s66, 8192
    s_add_u32 s69, s66, 12288
    s_lshl_b32 s60, s76, 2
    s_add_u32 s60, s60, s79
    s_mul_i32 s60, s60, 56
    s_mul_i32 s62, s77, 14
    s_add_u32 s60, s60, s62
    s_lshl_b32 s60, s60, 10
    s_lshl_b32 s61, s61, 4
    s_lshl_b32 s64, s64, 4
    s_add_u32 s65, s60, s64
    s_add_u32 s65, s65, 8192
    s_add_u32 s70, s65, 114688
    s_add_u32 s64, s60, s61
    s_add_u32 s64, s64, 0
    s_add_u32 s62, s64, 114688
    s_mov_b32 s11, 0
    s_waitcnt vmcnt(18)
    s_barrier
    ds_read_b128 a[0:3], v8 offset:0
    ds_read_b128 a[4:7], v8 offset:2048
    ds_read_b128 a[8:11], v8 offset:8192
    ds_read_b128 a[12:15], v8 offset:10240
    ds_read_b64_tr_b16 a[16:17], v10 offset:0
    ds_read_b64_tr_b16 a[18:19], v10 offset:256
    ds_read_b64_tr_b16 a[20:21], v11 offset:0
    ds_read_b64_tr_b16 a[22:23], v11 offset:256
    ds_read_b64_tr_b16 a[24:25], v10 offset:4096
    ds_read_b64_tr_b16 a[26:27], v10 offset:4352
    ds_read_b64_tr_b16 a[28:29], v11 offset:4096
    ds_read_b64_tr_b16 a[30:31], v11 offset:4352
    ds_read_b64_tr_b16 a[32:33], v12 offset:16384
    ds_read_b64_tr_b16 a[34:35], v12 offset:16640
    ds_read_b128 a[40:43], v9 offset:0
    ds_read_b128 a[44:47], v9 offset:2048
    s_waitcnt lgkmcnt(0)
    .p2align 6
L_F_B43_loop:
    s_add_u32 m0, s74, 2048
    v_mfma_f32_16x16x32_bf16 v[32:35], a[0:3], a[16:19], v[32:35]
    buffer_load_dwordx4 v4, s[28:31], s81 offen lds
    ds_read_b128 a[56:59], v14 offset:0
    v_mfma_f32_16x16x32_bf16 v[36:39], a[4:7], a[16:19], v[36:39]
    ds_read_b128 a[60:63], v14 offset:2048
    v_mfma_f32_16x16x32_bf16 v[40:43], a[8:11], a[16:19], v[40:43]
    ds_read_b128 a[64:67], v14 offset:8192
    v_mfma_f32_16x16x32_bf16 v[44:47], a[12:15], a[16:19], v[44:47]
    ds_read_b128 a[68:71], v14 offset:10240
    v_mfma_f32_16x16x32_bf16 v[48:51], a[0:3], a[20:23], v[48:51]
    ds_read_b64_tr_b16 a[72:73], v16 offset:0
    v_mfma_f32_16x16x32_bf16 v[52:55], a[4:7], a[20:23], v[52:55]
    ds_read_b64_tr_b16 a[74:75], v16 offset:256
    v_mfma_f32_16x16x32_bf16 v[56:59], a[8:11], a[20:23], v[56:59]
    ds_read_b64_tr_b16 a[76:77], v17 offset:0
    s_add_u32 m0, s74, 3072
    v_mfma_f32_16x16x32_bf16 v[60:63], a[12:15], a[20:23], v[60:63]
    buffer_load_dwordx4 v5, s[28:31], s81 offen lds
    s_add_u32 s81, s81, 128
    ds_read_b64_tr_b16 a[78:79], v17 offset:256
    v_mfma_f32_16x16x32_bf16 v[64:67], a[0:3], a[24:27], v[64:67]
    ds_read_b64_tr_b16 a[80:81], v16 offset:4096
    v_mfma_f32_16x16x32_bf16 v[68:71], a[4:7], a[24:27], v[68:71]
    ds_read_b64_tr_b16 a[82:83], v16 offset:4352
    v_mfma_f32_16x16x32_bf16 v[72:75], a[8:11], a[24:27], v[72:75]
    ds_read_b64_tr_b16 a[84:85], v17 offset:4096
    v_mfma_f32_16x16x32_bf16 v[76:79], a[12:15], a[24:27], v[76:79]
    ds_read_b64_tr_b16 a[86:87], v17 offset:4352
    v_mfma_f32_16x16x32_bf16 v[80:83], a[0:3], a[28:31], v[80:83]
    ds_read_b64_tr_b16 a[88:89], v29 offset:16384
    v_mfma_f32_16x16x32_bf16 v[84:87], a[4:7], a[28:31], v[84:87]
    ds_read_b64_tr_b16 a[90:91], v29 offset:16640
    s_add_u32 m0, s74, 4096
    v_mfma_f32_16x16x32_bf16 v[88:91], a[8:11], a[28:31], v[88:91]
    buffer_load_dwordx4 v4, s[28:31], s82 offen lds
    ds_read_b128 a[96:99], v15 offset:0
    v_mfma_f32_16x16x32_bf16 v[92:95], a[12:15], a[28:31], v[92:95]
    ds_read_b128 a[100:103], v15 offset:2048
    v_mfma_f32_16x16x32_bf16 v[96:99], a[32:35], a[0:3], v[96:99]
    s_cmp_eq_u32 s100, 94208
    s_cselect_b32 s101, -94208, s73
    v_mfma_f32_16x16x32_bf16 v[100:103], a[32:35], a[4:7], v[100:103]
    v_add_u32 v8, s101, v8
    v_mfma_f32_16x16x32_bf16 v[104:107], a[32:35], a[8:11], v[104:107]
    v_add_u32 v9, s101, v9
    v_mfma_f32_16x16x32_bf16 v[108:111], a[32:35], a[12:15], v[108:111]
    v_add_u32 v10, s101, v10
    v_mfma_f32_16x16x32_bf16 a[128:131], v[24:27], a[16:19], a[128:131]
    v_add_u32 v11, s101, v11
    s_add_u32 m0, s74, 5120
    v_mfma_f32_16x16x32_bf16 a[132:135], v[24:27], a[20:23], a[132:135]
    buffer_load_dwordx4 v5, s[28:31], s82 offen lds
    s_add_u32 s82, s82, 128
    v_add_u32 v12, s101, v12
    v_mfma_f32_16x16x32_bf16 a[136:139], v[24:27], a[24:27], a[136:139]
    v_mfma_f32_16x16x32_bf16 a[140:143], v[24:27], a[28:31], a[140:143]
    v_mfma_f32_16x16x32_bf16 a[144:147], v[24:27], a[32:35], a[144:147]
    v_mfma_f32_16x16x32_bf16 a[112:115], a[40:43], a[40:43], a[112:115]
    v_mfma_f32_16x16x32_bf16 a[116:119], v[24:27], a[40:43], a[116:119]
    v_mfma_f32_16x16x32_bf16 a[120:123], a[44:47], a[44:47], a[120:123]
    v_mfma_f32_16x16x32_bf16 a[124:127], v[24:27], a[44:47], a[124:127]
    s_cmp_eq_u32 s11, 5
    s_waitcnt lgkmcnt(0)
    s_waitcnt vmcnt(11)
    s_barrier
    s_cbranch_scc1 L_F_B43_five
    s_add_u32 s74, s100, s3
    s_add_u32 s75, s100, s10
    s_add_u32 m0, s75, 18432
    v_mfma_f32_16x16x32_bf16 v[32:35], a[56:59], a[72:75], v[32:35]
    buffer_load_dwordx4 v6, s[32:35], s83 offen offset:0 lds
    ds_read_b128 a[0:3], v8 offset:0
    v_mfma_f32_16x16x32_bf16 v[36:39], a[60:63], a[72:75], v[36:39]
    ds_read_b128 a[4:7], v8 offset:2048
    v_mfma_f32_16x16x32_bf16 v[40:43], a[64:67], a[72:75], v[40:43]
    ds_read_b128 a[8:11], v8 offset:8192
    s_add_u32 m0, s75, 22464
    v_mfma_f32_16x16x32_bf16 v[44:47], a[68:71], a[72:75], v[44:47]
    buffer_load_dwordx4 v6, s[32:35], s83 offen offset:64 lds
    ds_read_b128 a[12:15], v8 offset:10240
    v_mfma_f32_16x16x32_bf16 v[48:51], a[56:59], a[76:79], v[48:51]
    ds_read_b64_tr_b16 a[16:17], v10 offset:0
    v_mfma_f32_16x16x32_bf16 v[52:55], a[60:63], a[76:79], v[52:55]
    ds_read_b64_tr_b16 a[18:19], v10 offset:256
    s_add_u32 m0, s75, 26496
    v_mfma_f32_16x16x32_bf16 v[56:59], a[64:67], a[76:79], v[56:59]
    buffer_load_dwordx4 v6, s[32:35], s83 offen offset:128 lds
    ds_read_b64_tr_b16 a[20:21], v11 offset:0
    v_mfma_f32_16x16x32_bf16 v[60:63], a[68:71], a[76:79], v[60:63]
    ds_read_b64_tr_b16 a[22:23], v11 offset:256
    v_mfma_f32_16x16x32_bf16 v[64:67], a[56:59], a[80:83], v[64:67]
    ds_read_b64_tr_b16 a[24:25], v10 offset:4096
    s_add_u32 m0, s75, 30528
    v_mfma_f32_16x16x32_bf16 v[68:71], a[60:63], a[80:83], v[68:71]
    buffer_load_dwordx4 v6, s[32:35], s83 offen offset:192 lds
    s_add_u32 s83, s83, 229376
    ds_read_b64_tr_b16 a[26:27], v10 offset:4352
    v_mfma_f32_16x16x32_bf16 v[72:75], a[64:67], a[80:83], v[72:75]
    ds_read_b64_tr_b16 a[28:29], v11 offset:4096
    v_mfma_f32_16x16x32_bf16 v[76:79], a[68:71], a[80:83], v[76:79]
    ds_read_b64_tr_b16 a[30:31], v11 offset:4352
    v_mfma_f32_16x16x32_bf16 v[80:83], a[56:59], a[84:87], v[80:83]
    ds_read_b64_tr_b16 a[32:33], v12 offset:16384
    s_add_u32 m0, s75, 34816
    v_mfma_f32_16x16x32_bf16 v[84:87], a[60:63], a[84:87], v[84:87]
    buffer_load_dwordx4 v6, s[32:35], s26 offen offset:0 lds
    s_add_u32 s26, s26, 229376
    ds_read_b64_tr_b16 a[34:35], v12 offset:16640
    v_mfma_f32_16x16x32_bf16 v[88:91], a[64:67], a[84:87], v[88:91]
    ds_read_b128 a[40:43], v9 offset:0
    v_mfma_f32_16x16x32_bf16 v[92:95], a[68:71], a[84:87], v[92:95]
    ds_read_b128 a[44:47], v9 offset:2048
    v_mfma_f32_16x16x32_bf16 v[96:99], a[88:91], a[56:59], v[96:99]
    s_mov_b64 exec, 0xff
    buffer_load_dword v28, v18, s[28:31], s58 offen
    s_mov_b64 exec, -1
    s_add_u32 s58, s58, 128
    v_add_u32 v14, s101, v14
    v_mfma_f32_16x16x32_bf16 v[100:103], a[88:91], a[60:63], v[100:103]
    v_add_u32 v15, s101, v15
    v_mfma_f32_16x16x32_bf16 v[104:107], a[88:91], a[64:67], v[104:107]
    v_add_u32 v16, s101, v16
    v_mfma_f32_16x16x32_bf16 v[108:111], a[88:91], a[68:71], v[108:111]
    s_mov_b64 exec, 4095
    buffer_load_dword v28, v19, s[32:35], s72 offen
    s_mov_b64 exec, -1
    s_add_u32 s72, s72, 229376
    v_add_u32 v17, s101, v17
    v_mfma_f32_16x16x32_bf16 a[112:115], a[96:99], a[96:99], a[112:115]
    v_add_u32 v29, s101, v29
    v_mfma_f32_16x16x32_bf16 a[116:119], v[24:27], a[96:99], a[116:119]
    v_mfma_f32_16x16x32_bf16 a[120:123], a[100:103], a[100:103], a[120:123]
    v_mfma_f32_16x16x32_bf16 a[124:127], v[24:27], a[100:103], a[124:127]
    s_add_u32 s100, s100, s101
    s_add_u32 s11, s11, 1
    s_cmp_lt_u32 s11, 8
    s_waitcnt lgkmcnt(0)
    s_branch L_F_B43_loop
L_F_B43_five:
    global_load_dword v21, v22, s[22:23] sc1
    s_and_b32 s71, s76, 3
    s_lshl_b32 s71, s71, 2
    s_and_b32 s81, s77, 1
    s_lshl_b32 s81, s81, 1
    v_mfma_f32_16x16x32_bf16 v[32:35], a[56:59], a[72:75], v[32:35]
    ds_read_b128 a[0:3], v8 offset:0
    s_add_u32 s71, s71, s81
    s_add_u32 s71, s71, 0
    s_lshr_b32 s81, s76, 2
    s_mul_i32 s82, s81, 7
    s_add_u32 s82, s82, 12
    v_mfma_f32_16x16x32_bf16 v[36:39], a[60:63], a[72:75], v[36:39]
    ds_read_b128 a[4:7], v8 offset:2048
    s_lshl_b32 s81, s81, 2
    s_cmp_lt_u32 s71, 4
    s_cselect_b32 s81, s81, s82
    s_add_u32 s81, s81, s71
    s_cmp_gt_u32 s71, 10
    v_mfma_f32_16x16x32_bf16 v[40:43], a[64:67], a[72:75], v[40:43]
    ds_read_b128 a[8:11], v8 offset:8192
    s_cselect_b32 s81, 64, s81
    s_lshr_b32 s71, s77, 1
    s_lshl_b32 s71, s71, 2
    s_add_u32 s71, s71, s48
    v_mfma_f32_16x16x32_bf16 v[44:47], a[68:71], a[72:75], v[44:47]
    ds_read_b128 a[12:15], v8 offset:10240
    s_lshl_b32 s26, s81, 3
    s_add_u32 s26, s26, s71
    s_lshl_b32 s26, s26, 12
    s_lshl_b32 s71, s71, 7
    s_sub_u32 s82, s81, 16
    v_mfma_f32_16x16x32_bf16 v[48:51], a[56:59], a[76:79], v[48:51]
    ds_read_b64_tr_b16 a[16:17], v10 offset:0
    s_cmp_lt_u32 s81, 16
    s_cselect_b32 s32, s8, s18
    s_cselect_b32 s33, s9, s19
    s_cselect_b32 s81, s81, s82
    s_mov_b32 s34, 917504
    v_mfma_f32_16x16x32_bf16 v[52:55], a[60:63], a[76:79], v[52:55]
    ds_read_b64_tr_b16 a[18:19], v10 offset:256
    s_cselect_b32 s34, 524288, s34
    s_mov_b32 s35, 0x20000
    s_lshl_b32 s81, s81, 15
    s_add_u32 s81, s81, s71
    s_add_u32 s82, s81, 16384
    v_mfma_f32_16x16x32_bf16 v[56:59], a[64:67], a[76:79], v[56:59]
    ds_read_b64_tr_b16 a[20:21], v11 offset:0
    s_lshl_b32 s71, s48, 12
    s_add_u32 s10, s71, 143360
    v_and_b32 v141, 1, v1
    v_lshlrev_b32 v141, 1, v141
    v_mfma_f32_16x16x32_bf16 v[60:63], a[68:71], a[76:79], v[60:63]
    ds_read_b64_tr_b16 a[22:23], v11 offset:256
    v_and_b32 v140, 3, v0
    v_xor_b32 v140, v140, v141
    v_lshlrev_b32 v140, 4, v140
    v_lshrrev_b32 v142, 2, v0
    v_lshl_add_u32 v140, v142, 10, v140
    v_mfma_f32_16x16x32_bf16 v[64:67], a[56:59], a[80:83], v[64:67]
    ds_read_b64_tr_b16 a[24:25], v10 offset:4096
    v_bfe_u32 v143, v0, 1, 1
    v_xor_b32 v141, v141, v143
    v_lshlrev_b32 v141, 4, v141
    v_lshl_add_u32 v141, v142, 6, v141
    v_and_b32 v143, 1, v0
    v_mfma_f32_16x16x32_bf16 v[68:71], a[60:63], a[80:83], v[68:71]
    ds_read_b64_tr_b16 a[26:27], v10 offset:4352
    v_lshl_add_u32 v141, v143, 3, v141
    v_add_u32 v141, s10, v141
    v_xor_b32 v142, 32, v141
    s_and_b32 s52, s2, 7
    v_mfma_f32_16x16x32_bf16 v[72:75], a[64:67], a[80:83], v[72:75]
    ds_read_b64_tr_b16 a[28:29], v11 offset:4096
    s_lshr_b32 s53, s2, 3
    s_lshr_b32 s50, s52, 1
    s_lshl_b32 s50, s50, 3
    s_lshr_b32 s54, s53, 2
    s_add_u32 s50, s50, s54
    v_mfma_f32_16x16x32_bf16 v[76:79], a[68:71], a[80:83], v[76:79]
    ds_read_b64_tr_b16 a[30:31], v11 offset:4352
    s_and_b32 s51, s52, 1
    s_lshl_b32 s51, s51, 2
    s_and_b32 s54, s53, 3
    s_add_u32 s51, s51, s54
    s_xor_b32 s52, s48, 0
    v_mfma_f32_16x16x32_bf16 v[80:83], a[56:59], a[84:87], v[80:83]
    ds_read_b64_tr_b16 a[32:33], v12 offset:16384
    s_lshl_b32 s53, s50, 2
    s_add_u32 s52, s52, s53
    s_lshl_b32 s52, s52, 16
    s_lshl_b32 s53, s48, 10
    s_add_u32 s83, s52, s53
    v_mfma_f32_16x16x32_bf16 v[84:87], a[60:63], a[84:87], v[84:87]
    ds_read_b64_tr_b16 a[34:35], v12 offset:16640
    s_xor_b32 s52, s48, 1
    s_lshl_b32 s53, s50, 2
    s_add_u32 s52, s52, s53
    s_lshl_b32 s52, s52, 16
    v_mfma_f32_16x16x32_bf16 v[88:91], a[64:67], a[84:87], v[88:91]
    ds_read_b128 a[40:43], v9 offset:0
    s_lshl_b32 s53, s48, 10
    s_add_u32 s27, s52, s53
    s_xor_b32 s52, s48, 2
    s_lshl_b32 s53, s50, 2
    s_add_u32 s52, s52, s53
    v_mfma_f32_16x16x32_bf16 v[92:95], a[68:71], a[84:87], v[92:95]
    ds_read_b128 a[44:47], v9 offset:2048
    s_lshl_b32 s52, s52, 16
    s_lshl_b32 s53, s48, 10
    s_add_u32 s58, s52, s53
    s_xor_b32 s52, s48, 3
    s_lshl_b32 s53, s50, 2
    v_mfma_f32_16x16x32_bf16 v[96:99], a[88:91], a[56:59], v[96:99]
    v_add_u32 v14, s101, v14
    s_add_u32 s52, s52, s53
    s_lshl_b32 s52, s52, 16
    s_lshl_b32 s53, s48, 10
    s_add_u32 s72, s52, s53
    v_mfma_f32_16x16x32_bf16 v[100:103], a[88:91], a[60:63], v[100:103]
    v_add_u32 v15, s101, v15
    s_add_u32 m0, s10, 0
    v_mfma_f32_16x16x32_bf16 v[104:107], a[88:91], a[64:67], v[104:107]
    buffer_load_dwordx4 v140, s[32:35], s81 offen offset:0 lds
    v_add_u32 v16, s101, v16
    s_add_u32 m0, s10, 1024
    v_mfma_f32_16x16x32_bf16 v[108:111], a[88:91], a[68:71], v[108:111]
    buffer_load_dwordx4 v140, s[32:35], s82 offen offset:0 lds
    v_add_u32 v17, s101, v17
    s_add_u32 m0, s10, 1984
    v_mfma_f32_16x16x32_bf16 a[112:115], a[96:99], a[96:99], a[112:115]
    buffer_load_dwordx4 v140, s[32:35], s81 offen offset:64 lds
    v_add_u32 v29, s101, v29
    s_add_u32 m0, s10, 3008
    v_mfma_f32_16x16x32_bf16 a[116:119], v[24:27], a[96:99], a[116:119]
    buffer_load_dwordx4 v140, s[32:35], s82 offen offset:64 lds
    v_mfma_f32_16x16x32_bf16 a[120:123], a[100:103], a[100:103], a[120:123]
    v_mfma_f32_16x16x32_bf16 a[124:127], v[24:27], a[100:103], a[124:127]
    s_add_u32 s100, s100, s101
    s_add_u32 s11, s11, 1
    s_cmp_lt_u32 s11, 8
    s_waitcnt lgkmcnt(0)
L_F_B43_tail:
    v_mfma_f32_16x16x32_bf16 v[32:35], a[0:3], a[16:19], v[32:35]
    ds_read_b128 a[56:59], v14 offset:0
    v_mfma_f32_16x16x32_bf16 v[36:39], a[4:7], a[16:19], v[36:39]
    ds_read_b128 a[60:63], v14 offset:2048
    v_mfma_f32_16x16x32_bf16 v[40:43], a[8:11], a[16:19], v[40:43]
    ds_read_b128 a[64:67], v14 offset:8192
    v_mfma_f32_16x16x32_bf16 v[44:47], a[12:15], a[16:19], v[44:47]
    ds_read_b128 a[68:71], v14 offset:10240
    v_mfma_f32_16x16x32_bf16 v[48:51], a[0:3], a[20:23], v[48:51]
    ds_read_b64_tr_b16 a[72:73], v16 offset:0
    v_mfma_f32_16x16x32_bf16 v[52:55], a[4:7], a[20:23], v[52:55]
    ds_read_b64_tr_b16 a[74:75], v16 offset:256
    v_mfma_f32_16x16x32_bf16 v[56:59], a[8:11], a[20:23], v[56:59]
    ds_read_b64_tr_b16 a[76:77], v17 offset:0
    v_mfma_f32_16x16x32_bf16 v[60:63], a[12:15], a[20:23], v[60:63]
    ds_read_b64_tr_b16 a[78:79], v17 offset:256
    v_mfma_f32_16x16x32_bf16 v[64:67], a[0:3], a[24:27], v[64:67]
    ds_read_b64_tr_b16 a[80:81], v16 offset:4096
    v_mfma_f32_16x16x32_bf16 v[68:71], a[4:7], a[24:27], v[68:71]
    ds_read_b64_tr_b16 a[82:83], v16 offset:4352
    v_mfma_f32_16x16x32_bf16 v[72:75], a[8:11], a[24:27], v[72:75]
    ds_read_b64_tr_b16 a[84:85], v17 offset:4096
    v_mfma_f32_16x16x32_bf16 v[76:79], a[12:15], a[24:27], v[76:79]
    ds_read_b64_tr_b16 a[86:87], v17 offset:4352
    v_mfma_f32_16x16x32_bf16 v[80:83], a[0:3], a[28:31], v[80:83]
    ds_read_b64_tr_b16 a[88:89], v29 offset:16384
    v_mfma_f32_16x16x32_bf16 v[84:87], a[4:7], a[28:31], v[84:87]
    ds_read_b64_tr_b16 a[90:91], v29 offset:16640
    v_mfma_f32_16x16x32_bf16 v[88:91], a[8:11], a[28:31], v[88:91]
    ds_read_b128 a[96:99], v15 offset:0
    v_mfma_f32_16x16x32_bf16 v[92:95], a[12:15], a[28:31], v[92:95]
    ds_read_b128 a[100:103], v15 offset:2048
    v_mfma_f32_16x16x32_bf16 v[96:99], a[32:35], a[0:3], v[96:99]
    s_cmp_eq_u32 s100, 94208
    s_cselect_b32 s101, -94208, s73
    v_mfma_f32_16x16x32_bf16 v[100:103], a[32:35], a[4:7], v[100:103]
    v_add_u32 v8, s101, v8
    v_mfma_f32_16x16x32_bf16 v[104:107], a[32:35], a[8:11], v[104:107]
    v_add_u32 v9, s101, v9
    v_mfma_f32_16x16x32_bf16 v[108:111], a[32:35], a[12:15], v[108:111]
    v_add_u32 v10, s101, v10
    v_mfma_f32_16x16x32_bf16 a[128:131], v[24:27], a[16:19], a[128:131]
    v_add_u32 v11, s101, v11
    v_mfma_f32_16x16x32_bf16 a[132:135], v[24:27], a[20:23], a[132:135]
    v_add_u32 v12, s101, v12
    v_mfma_f32_16x16x32_bf16 a[136:139], v[24:27], a[24:27], a[136:139]
    v_mfma_f32_16x16x32_bf16 a[140:143], v[24:27], a[28:31], a[140:143]
    v_mfma_f32_16x16x32_bf16 a[144:147], v[24:27], a[32:35], a[144:147]
    v_mfma_f32_16x16x32_bf16 a[112:115], a[40:43], a[40:43], a[112:115]
    v_mfma_f32_16x16x32_bf16 a[116:119], v[24:27], a[40:43], a[116:119]
    v_mfma_f32_16x16x32_bf16 a[120:123], a[44:47], a[44:47], a[120:123]
    v_mfma_f32_16x16x32_bf16 a[124:127], v[24:27], a[44:47], a[124:127]
    s_waitcnt lgkmcnt(0)
    s_waitcnt vmcnt(5)
    s_barrier
    v_mfma_f32_16x16x32_bf16 v[32:35], a[56:59], a[72:75], v[32:35]
    ds_read_b128 a[0:3], v8 offset:0
    v_mfma_f32_16x16x32_bf16 v[36:39], a[60:63], a[72:75], v[36:39]
    ds_read_b128 a[4:7], v8 offset:2048
    v_mfma_f32_16x16x32_bf16 v[40:43], a[64:67], a[72:75], v[40:43]
    ds_read_b128 a[8:11], v8 offset:8192
    v_mfma_f32_16x16x32_bf16 v[44:47], a[68:71], a[72:75], v[44:47]
    ds_read_b128 a[12:15], v8 offset:10240
    v_mfma_f32_16x16x32_bf16 v[48:51], a[56:59], a[76:79], v[48:51]
    ds_read_b64_tr_b16 a[16:17], v10 offset:0
    v_mfma_f32_16x16x32_bf16 v[52:55], a[60:63], a[76:79], v[52:55]
    ds_read_b64_tr_b16 a[18:19], v10 offset:256
    v_mfma_f32_16x16x32_bf16 v[56:59], a[64:67], a[76:79], v[56:59]
    ds_read_b64_tr_b16 a[20:21], v11 offset:0
    v_mfma_f32_16x16x32_bf16 v[60:63], a[68:71], a[76:79], v[60:63]
    ds_read_b64_tr_b16 a[22:23], v11 offset:256
    v_mfma_f32_16x16x32_bf16 v[64:67], a[56:59], a[80:83], v[64:67]
    ds_read_b64_tr_b16 a[24:25], v10 offset:4096
    v_mfma_f32_16x16x32_bf16 v[68:71], a[60:63], a[80:83], v[68:71]
    ds_read_b64_tr_b16 a[26:27], v10 offset:4352
    v_mfma_f32_16x16x32_bf16 v[72:75], a[64:67], a[80:83], v[72:75]
    ds_read_b64_tr_b16 a[28:29], v11 offset:4096
    v_mfma_f32_16x16x32_bf16 v[76:79], a[68:71], a[80:83], v[76:79]
    ds_read_b64_tr_b16 a[30:31], v11 offset:4352
    v_mfma_f32_16x16x32_bf16 v[80:83], a[56:59], a[84:87], v[80:83]
    ds_read_b64_tr_b16 a[32:33], v12 offset:16384
    v_mfma_f32_16x16x32_bf16 v[84:87], a[60:63], a[84:87], v[84:87]
    ds_read_b64_tr_b16 a[34:35], v12 offset:16640
    v_mfma_f32_16x16x32_bf16 v[88:91], a[64:67], a[84:87], v[88:91]
    ds_read_b128 a[40:43], v9 offset:0
    v_mfma_f32_16x16x32_bf16 v[92:95], a[68:71], a[84:87], v[92:95]
    ds_read_b128 a[44:47], v9 offset:2048
    v_mfma_f32_16x16x32_bf16 v[96:99], a[88:91], a[56:59], v[96:99]
    v_add_u32 v14, s101, v14
    v_mfma_f32_16x16x32_bf16 v[100:103], a[88:91], a[60:63], v[100:103]
    v_add_u32 v15, s101, v15
    v_mfma_f32_16x16x32_bf16 v[104:107], a[88:91], a[64:67], v[104:107]
    v_add_u32 v16, s101, v16
    v_mfma_f32_16x16x32_bf16 v[108:111], a[88:91], a[68:71], v[108:111]
    v_add_u32 v17, s101, v17
    v_mfma_f32_16x16x32_bf16 a[112:115], a[96:99], a[96:99], a[112:115]
    v_add_u32 v29, s101, v29
    v_mfma_f32_16x16x32_bf16 a[116:119], v[24:27], a[96:99], a[116:119]
    v_mfma_f32_16x16x32_bf16 a[120:123], a[100:103], a[100:103], a[120:123]
    v_mfma_f32_16x16x32_bf16 a[124:127], v[24:27], a[100:103], a[124:127]
    s_add_u32 s100, s100, s101
    s_add_u32 s11, s11, 1
    s_cmp_lt_u32 s11, 8
    s_waitcnt lgkmcnt(0)
    s_cbranch_scc1 L_F_B43_tail
    s_barrier
    s_mul_i32 s73, s48, 33792
    s_mov_b32 s28, s14
    s_mov_b32 s29, s15
    s_mov_b32 s30, 8388608
    s_mov_b32 s31, 0x20000
    s_waitcnt vmcnt(4)
    s_mov_b32 s101, 0
    v_cmp_eq_u32 vcc, 0, v21
    s_nop 3
    s_cbranch_vccnz L_F_B43_nspin
L_F_B43_nspin_go:
    v_readfirstlane_b32 s49, v21
    v_mov_b32 v144, 0x3b000000
    v_mov_b32 v145, 0x3727c5ac
    v_and_b32 v146, 1, v0
    v_cmp_eq_u32 s[50:51], 1, v146
    v_and_b32 v146, 2, v0
    v_cmp_eq_u32 s[52:53], 2, v146
    v_lshrrev_b32 v146, 2, v2
    v_cmp_eq_u32 s[54:55], v1, v146
    s_waitcnt vmcnt(0)
    ds_read_b64_tr_b16 v[192:193], v141 offset:0
    ds_read_b64_tr_b16 v[194:195], v141 offset:1024
    ds_read_b64_tr_b16 v[196:197], v142 offset:0
    ds_read_b64_tr_b16 v[198:199], v142 offset:1024
    ds_read_b64_tr_b16 v[200:201], v141 offset:2048
    ds_read_b64_tr_b16 v[202:203], v141 offset:3072
    ds_read_b64_tr_b16 v[204:205], v142 offset:2048
    ds_read_b64_tr_b16 v[206:207], v142 offset:3072
    v_accvgpr_read_b32 v160, a112
    v_accvgpr_read_b32 v161, a113
    v_accvgpr_read_b32 v162, a114
    v_accvgpr_read_b32 v163, a115
    v_accvgpr_read_b32 v164, a116
    v_accvgpr_read_b32 v168, a120
    v_accvgpr_read_b32 v169, a121
    v_accvgpr_read_b32 v170, a122
    v_accvgpr_read_b32 v171, a123
    v_accvgpr_read_b32 v172, a124
    v_cndmask_b32 v160, v160, v161, s[50:51]
    v_cndmask_b32 v162, v162, v163, s[50:51]
    v_cndmask_b32 v168, v168, v169, s[50:51]
    v_cndmask_b32 v170, v170, v171, s[50:51]
    v_mul_f32 v164, v164, v144
    v_cndmask_b32 v160, v160, v162, s[52:53]
    v_mul_f32 v172, v172, v144
    v_cndmask_b32 v168, v168, v170, s[52:53]
    v_mul_f32 v160, v160, v144
    v_mul_f32 v168, v168, v144
    v_fma_f32 v160, -v164, v164, v160
    v_fma_f32 v168, -v172, v172, v168
    v_max_f32 v160, 0, v160
    v_max_f32 v168, 0, v168
    v_cvt_pk_bf16_f32 v160, v160, v160
    v_and_b32 v160, 0xffff0000, v160
    v_cvt_pk_bf16_f32 v168, v168, v168
    v_and_b32 v168, 0xffff0000, v168
    v_add_f32 v160, v160, v145
    v_add_f32 v168, v168, v145
    v_cvt_pk_bf16_f32 v160, v160, v160
    v_and_b32 v160, 0xffff0000, v160
    v_cvt_pk_bf16_f32 v168, v168, v168
    v_and_b32 v168, 0xffff0000, v168
    v_sqrt_f32 v160, v160
    v_sqrt_f32 v168, v168
    s_add_u32 s32, s24, 16777216
    s_addc_u32 s33, s25, 0
    s_mov_b32 s34, 1441792
    s_waitcnt lgkmcnt(0)
    buffer_store_dwordx4 v[192:195], v20, s[32:35], s26 offen offset:0 sc1
    buffer_store_dwordx4 v[196:199], v20, s[32:35], s26 offen offset:1024 sc1
    buffer_store_dwordx4 v[200:203], v20, s[32:35], s26 offen offset:2048 sc1
    buffer_store_dwordx4 v[204:207], v20, s[32:35], s26 offen offset:3072 sc1
    v_cvt_pk_bf16_f32 v164, v164, v164
    v_and_b32 v164, 0xffff0000, v164
    v_cvt_pk_bf16_f32 v172, v172, v172
    v_and_b32 v172, 0xffff0000, v172
    v_cvt_pk_bf16_f32 v160, v160, v160
    v_and_b32 v160, 0xffff0000, v160
    v_cvt_pk_bf16_f32 v168, v168, v168
    v_and_b32 v168, 0xffff0000, v168
    v_rcp_f32 v160, v160
    v_rcp_f32 v168, v168
    v_mul_f32 v164, -v164, v160
    v_mul_f32 v172, -v172, v168
    ds_write_b32 v149, a128 offset:2048
    ds_write_b32 v149, a132 offset:2112
    ds_write_b32 v149, a136 offset:2176
    ds_write_b32 v149, a140 offset:2240
    ds_write_b32 v150, a144 offset:2560
    s_mov_b64 exec, s[54:55]
    ds_write_b32 v148, v160 offset:0
    ds_write_b32 v148, v164 offset:1024
    ds_write_b32 v148, v168 offset:64
    ds_write_b32 v148, v172 offset:1088
    s_mov_b64 exec, -1
    s_add_u32 s44, s24, 15466496
    s_addc_u32 s45, s25, 0
    s_mov_b32 s46, 196608
    s_mov_b32 s47, 0x20000
    s_waitcnt lgkmcnt(0)
    s_barrier
    ds_read_b128 v[152:155], v240 offset:0
    ds_read_b128 v[168:171], v240 offset:1024
    ds_read_b128 v[156:159], v240 offset:64
    ds_read_b128 v[172:175], v240 offset:1088
    ds_read_b32 v184, v244 offset:2048
    ds_read_b32 v185, v244 offset:3072
    ds_read_b32 v186, v244 offset:2112
    ds_read_b32 v187, v244 offset:3136
    ds_read_b32 v188, v244 offset:2176
    ds_read_b32 v189, v244 offset:3200
    ds_read_b32 v190, v244 offset:2240
    ds_read_b32 v191, v244 offset:3264
    s_add_u32 s32, s24, 14942208
    s_addc_u32 s33, s25, 0
    s_mov_b32 s34, 262144
    s_mov_b32 s35, 0x20000
    s_mov_b32 s71, 0
    v_mov_b32 v247, s49
    v_mov_b32 v249, s49
    s_waitcnt lgkmcnt(0)
    ds_read_b128 v[160:163], v240 offset:256
    ds_read_b128 v[176:179], v240 offset:1280
    ds_read_b128 v[164:167], v240 offset:320
    ds_read_b128 v[180:183], v240 offset:1344
    ds_read_b32 v232, v242 offset:0
    ds_read_b32 v236, v242 offset:1024
    ds_read_b32 v233, v242 offset:64
    ds_read_b32 v237, v242 offset:1088
    ds_read_b32 v234, v242 offset:256
    ds_read_b32 v238, v242 offset:1280
    ds_read_b32 v235, v242 offset:320
    ds_read_b32 v239, v242 offset:1344
    v_add_f32 v184, v184, v185
    v_add_f32 v186, v186, v187
    v_add_f32 v188, v188, v189
    v_add_f32 v190, v190, v191
    v_pk_mul_f32 v[224:225], v[168:169], v[184:185] op_sel_hi:[1,0]
    v_pk_mul_f32 v[226:227], v[170:171], v[184:185] op_sel_hi:[1,0]
    v_pk_mul_f32 v[228:229], v[172:173], v[184:185] op_sel_hi:[1,0]
    v_pk_mul_f32 v[230:231], v[174:175], v[184:185] op_sel_hi:[1,0]
    v_pk_fma_f32 v[32:33], v[152:153], v[32:33], v[224:225]
    v_pk_fma_f32 v[34:35], v[154:155], v[34:35], v[226:227]
    v_pk_fma_f32 v[36:37], v[156:157], v[36:37], v[228:229]
    v_pk_fma_f32 v[38:39], v[158:159], v[38:39], v[230:231]
    v_pk_mul_f32 v[224:225], v[32:33], v[32:33]
    v_pk_mul_f32 v[226:227], v[34:35], v[34:35]
    v_pk_mul_f32 v[228:229], v[36:37], v[36:37]
    v_pk_mul_f32 v[230:231], v[38:39], v[38:39]
    v_pk_fma_f32 v[224:225], v[224:225], v[250:251], v[250:251] op_sel:[0,1,0] op_sel_hi:[1,1,0]
    v_pk_fma_f32 v[226:227], v[226:227], v[250:251], v[250:251] op_sel:[0,1,0] op_sel_hi:[1,1,0]
    v_pk_fma_f32 v[228:229], v[228:229], v[250:251], v[250:251] op_sel:[0,1,0] op_sel_hi:[1,1,0]
    v_pk_fma_f32 v[230:231], v[230:231], v[250:251], v[250:251] op_sel:[0,1,0] op_sel_hi:[1,1,0]
    v_pk_mul_f32 v[224:225], v[224:225], v[32:33]
    v_pk_mul_f32 v[226:227], v[226:227], v[34:35]
    v_pk_mul_f32 v[228:229], v[228:229], v[36:37]
    v_pk_mul_f32 v[230:231], v[230:231], v[38:39]
    v_exp_f32 v224, v224
    v_exp_f32 v225, v225
    v_exp_f32 v226, v226
    v_exp_f32 v227, v227
    v_exp_f32 v228, v228
    s_add_u32 m0, s73, 1024
    s_nop 0
    buffer_load_dwordx4 v23, s[28:31], s83 offen offset:0  lds
    v_exp_f32 v229, v229
    v_exp_f32 v230, v230
    v_exp_f32 v231, v231
    v_pk_add_f32 v[224:225], v[224:225], 1.0 op_sel_hi:[1,0]
    v_pk_add_f32 v[226:227], v[226:227], 1.0 op_sel_hi:[1,0]
    v_pk_add_f32 v[228:229], v[228:229], 1.0 op_sel_hi:[1,0]
    v_pk_add_f32 v[230:231], v[230:231], 1.0 op_sel_hi:[1,0]
    v_rcp_f32 v224, v224
    v_rcp_f32 v225, v225
    v_rcp_f32 v226, v226
    v_rcp_f32 v227, v227
    v_rcp_f32 v228, v228
    v_rcp_f32 v229, v229
    v_rcp_f32 v230, v230
    v_rcp_f32 v231, v231
    v_pk_mul_f32 v[32:33], v[32:33], v[224:225]
    v_pk_mul_f32 v[34:35], v[34:35], v[226:227]
    v_pk_mul_f32 v[36:37], v[36:37], v[228:229]
    v_pk_mul_f32 v[38:39], v[38:39], v[230:231]
    s_add_u32 m0, s73, 2048
    s_nop 0
    buffer_load_dwordx4 v31, s[28:31], s83 offen offset:0  lds
    v_mov_b32 v192, v32
    v_mov_b32 v193, v33
    v_pk_mul_f32 v[196:197], v[32:33], v[32:33]
    v_mov_b32 v194, v34
    v_mov_b32 v195, v35
    v_pk_mul_f32 v[198:199], v[34:35], v[34:35]
    v_mov_b32 v200, v36
    v_mov_b32 v201, v37
    v_pk_mul_f32 v[204:205], v[36:37], v[36:37]
    v_mov_b32 v202, v38
    v_mov_b32 v203, v39
    v_pk_mul_f32 v[206:207], v[38:39], v[38:39]
    v_pk_mul_f32 v[224:225], v[168:169], v[186:187] op_sel_hi:[1,0]
    v_pk_mul_f32 v[226:227], v[170:171], v[186:187] op_sel_hi:[1,0]
    v_pk_mul_f32 v[228:229], v[172:173], v[186:187] op_sel_hi:[1,0]
    v_pk_mul_f32 v[230:231], v[174:175], v[186:187] op_sel_hi:[1,0]
    v_pk_fma_f32 v[48:49], v[152:153], v[48:49], v[224:225]
    v_pk_fma_f32 v[50:51], v[154:155], v[50:51], v[226:227]
    v_pk_fma_f32 v[52:53], v[156:157], v[52:53], v[228:229]
    v_pk_fma_f32 v[54:55], v[158:159], v[54:55], v[230:231]
    v_pk_mul_f32 v[224:225], v[48:49], v[48:49]
    v_pk_mul_f32 v[226:227], v[50:51], v[50:51]
    v_pk_mul_f32 v[228:229], v[52:53], v[52:53]
    v_pk_mul_f32 v[230:231], v[54:55], v[54:55]
    v_pk_fma_f32 v[224:225], v[224:225], v[250:251], v[250:251] op_sel:[0,1,0] op_sel_hi:[1,1,0]
    v_pk_fma_f32 v[226:227], v[226:227], v[250:251], v[250:251] op_sel:[0,1,0] op_sel_hi:[1,1,0]
    v_pk_fma_f32 v[228:229], v[228:229], v[250:251], v[250:251] op_sel:[0,1,0] op_sel_hi:[1,1,0]
    v_pk_fma_f32 v[230:231], v[230:231], v[250:251], v[250:251] op_sel:[0,1,0] op_sel_hi:[1,1,0]
    v_pk_mul_f32 v[224:225], v[224:225], v[48:49]
    v_pk_mul_f32 v[226:227], v[226:227], v[50:51]
    s_add_u32 m0, s73, 3072
    s_nop 0
    buffer_load_dwordx4 v23, s[28:31], s27 offen offset:0  lds
    v_pk_mul_f32 v[228:229], v[228:229], v[52:53]
    v_pk_mul_f32 v[230:231], v[230:231], v[54:55]
    v_exp_f32 v224, v224
    v_exp_f32 v225, v225
    v_exp_f32 v226, v226
    v_exp_f32 v227, v227
    v_exp_f32 v228, v228
    v_exp_f32 v229, v229
    v_exp_f32 v230, v230
    v_exp_f32 v231, v231
    v_pk_add_f32 v[224:225], v[224:225], 1.0 op_sel_hi:[1,0]
    v_pk_add_f32 v[226:227], v[226:227], 1.0 op_sel_hi:[1,0]
    v_pk_add_f32 v[228:229], v[228:229], 1.0 op_sel_hi:[1,0]
    v_pk_add_f32 v[230:231], v[230:231], 1.0 op_sel_hi:[1,0]
    v_rcp_f32 v224, v224
    v_rcp_f32 v225, v225
    v_rcp_f32 v226, v226
    v_rcp_f32 v227, v227
    s_add_u32 m0, s73, 4096
    s_nop 0
    buffer_load_dwordx4 v31, s[28:31], s27 offen offset:0  lds
    v_rcp_f32 v228, v228
    v_rcp_f32 v229, v229
    v_rcp_f32 v230, v230
    v_rcp_f32 v231, v231
    v_pk_mul_f32 v[48:49], v[48:49], v[224:225]
    v_pk_mul_f32 v[50:51], v[50:51], v[226:227]
    v_pk_mul_f32 v[52:53], v[52:53], v[228:229]
    v_pk_mul_f32 v[54:55], v[54:55], v[230:231]
    v_pk_add_f32 v[192:193], v[192:193], v[48:49]
    v_pk_fma_f32 v[196:197], v[48:49], v[48:49], v[196:197]
    v_pk_add_f32 v[194:195], v[194:195], v[50:51]
    v_pk_fma_f32 v[198:199], v[50:51], v[50:51], v[198:199]
    v_pk_add_f32 v[200:201], v[200:201], v[52:53]
    v_pk_fma_f32 v[204:205], v[52:53], v[52:53], v[204:205]
    v_pk_add_f32 v[202:203], v[202:203], v[54:55]
    v_pk_fma_f32 v[206:207], v[54:55], v[54:55], v[206:207]
    v_pk_mul_f32 v[224:225], v[168:169], v[188:189] op_sel_hi:[1,0]
    v_pk_mul_f32 v[226:227], v[170:171], v[188:189] op_sel_hi:[1,0]
    v_pk_mul_f32 v[228:229], v[172:173], v[188:189] op_sel_hi:[1,0]
    v_pk_mul_f32 v[230:231], v[174:175], v[188:189] op_sel_hi:[1,0]
    v_pk_fma_f32 v[64:65], v[152:153], v[64:65], v[224:225]
    v_pk_fma_f32 v[66:67], v[154:155], v[66:67], v[226:227]
    v_pk_fma_f32 v[68:69], v[156:157], v[68:69], v[228:229]
    v_pk_fma_f32 v[70:71], v[158:159], v[70:71], v[230:231]
    v_pk_mul_f32 v[224:225], v[64:65], v[64:65]
    v_pk_mul_f32 v[226:227], v[66:67], v[66:67]
    s_add_u32 m0, s73, 5120
    s_nop 0
    buffer_load_dwordx4 v23, s[28:31], s58 offen offset:0  lds
    v_pk_mul_f32 v[228:229], v[68:69], v[68:69]
    v_pk_mul_f32 v[230:231], v[70:71], v[70:71]
    v_pk_fma_f32 v[224:225], v[224:225], v[250:251], v[250:251] op_sel:[0,1,0] op_sel_hi:[1,1,0]
    v_pk_fma_f32 v[226:227], v[226:227], v[250:251], v[250:251] op_sel:[0,1,0] op_sel_hi:[1,1,0]
    v_pk_fma_f32 v[228:229], v[228:229], v[250:251], v[250:251] op_sel:[0,1,0] op_sel_hi:[1,1,0]
    v_pk_fma_f32 v[230:231], v[230:231], v[250:251], v[250:251] op_sel:[0,1,0] op_sel_hi:[1,1,0]
    v_pk_mul_f32 v[224:225], v[224:225], v[64:65]
    v_pk_mul_f32 v[226:227], v[226:227], v[66:67]
    v_pk_mul_f32 v[228:229], v[228:229], v[68:69]
    v_pk_mul_f32 v[230:231], v[230:231], v[70:71]
    v_exp_f32 v224, v224
    v_exp_f32 v225, v225
    v_exp_f32 v226, v226
    v_exp_f32 v227, v227
    v_exp_f32 v228, v228
    v_exp_f32 v229, v229
    v_exp_f32 v230, v230
    v_exp_f32 v231, v231
    v_pk_add_f32 v[224:225], v[224:225], 1.0 op_sel_hi:[1,0]
    v_pk_add_f32 v[226:227], v[226:227], 1.0 op_sel_hi:[1,0]
    v_pk_add_f32 v[228:229], v[228:229], 1.0 op_sel_hi:[1,0]
    v_pk_add_f32 v[230:231], v[230:231], 1.0 op_sel_hi:[1,0]
    s_add_u32 m0, s73, 6144
    s_nop 0
    buffer_load_dwordx4 v31, s[28:31], s58 offen offset:0  lds
    v_rcp_f32 v224, v224
    v_rcp_f32 v225, v225
    v_rcp_f32 v226, v226
    v_rcp_f32 v227, v227
    v_rcp_f32 v228, v228
    v_rcp_f32 v229, v229
    v_rcp_f32 v230, v230
    v_rcp_f32 v231, v231
    v_pk_mul_f32 v[64:65], v[64:65], v[224:225]
    v_pk_mul_f32 v[66:67], v[66:67], v[226:227]
    v_pk_mul_f32 v[68:69], v[68:69], v[228:229]
    v_pk_mul_f32 v[70:71], v[70:71], v[230:231]
    v_pk_add_f32 v[192:193], v[192:193], v[64:65]
    v_pk_fma_f32 v[196:197], v[64:65], v[64:65], v[196:197]
    v_pk_add_f32 v[194:195], v[194:195], v[66:67]
    v_pk_fma_f32 v[198:199], v[66:67], v[66:67], v[198:199]
    v_pk_add_f32 v[200:201], v[200:201], v[68:69]
    v_pk_fma_f32 v[204:205], v[68:69], v[68:69], v[204:205]
    v_pk_add_f32 v[202:203], v[202:203], v[70:71]
    v_pk_fma_f32 v[206:207], v[70:71], v[70:71], v[206:207]
    v_pk_mul_f32 v[224:225], v[168:169], v[190:191] op_sel_hi:[1,0]
    v_pk_mul_f32 v[226:227], v[170:171], v[190:191] op_sel_hi:[1,0]
    s_add_u32 m0, s73, 7168
    s_nop 0
    buffer_load_dwordx4 v23, s[28:31], s72 offen offset:0  lds
    v_pk_mul_f32 v[228:229], v[172:173], v[190:191] op_sel_hi:[1,0]
    v_pk_mul_f32 v[230:231], v[174:175], v[190:191] op_sel_hi:[1,0]
    v_pk_fma_f32 v[80:81], v[152:153], v[80:81], v[224:225]
    v_pk_fma_f32 v[82:83], v[154:155], v[82:83], v[226:227]
    v_pk_fma_f32 v[84:85], v[156:157], v[84:85], v[228:229]
    v_pk_fma_f32 v[86:87], v[158:159], v[86:87], v[230:231]
    v_pk_mul_f32 v[224:225], v[80:81], v[80:81]
    v_pk_mul_f32 v[226:227], v[82:83], v[82:83]
    v_pk_mul_f32 v[228:229], v[84:85], v[84:85]
    v_pk_mul_f32 v[230:231], v[86:87], v[86:87]
    v_pk_fma_f32 v[224:225], v[224:225], v[250:251], v[250:251] op_sel:[0,1,0] op_sel_hi:[1,1,0]
    v_pk_fma_f32 v[226:227], v[226:227], v[250:251], v[250:251] op_sel:[0,1,0] op_sel_hi:[1,1,0]
    v_pk_fma_f32 v[228:229], v[228:229], v[250:251], v[250:251] op_sel:[0,1,0] op_sel_hi:[1,1,0]
    v_pk_fma_f32 v[230:231], v[230:231], v[250:251], v[250:251] op_sel:[0,1,0] op_sel_hi:[1,1,0]
    v_pk_mul_f32 v[224:225], v[224:225], v[80:81]
    v_pk_mul_f32 v[226:227], v[226:227], v[82:83]
    v_pk_mul_f32 v[228:229], v[228:229], v[84:85]
    v_pk_mul_f32 v[230:231], v[230:231], v[86:87]
    v_exp_f32 v224, v224
    v_exp_f32 v225, v225
    v_exp_f32 v226, v226
    v_exp_f32 v227, v227
    v_exp_f32 v228, v228
    v_exp_f32 v229, v229
    s_add_u32 m0, s73, 8192
    s_nop 0
    buffer_load_dwordx4 v31, s[28:31], s72 offen offset:0  lds
    v_exp_f32 v230, v230
    v_exp_f32 v231, v231
    v_pk_add_f32 v[224:225], v[224:225], 1.0 op_sel_hi:[1,0]
    v_pk_add_f32 v[226:227], v[226:227], 1.0 op_sel_hi:[1,0]
    v_pk_add_f32 v[228:229], v[228:229], 1.0 op_sel_hi:[1,0]
    v_pk_add_f32 v[230:231], v[230:231], 1.0 op_sel_hi:[1,0]
    v_rcp_f32 v224, v224
    v_rcp_f32 v225, v225
    v_rcp_f32 v226, v226
    v_rcp_f32 v227, v227
    v_rcp_f32 v228, v228
    v_rcp_f32 v229, v229
    v_rcp_f32 v230, v230
    v_rcp_f32 v231, v231
    v_pk_mul_f32 v[80:81], v[80:81], v[224:225]
    v_pk_mul_f32 v[82:83], v[82:83], v[226:227]
    v_pk_mul_f32 v[84:85], v[84:85], v[228:229]
    v_pk_mul_f32 v[86:87], v[86:87], v[230:231]
    v_pk_add_f32 v[192:193], v[192:193], v[80:81]
    v_pk_fma_f32 v[196:197], v[80:81], v[80:81], v[196:197]
    s_add_u32 m0, s73, 8960
    s_nop 0
    buffer_load_dwordx4 v23, s[28:31], s83 offen offset:256  lds
    v_pk_add_f32 v[194:195], v[194:195], v[82:83]
    v_pk_fma_f32 v[198:199], v[82:83], v[82:83], v[198:199]
    v_pk_add_f32 v[200:201], v[200:201], v[84:85]
    v_pk_fma_f32 v[204:205], v[84:85], v[84:85], v[204:205]
    v_pk_add_f32 v[202:203], v[202:203], v[86:87]
    v_pk_fma_f32 v[206:207], v[86:87], v[86:87], v[206:207]
    ds_read_b128 v[152:155], v245 offset:2560
    ds_read_b128 v[156:159], v245 offset:3584
    v_add_f32_dpp v192, v192, v192 row_mirror row_mask:0xf bank_mask:0x3
    v_add_f32_dpp v193, v193, v193 row_mirror row_mask:0xf bank_mask:0x3
    v_add_f32_dpp v194, v194, v194 row_mirror row_mask:0xf bank_mask:0x3
    v_add_f32_dpp v195, v195, v195 row_mirror row_mask:0xf bank_mask:0x3
    v_add_f32_dpp v196, v196, v196 row_mirror row_mask:0xf bank_mask:0x3
    v_add_f32_dpp v197, v197, v197 row_mirror row_mask:0xf bank_mask:0x3
    v_add_f32_dpp v198, v198, v198 row_mirror row_mask:0xf bank_mask:0x3
    v_add_f32_dpp v199, v199, v199 row_mirror row_mask:0xf bank_mask:0x3
    v_add_f32_dpp v192, v200, v200 row_mirror row_mask:0xf bank_mask:0xc
    v_add_f32_dpp v193, v201, v201 row_mirror row_mask:0xf bank_mask:0xc
    v_add_f32_dpp v194, v202, v202 row_mirror row_mask:0xf bank_mask:0xc
    v_add_f32_dpp v195, v203, v203 row_mirror row_mask:0xf bank_mask:0xc
    v_add_f32_dpp v196, v204, v204 row_mirror row_mask:0xf bank_mask:0xc
    v_add_f32_dpp v197, v205, v205 row_mirror row_mask:0xf bank_mask:0xc
    v_add_f32_dpp v198, v206, v206 row_mirror row_mask:0xf bank_mask:0xc
    v_add_f32_dpp v199, v207, v207 row_mirror row_mask:0xf bank_mask:0xc
    v_add_f32_dpp v192, v192, v192 row_half_mirror row_mask:0xf bank_mask:0x5
    v_add_f32_dpp v193, v193, v193 row_half_mirror row_mask:0xf bank_mask:0x5
    v_add_f32_dpp v194, v194, v194 row_half_mirror row_mask:0xf bank_mask:0x5
    v_add_f32_dpp v195, v195, v195 row_half_mirror row_mask:0xf bank_mask:0x5
    v_add_f32_dpp v192, v196, v196 row_half_mirror row_mask:0xf bank_mask:0xa
    v_add_f32_dpp v193, v197, v197 row_half_mirror row_mask:0xf bank_mask:0xa
    v_add_f32_dpp v194, v198, v198 row_half_mirror row_mask:0xf bank_mask:0xa
    v_add_f32_dpp v195, v199, v199 row_half_mirror row_mask:0xf bank_mask:0xa
    s_add_u32 m0, s73, 9984
    s_nop 0
    buffer_load_dwordx4 v31, s[28:31], s83 offen offset:256  lds
    v_add_f32_dpp v192, v192, v192 quad_perm:[1,0,3,2] row_mask:0xf bank_mask:0xf
    v_add_f32_dpp v193, v193, v193 quad_perm:[1,0,3,2] row_mask:0xf bank_mask:0xf
    v_add_f32_dpp v194, v194, v194 quad_perm:[1,0,3,2] row_mask:0xf bank_mask:0xf
    v_add_f32_dpp v195, v195, v195 quad_perm:[1,0,3,2] row_mask:0xf bank_mask:0xf
    v_add_f32_dpp v192, v192, v192 quad_perm:[2,3,0,1] row_mask:0xf bank_mask:0xf
    v_add_f32_dpp v193, v193, v193 quad_perm:[2,3,0,1] row_mask:0xf bank_mask:0xf
    v_add_f32_dpp v194, v194, v194 quad_perm:[2,3,0,1] row_mask:0xf bank_mask:0xf
    v_add_f32_dpp v195, v195, v195 quad_perm:[2,3,0,1] row_mask:0xf bank_mask:0xf
    ds_write_b128 v241, v[192:195] offset:4096
    s_waitcnt lgkmcnt(0)
    s_barrier
    ds_read_b32 v246, v243 offset:4096
    ds_read_b32 v248, v243 offset:4352
    ds_read_b32 v135, v243 offset:4608
    ds_read_b32 v136, v243 offset:4864
    v_pk_add_f32 v[152:153], v[152:153], v[156:157]
    v_pk_add_f32 v[154:155], v[154:155], v[158:159]
    s_waitcnt lgkmcnt(0)
    v_add_f32 v246, v246, v135
    v_add_f32 v248, v248, v136
    s_mov_b64 exec, 0xffff
    buffer_store_dwordx4 v[246:249], v20, s[32:35], s63 offen offset:0 sc1
    s_mov_b64 exec, -1
    v_pk_mul_f32 v[224:225], v[176:177], v[184:185] op_sel_hi:[1,0]
    v_pk_mul_f32 v[226:227], v[178:179], v[184:185] op_sel_hi:[1,0]
    v_pk_mul_f32 v[228:229], v[180:181], v[184:185] op_sel_hi:[1,0]
    v_pk_mul_f32 v[230:231], v[182:183], v[184:185] op_sel_hi:[1,0]
    v_pk_fma_f32 v[40:41], v[160:161], v[40:41], v[224:225]
    v_pk_fma_f32 v[42:43], v[162:163], v[42:43], v[226:227]
    v_pk_fma_f32 v[44:45], v[164:165], v[44:45], v[228:229]
    v_pk_fma_f32 v[46:47], v[166:167], v[46:47], v[230:231]
    v_pk_mul_f32 v[224:225], v[40:41], v[40:41]
    v_pk_mul_f32 v[226:227], v[42:43], v[42:43]
    v_pk_mul_f32 v[228:229], v[44:45], v[44:45]
    v_pk_mul_f32 v[230:231], v[46:47], v[46:47]
    v_pk_fma_f32 v[224:225], v[224:225], v[250:251], v[250:251] op_sel:[0,1,0] op_sel_hi:[1,1,0]
    s_add_u32 m0, s73, 11008
    s_nop 0
    buffer_load_dwordx4 v23, s[28:31], s27 offen offset:256  lds
    v_pk_fma_f32 v[226:227], v[226:227], v[250:251], v[250:251] op_sel:[0,1,0] op_sel_hi:[1,1,0]
    v_pk_fma_f32 v[228:229], v[228:229], v[250:251], v[250:251] op_sel:[0,1,0] op_sel_hi:[1,1,0]
    v_pk_fma_f32 v[230:231], v[230:231], v[250:251], v[250:251] op_sel:[0,1,0] op_sel_hi:[1,1,0]
    v_pk_mul_f32 v[224:225], v[224:225], v[40:41]
    v_pk_mul_f32 v[226:227], v[226:227], v[42:43]
    v_pk_mul_f32 v[228:229], v[228:229], v[44:45]
    v_pk_mul_f32 v[230:231], v[230:231], v[46:47]
    v_exp_f32 v224, v224
    v_exp_f32 v225, v225
    v_exp_f32 v226, v226
    v_exp_f32 v227, v227
    v_exp_f32 v228, v228
    v_exp_f32 v229, v229
    v_exp_f32 v230, v230
    v_exp_f32 v231, v231
    v_pk_add_f32 v[224:225], v[224:225], 1.0 op_sel_hi:[1,0]
    v_pk_add_f32 v[226:227], v[226:227], 1.0 op_sel_hi:[1,0]
    s_add_u32 m0, s73, 12032
    s_nop 0
    buffer_load_dwordx4 v31, s[28:31], s27 offen offset:256  lds
    v_pk_add_f32 v[228:229], v[228:229], 1.0 op_sel_hi:[1,0]
    v_pk_add_f32 v[230:231], v[230:231], 1.0 op_sel_hi:[1,0]
    v_rcp_f32 v224, v224
    v_rcp_f32 v225, v225
    v_rcp_f32 v226, v226
    v_rcp_f32 v227, v227
    v_rcp_f32 v228, v228
    v_rcp_f32 v229, v229
    v_rcp_f32 v230, v230
    v_rcp_f32 v231, v231
    v_pk_mul_f32 v[40:41], v[40:41], v[224:225]
    v_pk_mul_f32 v[42:43], v[42:43], v[226:227]
    v_pk_mul_f32 v[44:45], v[44:45], v[228:229]
    v_pk_mul_f32 v[46:47], v[46:47], v[230:231]
    v_mov_b32 v192, v40
    v_mov_b32 v193, v41
    v_pk_mul_f32 v[196:197], v[40:41], v[40:41]
    s_add_u32 m0, s73, 13056
    s_nop 0
    buffer_load_dwordx4 v23, s[28:31], s58 offen offset:256  lds
    v_mov_b32 v194, v42
    v_mov_b32 v195, v43
    v_pk_mul_f32 v[198:199], v[42:43], v[42:43]
    v_mov_b32 v200, v44
    v_mov_b32 v201, v45
    v_pk_mul_f32 v[204:205], v[44:45], v[44:45]
    v_mov_b32 v202, v46
    v_mov_b32 v203, v47
    v_pk_mul_f32 v[206:207], v[46:47], v[46:47]
    v_pk_mul_f32 v[224:225], v[176:177], v[186:187] op_sel_hi:[1,0]
    v_pk_mul_f32 v[226:227], v[178:179], v[186:187] op_sel_hi:[1,0]
    v_pk_mul_f32 v[228:229], v[180:181], v[186:187] op_sel_hi:[1,0]
    v_pk_mul_f32 v[230:231], v[182:183], v[186:187] op_sel_hi:[1,0]
    v_pk_fma_f32 v[56:57], v[160:161], v[56:57], v[224:225]
    v_pk_fma_f32 v[58:59], v[162:163], v[58:59], v[226:227]
    v_pk_fma_f32 v[60:61], v[164:165], v[60:61], v[228:229]
    v_pk_fma_f32 v[62:63], v[166:167], v[62:63], v[230:231]
    v_pk_mul_f32 v[224:225], v[56:57], v[56:57]
    v_pk_mul_f32 v[226:227], v[58:59], v[58:59]
    v_pk_mul_f32 v[228:229], v[60:61], v[60:61]
    v_pk_mul_f32 v[230:231], v[62:63], v[62:63]
    v_pk_fma_f32 v[224:225], v[224:225], v[250:251], v[250:251] op_sel:[0,1,0] op_sel_hi:[1,1,0]
    v_pk_fma_f32 v[226:227], v[226:227], v[250:251], v[250:251] op_sel:[0,1,0] op_sel_hi:[1,1,0]
    v_pk_fma_f32 v[228:229], v[228:229], v[250:251], v[250:251] op_sel:[0,1,0] op_sel_hi:[1,1,0]
    v_pk_fma_f32 v[230:231], v[230:231], v[250:251], v[250:251] op_sel:[0,1,0] op_sel_hi:[1,1,0]
    s_add_u32 m0, s73, 14080
    s_nop 0
    buffer_load_dwordx4 v31, s[28:31], s58 offen offset:256  lds
    v_pk_mul_f32 v[224:225], v[224:225], v[56:57]
    v_pk_mul_f32 v[226:227], v[226:227], v[58:59]
    v_pk_mul_f32 v[228:229], v[228:229], v[60:61]
    v_pk_mul_f32 v[230:231], v[230:231], v[62:63]
    v_exp_f32 v224, v224
    v_exp_f32 v225, v225
    v_exp_f32 v226, v226
    v_exp_f32 v227, v227
    v_exp_f32 v228, v228
    v_exp_f32 v229, v229
    v_exp_f32 v230, v230
    v_exp_f32 v231, v231
    v_pk_add_f32 v[224:225], v[224:225], 1.0 op_sel_hi:[1,0]
    v_pk_add_f32 v[226:227], v[226:227], 1.0 op_sel_hi:[1,0]
    v_pk_add_f32 v[228:229], v[228:229], 1.0 op_sel_hi:[1,0]
    v_pk_add_f32 v[230:231], v[230:231], 1.0 op_sel_hi:[1,0]
    v_rcp_f32 v224, v224
    s_add_u32 m0, s73, 15104
    s_nop 0
    buffer_load_dwordx4 v23, s[28:31], s72 offen offset:256  lds
    v_rcp_f32 v225, v225
    v_rcp_f32 v226, v226
    v_rcp_f32 v227, v227
    v_rcp_f32 v228, v228
    v_rcp_f32 v229, v229
    v_rcp_f32 v230, v230
    v_rcp_f32 v231, v231
    v_pk_mul_f32 v[56:57], v[56:57], v[224:225]
    v_pk_mul_f32 v[58:59], v[58:59], v[226:227]
    v_pk_mul_f32 v[60:61], v[60:61], v[228:229]
    v_pk_mul_f32 v[62:63], v[62:63], v[230:231]
    v_pk_add_f32 v[192:193], v[192:193], v[56:57]
    v_pk_fma_f32 v[196:197], v[56:57], v[56:57], v[196:197]
    v_pk_add_f32 v[194:195], v[194:195], v[58:59]
    v_pk_fma_f32 v[198:199], v[58:59], v[58:59], v[198:199]
    v_pk_add_f32 v[200:201], v[200:201], v[60:61]
    v_pk_fma_f32 v[204:205], v[60:61], v[60:61], v[204:205]
    v_pk_add_f32 v[202:203], v[202:203], v[62:63]
    s_add_u32 m0, s73, 16128
    s_nop 0
    buffer_load_dwordx4 v31, s[28:31], s72 offen offset:256  lds
    v_pk_fma_f32 v[206:207], v[62:63], v[62:63], v[206:207]
    v_pk_mul_f32 v[224:225], v[176:177], v[188:189] op_sel_hi:[1,0]
    v_pk_mul_f32 v[226:227], v[178:179], v[188:189] op_sel_hi:[1,0]
    v_pk_mul_f32 v[228:229], v[180:181], v[188:189] op_sel_hi:[1,0]
    v_pk_mul_f32 v[230:231], v[182:183], v[188:189] op_sel_hi:[1,0]
    v_pk_fma_f32 v[72:73], v[160:161], v[72:73], v[224:225]
    v_pk_fma_f32 v[74:75], v[162:163], v[74:75], v[226:227]
    v_pk_fma_f32 v[76:77], v[164:165], v[76:77], v[228:229]
    v_pk_fma_f32 v[78:79], v[166:167], v[78:79], v[230:231]
    v_pk_mul_f32 v[224:225], v[72:73], v[72:73]
    v_pk_mul_f32 v[226:227], v[74:75], v[74:75]
    v_pk_mul_f32 v[228:229], v[76:77], v[76:77]
    v_pk_mul_f32 v[230:231], v[78:79], v[78:79]
    v_pk_fma_f32 v[224:225], v[224:225], v[250:251], v[250:251] op_sel:[0,1,0] op_sel_hi:[1,1,0]
    v_pk_fma_f32 v[226:227], v[226:227], v[250:251], v[250:251] op_sel:[0,1,0] op_sel_hi:[1,1,0]
    v_pk_fma_f32 v[228:229], v[228:229], v[250:251], v[250:251] op_sel:[0,1,0] op_sel_hi:[1,1,0]
    v_pk_fma_f32 v[230:231], v[230:231], v[250:251], v[250:251] op_sel:[0,1,0] op_sel_hi:[1,1,0]
    v_pk_mul_f32 v[224:225], v[224:225], v[72:73]
    v_pk_mul_f32 v[226:227], v[226:227], v[74:75]
    v_pk_mul_f32 v[228:229], v[228:229], v[76:77]
    v_pk_mul_f32 v[230:231], v[230:231], v[78:79]
    v_exp_f32 v224, v224
    v_exp_f32 v225, v225
    s_add_u32 m0, s73, 16896
    s_nop 0
    buffer_load_dwordx4 v23, s[28:31], s83 offen offset:512  lds
    v_exp_f32 v226, v226
    v_exp_f32 v227, v227
    v_exp_f32 v228, v228
    v_exp_f32 v229, v229
    v_exp_f32 v230, v230
    v_exp_f32 v231, v231
    v_pk_add_f32 v[224:225], v[224:225], 1.0 op_sel_hi:[1,0]
    v_pk_add_f32 v[226:227], v[226:227], 1.0 op_sel_hi:[1,0]
    v_pk_add_f32 v[228:229], v[228:229], 1.0 op_sel_hi:[1,0]
    v_pk_add_f32 v[230:231], v[230:231], 1.0 op_sel_hi:[1,0]
    v_rcp_f32 v224, v224
    v_rcp_f32 v225, v225
    v_rcp_f32 v226, v226
    v_rcp_f32 v227, v227
    v_rcp_f32 v228, v228
    s_add_u32 m0, s73, 17920
    s_nop 0
    buffer_load_dwordx4 v31, s[28:31], s83 offen offset:512  lds
    v_rcp_f32 v229, v229
    v_rcp_f32 v230, v230
    v_rcp_f32 v231, v231
    v_pk_mul_f32 v[72:73], v[72:73], v[224:225]
    v_pk_mul_f32 v[74:75], v[74:75], v[226:227]
    v_pk_mul_f32 v[76:77], v[76:77], v[228:229]
    v_pk_mul_f32 v[78:79], v[78:79], v[230:231]
    v_pk_add_f32 v[192:193], v[192:193], v[72:73]
    v_pk_fma_f32 v[196:197], v[72:73], v[72:73], v[196:197]
    v_pk_add_f32 v[194:195], v[194:195], v[74:75]
    v_pk_fma_f32 v[198:199], v[74:75], v[74:75], v[198:199]
    v_pk_add_f32 v[200:201], v[200:201], v[76:77]
    v_pk_fma_f32 v[204:205], v[76:77], v[76:77], v[204:205]
    v_pk_add_f32 v[202:203], v[202:203], v[78:79]
    v_pk_fma_f32 v[206:207], v[78:79], v[78:79], v[206:207]
    v_pk_mul_f32 v[224:225], v[176:177], v[190:191] op_sel_hi:[1,0]
    v_pk_mul_f32 v[226:227], v[178:179], v[190:191] op_sel_hi:[1,0]
    v_pk_mul_f32 v[228:229], v[180:181], v[190:191] op_sel_hi:[1,0]
    v_pk_mul_f32 v[230:231], v[182:183], v[190:191] op_sel_hi:[1,0]
    v_pk_fma_f32 v[88:89], v[160:161], v[88:89], v[224:225]
    v_pk_fma_f32 v[90:91], v[162:163], v[90:91], v[226:227]
    v_pk_fma_f32 v[92:93], v[164:165], v[92:93], v[228:229]
    s_add_u32 m0, s73, 18944
    s_nop 0
    buffer_load_dwordx4 v23, s[28:31], s27 offen offset:512  lds
    v_pk_fma_f32 v[94:95], v[166:167], v[94:95], v[230:231]
    v_pk_mul_f32 v[224:225], v[88:89], v[88:89]
    v_pk_mul_f32 v[226:227], v[90:91], v[90:91]
    v_pk_mul_f32 v[228:229], v[92:93], v[92:93]
    v_pk_mul_f32 v[230:231], v[94:95], v[94:95]
    v_pk_fma_f32 v[224:225], v[224:225], v[250:251], v[250:251] op_sel:[0,1,0] op_sel_hi:[1,1,0]
    v_pk_fma_f32 v[226:227], v[226:227], v[250:251], v[250:251] op_sel:[0,1,0] op_sel_hi:[1,1,0]
    v_pk_fma_f32 v[228:229], v[228:229], v[250:251], v[250:251] op_sel:[0,1,0] op_sel_hi:[1,1,0]
    v_pk_fma_f32 v[230:231], v[230:231], v[250:251], v[250:251] op_sel:[0,1,0] op_sel_hi:[1,1,0]
    v_pk_mul_f32 v[224:225], v[224:225], v[88:89]
    v_pk_mul_f32 v[226:227], v[226:227], v[90:91]
    v_pk_mul_f32 v[228:229], v[228:229], v[92:93]
    v_pk_mul_f32 v[230:231], v[230:231], v[94:95]
    v_exp_f32 v224, v224
    v_exp_f32 v225, v225
    v_exp_f32 v226, v226
    v_exp_f32 v227, v227
    v_exp_f32 v228, v228
    v_exp_f32 v229, v229
    s_add_u32 m0, s73, 19968
    s_nop 0
    buffer_load_dwordx4 v31, s[28:31], s27 offen offset:512  lds
    v_exp_f32 v230, v230
    v_exp_f32 v231, v231
    v_pk_add_f32 v[224:225], v[224:225], 1.0 op_sel_hi:[1,0]
    v_pk_add_f32 v[226:227], v[226:227], 1.0 op_sel_hi:[1,0]
    v_pk_add_f32 v[228:229], v[228:229], 1.0 op_sel_hi:[1,0]
    v_pk_add_f32 v[230:231], v[230:231], 1.0 op_sel_hi:[1,0]
    v_rcp_f32 v224, v224
    v_rcp_f32 v225, v225
    v_rcp_f32 v226, v226
    v_rcp_f32 v227, v227
    v_rcp_f32 v228, v228
    v_rcp_f32 v229, v229
    v_rcp_f32 v230, v230
    v_rcp_f32 v231, v231
    v_pk_mul_f32 v[88:89], v[88:89], v[224:225]
    s_add_u32 m0, s73, 20992
    s_nop 0
    buffer_load_dwordx4 v23, s[28:31], s58 offen offset:512  lds
    v_pk_mul_f32 v[90:91], v[90:91], v[226:227]
    v_pk_mul_f32 v[92:93], v[92:93], v[228:229]
    v_pk_mul_f32 v[94:95], v[94:95], v[230:231]
    v_pk_add_f32 v[192:193], v[192:193], v[88:89]
    v_pk_fma_f32 v[196:197], v[88:89], v[88:89], v[196:197]
    v_pk_add_f32 v[194:195], v[194:195], v[90:91]
    v_pk_fma_f32 v[198:199], v[90:91], v[90:91], v[198:199]
    v_pk_add_f32 v[200:201], v[200:201], v[92:93]
    v_pk_fma_f32 v[204:205], v[92:93], v[92:93], v[204:205]
    v_pk_add_f32 v[202:203], v[202:203], v[94:95]
    v_pk_fma_f32 v[206:207], v[94:95], v[94:95], v[206:207]
    v_add_f32_dpp v192, v192, v192 row_mirror row_mask:0xf bank_mask:0x3
    v_add_f32_dpp v193, v193, v193 row_mirror row_mask:0xf bank_mask:0x3
    v_add_f32_dpp v194, v194, v194 row_mirror row_mask:0xf bank_mask:0x3
    v_add_f32_dpp v195, v195, v195 row_mirror row_mask:0xf bank_mask:0x3
    v_add_f32_dpp v196, v196, v196 row_mirror row_mask:0xf bank_mask:0x3
    v_add_f32_dpp v197, v197, v197 row_mirror row_mask:0xf bank_mask:0x3
    v_add_f32_dpp v198, v198, v198 row_mirror row_mask:0xf bank_mask:0x3
    v_add_f32_dpp v199, v199, v199 row_mirror row_mask:0xf bank_mask:0x3
    v_add_f32_dpp v192, v200, v200 row_mirror row_mask:0xf bank_mask:0xc
    v_add_f32_dpp v193, v201, v201 row_mirror row_mask:0xf bank_mask:0xc
    v_add_f32_dpp v194, v202, v202 row_mirror row_mask:0xf bank_mask:0xc
    v_add_f32_dpp v195, v203, v203 row_mirror row_mask:0xf bank_mask:0xc
    v_add_f32_dpp v196, v204, v204 row_mirror row_mask:0xf bank_mask:0xc
    v_add_f32_dpp v197, v205, v205 row_mirror row_mask:0xf bank_mask:0xc
    s_add_u32 m0, s73, 22016
    s_nop 0
    buffer_load_dwordx4 v31, s[28:31], s58 offen offset:512  lds
    v_add_f32_dpp v198, v206, v206 row_mirror row_mask:0xf bank_mask:0xc
    v_add_f32_dpp v199, v207, v207 row_mirror row_mask:0xf bank_mask:0xc
    v_add_f32_dpp v192, v192, v192 row_half_mirror row_mask:0xf bank_mask:0x5
    v_add_f32_dpp v193, v193, v193 row_half_mirror row_mask:0xf bank_mask:0x5
    v_add_f32_dpp v194, v194, v194 row_half_mirror row_mask:0xf bank_mask:0x5
    v_add_f32_dpp v195, v195, v195 row_half_mirror row_mask:0xf bank_mask:0x5
    v_add_f32_dpp v192, v196, v196 row_half_mirror row_mask:0xf bank_mask:0xa
    v_add_f32_dpp v193, v197, v197 row_half_mirror row_mask:0xf bank_mask:0xa
    v_add_f32_dpp v194, v198, v198 row_half_mirror row_mask:0xf bank_mask:0xa
    v_add_f32_dpp v195, v199, v199 row_half_mirror row_mask:0xf bank_mask:0xa
    v_add_f32_dpp v192, v192, v192 quad_perm:[1,0,3,2] row_mask:0xf bank_mask:0xf
    v_add_f32_dpp v193, v193, v193 quad_perm:[1,0,3,2] row_mask:0xf bank_mask:0xf
    v_add_f32_dpp v194, v194, v194 quad_perm:[1,0,3,2] row_mask:0xf bank_mask:0xf
    v_add_f32_dpp v195, v195, v195 quad_perm:[1,0,3,2] row_mask:0xf bank_mask:0xf
    v_add_f32_dpp v192, v192, v192 quad_perm:[2,3,0,1] row_mask:0xf bank_mask:0xf
    v_add_f32_dpp v193, v193, v193 quad_perm:[2,3,0,1] row_mask:0xf bank_mask:0xf
    v_add_f32_dpp v194, v194, v194 quad_perm:[2,3,0,1] row_mask:0xf bank_mask:0xf
    v_add_f32_dpp v195, v195, v195 quad_perm:[2,3,0,1] row_mask:0xf bank_mask:0xf
    ds_write_b128 v241, v[192:195] offset:5120
    s_waitcnt lgkmcnt(0)
    s_barrier
    ds_read_b32 v246, v243 offset:5120
    ds_read_b32 v248, v243 offset:5376
    ds_read_b32 v135, v243 offset:5632
    ds_read_b32 v136, v243 offset:5888
    buffer_load_dwordx4 v[208:211], v134, s[32:35], s66 offen offset:0 sc1
    buffer_load_dwordx4 v[212:215], v134, s[32:35], s67 offen offset:0 sc1
    buffer_load_dwordx4 v[216:219], v134, s[32:35], s68 offen offset:0 sc1
    buffer_load_dwordx4 v[220:223], v134, s[32:35], s69 offen offset:0 sc1
    s_waitcnt lgkmcnt(0)
    v_add_f32 v246, v246, v135
    v_add_f32 v248, v248, v136
    s_mov_b64 exec, 0xffff
    buffer_store_dwordx4 v[246:249], v20, s[32:35], s63 offen offset:1024 sc1
    s_mov_b64 exec, -1
    v_pk_mul_f32 v[224:225], v[152:153], v[236:237] op_sel_hi:[1,0]
    s_add_u32 m0, s73, 23040
    s_nop 0
    buffer_load_dwordx4 v23, s[28:31], s72 offen offset:512  lds
    v_pk_mul_f32 v[226:227], v[154:155], v[236:237] op_sel_hi:[1,0]
    v_pk_mul_f32 v[228:229], v[152:153], v[236:237] op_sel:[0,1]
    v_pk_mul_f32 v[230:231], v[154:155], v[236:237] op_sel:[0,1]
    v_pk_fma_f32 v[96:97], v[96:97], v[232:233], v[224:225] op_sel_hi:[1,0,1]
    v_pk_fma_f32 v[98:99], v[98:99], v[232:233], v[226:227] op_sel_hi:[1,0,1]
    v_pk_fma_f32 v[100:101], v[100:101], v[232:233], v[228:229] op_sel:[0,1,0]
    v_pk_fma_f32 v[102:103], v[102:103], v[232:233], v[230:231] op_sel:[0,1,0]
    v_pk_mul_f32 v[224:225], v[96:97], v[96:97]
    v_pk_mul_f32 v[226:227], v[98:99], v[98:99]
    v_pk_mul_f32 v[228:229], v[100:101], v[100:101]
    v_pk_mul_f32 v[230:231], v[102:103], v[102:103]
    v_pk_fma_f32 v[224:225], v[224:225], v[250:251], v[250:251] op_sel:[0,1,0] op_sel_hi:[1,1,0]
    v_pk_fma_f32 v[226:227], v[226:227], v[250:251], v[250:251] op_sel:[0,1,0] op_sel_hi:[1,1,0]
    v_pk_fma_f32 v[228:229], v[228:229], v[250:251], v[250:251] op_sel:[0,1,0] op_sel_hi:[1,1,0]
    v_pk_fma_f32 v[230:231], v[230:231], v[250:251], v[250:251] op_sel:[0,1,0] op_sel_hi:[1,1,0]
    v_pk_mul_f32 v[224:225], v[224:225], v[96:97]
    v_pk_mul_f32 v[226:227], v[226:227], v[98:99]
    v_pk_mul_f32 v[228:229], v[228:229], v[100:101]
    v_pk_mul_f32 v[230:231], v[230:231], v[102:103]
    v_exp_f32 v224, v224
    s_add_u32 m0, s73, 24064
    s_nop 0
    buffer_load_dwordx4 v31, s[28:31], s72 offen offset:512  lds
    v_exp_f32 v225, v225
    v_exp_f32 v226, v226
    v_exp_f32 v227, v227
    v_exp_f32 v228, v228
    v_exp_f32 v229, v229
    v_exp_f32 v230, v230
    v_exp_f32 v231, v231
    v_pk_add_f32 v[224:225], v[224:225], 1.0 op_sel_hi:[1,0]
    v_pk_add_f32 v[226:227], v[226:227], 1.0 op_sel_hi:[1,0]
    v_pk_add_f32 v[228:229], v[228:229], 1.0 op_sel_hi:[1,0]
    v_pk_add_f32 v[230:231], v[230:231], 1.0 op_sel_hi:[1,0]
    v_rcp_f32 v224, v224
    s_add_u32 m0, s73, 24832
    s_nop 0
    buffer_load_dwordx4 v23, s[28:31], s83 offen offset:768  lds
    v_rcp_f32 v225, v225
    v_rcp_f32 v226, v226
    v_rcp_f32 v227, v227
    v_rcp_f32 v228, v228
    v_rcp_f32 v229, v229
    v_rcp_f32 v230, v230
    v_rcp_f32 v231, v231
    v_pk_mul_f32 v[96:97], v[96:97], v[224:225]
    v_pk_mul_f32 v[98:99], v[98:99], v[226:227]
    v_pk_mul_f32 v[100:101], v[100:101], v[228:229]
    v_pk_mul_f32 v[102:103], v[102:103], v[230:231]
    v_cvt_pk_bf16_f32 v96, v96, v97
    v_cvt_pk_bf16_f32 v97, v98, v99
    s_add_u32 m0, s73, 25856
    s_nop 0
    buffer_load_dwordx4 v31, s[28:31], s83 offen offset:768  lds
    v_cvt_pk_bf16_f32 v98, v100, v101
    v_cvt_pk_bf16_f32 v99, v102, v103
    buffer_store_dwordx4 v[96:99], v20, s[36:39], s65 offen offset:0 sc1
    s_add_u32 m0, s73, 26880
    s_nop 0
    buffer_load_dwordx4 v23, s[28:31], s27 offen offset:768  lds
    s_add_u32 m0, s73, 27904
    s_nop 0
    buffer_load_dwordx4 v31, s[28:31], s27 offen offset:768  lds
    s_add_u32 m0, s73, 28928
    s_nop 0
    buffer_load_dwordx4 v23, s[28:31], s58 offen offset:768  lds
    s_add_u32 m0, s73, 29952
    s_nop 0
    buffer_load_dwordx4 v31, s[28:31], s58 offen offset:768  lds
    s_waitcnt vmcnt(10)
    v_xor_b32 v209, s49, v209
    v_xor_b32 v211, s49, v211
    v_xor_b32 v213, s49, v213
    v_xor_b32 v215, s49, v215
    v_xor_b32 v217, s49, v217
    v_xor_b32 v219, s49, v219
    v_xor_b32 v221, s49, v221
    v_xor_b32 v223, s49, v223
    v_or3_b32 v209, v209, v211, v213
    v_or3_b32 v215, v215, v217, v219
    v_or3_b32 v209, v209, v221, v223
    v_or_b32 v209, v209, v215
    v_cmp_ne_u32 vcc, 0, v209
    s_nop 3
    s_cbranch_vccnz L_F_B43_slow0
L_F_B43_slow0_go:
    v_add_f32 v208, v208, v212
    v_add_f32 v210, v210, v214
    v_add_f32 v216, v216, v220
    v_add_f32 v218, v218, v222
    v_add_f32 v208, v208, v216
    v_add_f32 v209, v210, v218
    v_mov_b32 v210, v208
    v_mov_b32 v211, v209
    s_nop 0
    v_permlane32_swap_b32 v208, v210
    v_permlane32_swap_b32 v209, v211
    v_add_f32 v208, v208, v210
    v_add_f32 v209, v209, v211
    v_mul_f32 v208, 0x3a924925, v208
    v_mul_f32 v209, 0x3a924925, v209
    v_fma_f32 v209, -v208, v208, v209
    v_max_f32 v209, 0, v209
    v_cvt_pk_bf16_f32 v209, v209, v209
    v_and_b32 v209, 0xffff0000, v209
    v_add_f32 v209, 0x3727c5ac, v209
    v_cvt_pk_bf16_f32 v209, v209, v209
    v_and_b32 v209, 0xffff0000, v209
    v_sqrt_f32 v209, v209
    v_cvt_pk_bf16_f32 v208, v208, v208
    v_and_b32 v208, 0xffff0000, v208
    v_cvt_pk_bf16_f32 v209, v209, v209
    v_and_b32 v209, 0xffff0000, v209
    v_rcp_f32 v209, v209
    s_nop 0
    v_mul_f32 v208, -v208, v209
    ds_write_b32 v132, v209 offset:6144
    ds_write_b32 v132, v208 offset:6400
    s_waitcnt lgkmcnt(0)
    ds_read_b128 v[192:195], v133 offset:6144
    ds_read_b128 v[200:203], v133 offset:6400
    ds_read_b128 v[196:199], v133 offset:6208
    ds_read_b128 v[204:207], v133 offset:6464
    s_waitcnt lgkmcnt(0)
    v_pk_fma_f32 v[32:33], v[32:33], v[192:193], v[200:201]
    v_pk_fma_f32 v[34:35], v[34:35], v[194:195], v[202:203]
    v_pk_fma_f32 v[36:37], v[36:37], v[196:197], v[204:205]
    v_pk_fma_f32 v[38:39], v[38:39], v[198:199], v[206:207]
    v_cvt_pk_bf16_f32 v32, v32, v33
    v_cvt_pk_bf16_f32 v33, v34, v35
    v_cvt_pk_bf16_f32 v34, v36, v37
    v_cvt_pk_bf16_f32 v35, v38, v39
    buffer_store_dwordx4 v[32:35], v20, s[40:43], s64 offen offset:0 sc1
    v_pk_fma_f32 v[48:49], v[48:49], v[192:193], v[200:201]
    v_pk_fma_f32 v[50:51], v[50:51], v[194:195], v[202:203]
    v_pk_fma_f32 v[52:53], v[52:53], v[196:197], v[204:205]
    v_pk_fma_f32 v[54:55], v[54:55], v[198:199], v[206:207]
    v_cvt_pk_bf16_f32 v48, v48, v49
    v_cvt_pk_bf16_f32 v49, v50, v51
    v_cvt_pk_bf16_f32 v50, v52, v53
    v_cvt_pk_bf16_f32 v51, v54, v55
    buffer_store_dwordx4 v[48:51], v20, s[40:43], s64 offen offset:1024 sc1
    v_pk_fma_f32 v[64:65], v[64:65], v[192:193], v[200:201]
    v_pk_fma_f32 v[66:67], v[66:67], v[194:195], v[202:203]
    v_pk_fma_f32 v[68:69], v[68:69], v[196:197], v[204:205]
    v_pk_fma_f32 v[70:71], v[70:71], v[198:199], v[206:207]
    v_cvt_pk_bf16_f32 v64, v64, v65
    v_cvt_pk_bf16_f32 v65, v66, v67
    v_cvt_pk_bf16_f32 v66, v68, v69
    v_cvt_pk_bf16_f32 v67, v70, v71
    buffer_store_dwordx4 v[64:67], v20, s[40:43], s64 offen offset:2048 sc1
    v_pk_fma_f32 v[80:81], v[80:81], v[192:193], v[200:201]
    v_pk_fma_f32 v[82:83], v[82:83], v[194:195], v[202:203]
    v_pk_fma_f32 v[84:85], v[84:85], v[196:197], v[204:205]
    v_pk_fma_f32 v[86:87], v[86:87], v[198:199], v[206:207]
    v_cvt_pk_bf16_f32 v80, v80, v81
    v_cvt_pk_bf16_f32 v81, v82, v83
    v_cvt_pk_bf16_f32 v82, v84, v85
    v_cvt_pk_bf16_f32 v83, v86, v87
    buffer_store_dwordx4 v[80:83], v20, s[40:43], s64 offen offset:3072 sc1
    v_pk_mul_f32 v[224:225], v[152:153], v[238:239] op_sel_hi:[1,0]
    v_pk_mul_f32 v[226:227], v[154:155], v[238:239] op_sel_hi:[1,0]
    v_pk_mul_f32 v[228:229], v[152:153], v[238:239] op_sel:[0,1]
    v_pk_mul_f32 v[230:231], v[154:155], v[238:239] op_sel:[0,1]
    v_pk_fma_f32 v[104:105], v[104:105], v[234:235], v[224:225] op_sel_hi:[1,0,1]
    v_pk_fma_f32 v[106:107], v[106:107], v[234:235], v[226:227] op_sel_hi:[1,0,1]
    v_pk_fma_f32 v[108:109], v[108:109], v[234:235], v[228:229] op_sel:[0,1,0]
    v_pk_fma_f32 v[110:111], v[110:111], v[234:235], v[230:231] op_sel:[0,1,0]
    v_pk_mul_f32 v[224:225], v[104:105], v[104:105]
    v_pk_mul_f32 v[226:227], v[106:107], v[106:107]
    v_pk_mul_f32 v[228:229], v[108:109], v[108:109]
    v_pk_mul_f32 v[230:231], v[110:111], v[110:111]
    v_pk_fma_f32 v[224:225], v[224:225], v[250:251], v[250:251] op_sel:[0,1,0] op_sel_hi:[1,1,0]
    v_pk_fma_f32 v[226:227], v[226:227], v[250:251], v[250:251] op_sel:[0,1,0] op_sel_hi:[1,1,0]
    v_pk_fma_f32 v[228:229], v[228:229], v[250:251], v[250:251] op_sel:[0,1,0] op_sel_hi:[1,1,0]
    v_pk_fma_f32 v[230:231], v[230:231], v[250:251], v[250:251] op_sel:[0,1,0] op_sel_hi:[1,1,0]
    v_pk_mul_f32 v[224:225], v[224:225], v[104:105]
    v_pk_mul_f32 v[226:227], v[226:227], v[106:107]
    s_add_u32 m0, s73, 30976
    s_nop 0
    buffer_load_dwordx4 v23, s[28:31], s72 offen offset:768  lds
    v_pk_mul_f32 v[228:229], v[228:229], v[108:109]
    v_pk_mul_f32 v[230:231], v[230:231], v[110:111]
    v_exp_f32 v224, v224
    v_exp_f32 v225, v225
    v_exp_f32 v226, v226
    v_exp_f32 v227, v227
    v_exp_f32 v228, v228
    v_exp_f32 v229, v229
    v_exp_f32 v230, v230
    v_exp_f32 v231, v231
    v_pk_add_f32 v[224:225], v[224:225], 1.0 op_sel_hi:[1,0]
    v_pk_add_f32 v[226:227], v[226:227], 1.0 op_sel_hi:[1,0]
    s_add_u32 m0, s73, 32000
    s_nop 0
    buffer_load_dwordx4 v31, s[28:31], s72 offen offset:768  lds
    v_pk_add_f32 v[228:229], v[228:229], 1.0 op_sel_hi:[1,0]
    v_pk_add_f32 v[230:231], v[230:231], 1.0 op_sel_hi:[1,0]
    v_rcp_f32 v224, v224
    v_rcp_f32 v225, v225
    v_rcp_f32 v226, v226
    v_rcp_f32 v227, v227
    v_rcp_f32 v228, v228
    v_rcp_f32 v229, v229
    v_rcp_f32 v230, v230
    v_rcp_f32 v231, v231
    v_pk_mul_f32 v[104:105], v[104:105], v[224:225]
    v_pk_mul_f32 v[106:107], v[106:107], v[226:227]
    ds_read_b64 a[160:161], v252 offset:1024
    ds_read_b64 a[162:163], v253 offset:1024
    ds_read_b64 a[164:165], v252 offset:3072
    ds_read_b64 a[166:167], v253 offset:3072
    ds_read_b64 a[168:169], v252 offset:5120
    ds_read_b64 a[170:171], v253 offset:5120
    ds_read_b64 a[172:173], v252 offset:7168
    ds_read_b64 a[174:175], v253 offset:7168
    v_pk_mul_f32 v[108:109], v[108:109], v[228:229]
    v_pk_mul_f32 v[110:111], v[110:111], v[230:231]
    v_cvt_pk_bf16_f32 v104, v104, v105
    v_cvt_pk_bf16_f32 v105, v106, v107
    v_cvt_pk_bf16_f32 v106, v108, v109
    v_cvt_pk_bf16_f32 v107, v110, v111
    buffer_store_dwordx4 v[104:107], v20, s[36:39], s70 offen offset:0 sc1
    ds_read_b64 a[176:177], v254 offset:1024
    ds_read_b64 a[178:179], v255 offset:1024
    ds_read_b64 a[180:181], v254 offset:3072
    ds_read_b64 a[182:183], v255 offset:3072
    ds_read_b64 a[184:185], v254 offset:5120
    ds_read_b64 a[186:187], v255 offset:5120
    ds_read_b64 a[188:189], v254 offset:7168
    ds_read_b64 a[190:191], v255 offset:7168
    ds_read_b64 a[192:193], v252 offset:9216
    ds_read_b64 a[194:195], v253 offset:9216
    ds_read_b64 a[196:197], v252 offset:11264
    ds_read_b64 a[198:199], v253 offset:11264
    ds_read_b64 a[200:201], v252 offset:13312
    ds_read_b64 a[202:203], v253 offset:13312
    ds_read_b64 a[204:205], v252 offset:15360
    ds_read_b64 a[206:207], v253 offset:15360
    ds_read_b64 a[208:209], v254 offset:9216
    ds_read_b64 a[210:211], v255 offset:9216
    ds_read_b64 a[212:213], v254 offset:11264
    ds_read_b64 a[214:215], v255 offset:11264
    ds_read_b64 a[216:217], v254 offset:13312
    ds_read_b64 a[218:219], v255 offset:13312
    ds_read_b64 a[220:221], v254 offset:15360
    ds_read_b64 a[222:223], v255 offset:15360
    s_waitcnt lgkmcnt(15)
    s_add_u32 m0, s73, 896
    s_nop 0
    buffer_load_dwordx4 v23, s[28:31], s83 offen offset:128  lds
    s_add_u32 m0, s73, 1920
    s_nop 0
    buffer_load_dwordx4 v31, s[28:31], s83 offen offset:128  lds
    s_add_u32 m0, s73, 2944
    s_nop 0
    buffer_load_dwordx4 v23, s[28:31], s27 offen offset:128  lds
    s_add_u32 m0, s73, 3968
    s_nop 0
    buffer_load_dwordx4 v31, s[28:31], s27 offen offset:128  lds
    s_add_u32 m0, s73, 4992
    s_nop 0
    buffer_load_dwordx4 v23, s[28:31], s58 offen offset:128  lds
    s_add_u32 m0, s73, 6016
    s_nop 0
    buffer_load_dwordx4 v31, s[28:31], s58 offen offset:128  lds
    s_add_u32 m0, s73, 7040
    s_nop 0
    buffer_load_dwordx4 v23, s[28:31], s72 offen offset:128  lds
    s_add_u32 m0, s73, 8064
    s_nop 0
    buffer_load_dwordx4 v31, s[28:31], s72 offen offset:128  lds
    s_waitcnt vmcnt(22)
    ds_read_b64 a[224:225], v252 offset:17408
    ds_read_b64 a[226:227], v253 offset:17408
    ds_read_b64 a[228:229], v252 offset:19456
    ds_read_b64 a[230:231], v253 offset:19456
    ds_read_b64 a[232:233], v252 offset:21504
    ds_read_b64 a[234:235], v253 offset:21504
    ds_read_b64 a[236:237], v252 offset:23552
    ds_read_b64 a[238:239], v253 offset:23552
    ds_read_b64 a[240:241], v254 offset:17408
    ds_read_b64 a[242:243], v255 offset:17408
    ds_read_b64 a[244:245], v254 offset:19456
    ds_read_b64 a[246:247], v255 offset:19456
    ds_read_b64 a[248:249], v254 offset:21504
    ds_read_b64 a[250:251], v255 offset:21504
    ds_read_b64 a[252:253], v254 offset:23552
    ds_read_b64 a[254:255], v255 offset:23552
    s_waitcnt lgkmcnt(15)
    s_add_u32 m0, s73, 8832
    s_nop 0
    buffer_load_dwordx4 v23, s[28:31], s83 offen offset:384  lds
    s_add_u32 m0, s73, 9856
    s_nop 0
    buffer_load_dwordx4 v31, s[28:31], s83 offen offset:384  lds
    s_add_u32 m0, s73, 10880
    s_nop 0
    buffer_load_dwordx4 v23, s[28:31], s27 offen offset:384  lds
    buffer_load_dwordx4 v[208:211], v134, s[32:35], s66 offen offset:1024 sc1
    buffer_load_dwordx4 v[212:215], v134, s[32:35], s67 offen offset:1024 sc1
    buffer_load_dwordx4 v[216:219], v134, s[32:35], s68 offen offset:1024 sc1
    buffer_load_dwordx4 v[220:223], v134, s[32:35], s69 offen offset:1024 sc1
    s_waitcnt vmcnt(0)
    s_mov_b64 exec, 1
    buffer_store_dword v247, v22, s[44:47], s56 offen sc1
    s_mov_b64 exec, -1
    v_xor_b32 v209, s49, v209
    v_xor_b32 v211, s49, v211
    v_xor_b32 v213, s49, v213
    v_xor_b32 v215, s49, v215
    v_xor_b32 v217, s49, v217
    v_xor_b32 v219, s49, v219
    v_xor_b32 v221, s49, v221
    v_xor_b32 v223, s49, v223
    v_or3_b32 v209, v209, v211, v213
    v_or3_b32 v215, v215, v217, v219
    v_or3_b32 v209, v209, v221, v223
    v_or_b32 v209, v209, v215
    v_cmp_ne_u32 vcc, 0, v209
    s_nop 3
    s_cbranch_vccnz L_F_B43_slow1
L_F_B43_slow1_go:
    v_add_f32 v208, v208, v212
    v_add_f32 v210, v210, v214
    v_add_f32 v216, v216, v220
    v_add_f32 v218, v218, v222
    v_add_f32 v208, v208, v216
    v_add_f32 v209, v210, v218
    v_mov_b32 v210, v208
    v_mov_b32 v211, v209
    s_nop 0
    v_permlane32_swap_b32 v208, v210
    v_permlane32_swap_b32 v209, v211
    v_add_f32 v208, v208, v210
    v_add_f32 v209, v209, v211
    v_mul_f32 v208, 0x3a924925, v208
    v_mul_f32 v209, 0x3a924925, v209
    v_fma_f32 v209, -v208, v208, v209
    v_max_f32 v209, 0, v209
    v_cvt_pk_bf16_f32 v209, v209, v209
    v_and_b32 v209, 0xffff0000, v209
    v_add_f32 v209, 0x3727c5ac, v209
    v_cvt_pk_bf16_f32 v209, v209, v209
    v_and_b32 v209, 0xffff0000, v209
    v_sqrt_f32 v209, v209
    v_cvt_pk_bf16_f32 v208, v208, v208
    v_and_b32 v208, 0xffff0000, v208
    v_cvt_pk_bf16_f32 v209, v209, v209
    v_and_b32 v209, 0xffff0000, v209
    v_rcp_f32 v209, v209
    s_nop 0
    v_mul_f32 v208, -v208, v209
    ds_write_b32 v132, v209 offset:6144
    ds_write_b32 v132, v208 offset:6400
    s_waitcnt lgkmcnt(0)
    ds_read_b128 v[192:195], v133 offset:6144
    ds_read_b128 v[200:203], v133 offset:6400
    ds_read_b128 v[196:199], v133 offset:6208
    ds_read_b128 v[204:207], v133 offset:6464
    s_waitcnt lgkmcnt(0)
    v_pk_fma_f32 v[40:41], v[40:41], v[192:193], v[200:201]
    v_pk_fma_f32 v[42:43], v[42:43], v[194:195], v[202:203]
    v_pk_fma_f32 v[44:45], v[44:45], v[196:197], v[204:205]
    v_pk_fma_f32 v[46:47], v[46:47], v[198:199], v[206:207]
    v_cvt_pk_bf16_f32 v40, v40, v41
    v_cvt_pk_bf16_f32 v41, v42, v43
    v_cvt_pk_bf16_f32 v42, v44, v45
    v_cvt_pk_bf16_f32 v43, v46, v47
    buffer_store_dwordx4 v[40:43], v20, s[40:43], s62 offen offset:0 sc1
    v_pk_fma_f32 v[56:57], v[56:57], v[192:193], v[200:201]
    v_pk_fma_f32 v[58:59], v[58:59], v[194:195], v[202:203]
    v_pk_fma_f32 v[60:61], v[60:61], v[196:197], v[204:205]
    v_pk_fma_f32 v[62:63], v[62:63], v[198:199], v[206:207]
    v_cvt_pk_bf16_f32 v56, v56, v57
    v_cvt_pk_bf16_f32 v57, v58, v59
    v_cvt_pk_bf16_f32 v58, v60, v61
    v_cvt_pk_bf16_f32 v59, v62, v63
    buffer_store_dwordx4 v[56:59], v20, s[40:43], s62 offen offset:1024 sc1
    v_pk_fma_f32 v[72:73], v[72:73], v[192:193], v[200:201]
    v_pk_fma_f32 v[74:75], v[74:75], v[194:195], v[202:203]
    v_pk_fma_f32 v[76:77], v[76:77], v[196:197], v[204:205]
    v_pk_fma_f32 v[78:79], v[78:79], v[198:199], v[206:207]
    v_cvt_pk_bf16_f32 v72, v72, v73
    v_cvt_pk_bf16_f32 v73, v74, v75
    v_cvt_pk_bf16_f32 v74, v76, v77
    v_cvt_pk_bf16_f32 v75, v78, v79
    buffer_store_dwordx4 v[72:75], v20, s[40:43], s62 offen offset:2048 sc1
    v_pk_fma_f32 v[88:89], v[88:89], v[192:193], v[200:201]
    v_pk_fma_f32 v[90:91], v[90:91], v[194:195], v[202:203]
    v_pk_fma_f32 v[92:93], v[92:93], v[196:197], v[204:205]
    v_pk_fma_f32 v[94:95], v[94:95], v[198:199], v[206:207]
    v_cvt_pk_bf16_f32 v88, v88, v89
    v_cvt_pk_bf16_f32 v89, v90, v91
    v_cvt_pk_bf16_f32 v90, v92, v93
    v_cvt_pk_bf16_f32 v91, v94, v95
    buffer_store_dwordx4 v[88:91], v20, s[40:43], s62 offen offset:3072 sc1
    s_add_u32 m0, s73, 11904
    s_nop 0
    buffer_load_dwordx4 v31, s[28:31], s27 offen offset:384  lds
    s_add_u32 m0, s73, 12928
    s_nop 0
    buffer_load_dwordx4 v23, s[28:31], s58 offen offset:384  lds
    s_add_u32 m0, s73, 13952
    s_nop 0
    buffer_load_dwordx4 v31, s[28:31], s58 offen offset:384  lds
    s_add_u32 m0, s73, 14976
    s_nop 0
    buffer_load_dwordx4 v23, s[28:31], s72 offen offset:384  lds
    s_add_u32 m0, s73, 16000
    s_nop 0
    buffer_load_dwordx4 v31, s[28:31], s72 offen offset:384  lds
    ds_read_b64 a[128:129], v252 offset:25600
    ds_read_b64 a[130:131], v253 offset:25600
    ds_read_b64 a[132:133], v252 offset:27648
    ds_read_b64 a[134:135], v253 offset:27648
    ds_read_b64 a[136:137], v252 offset:29696
    ds_read_b64 a[138:139], v253 offset:29696
    ds_read_b64 a[140:141], v252 offset:31744
    ds_read_b64 a[142:143], v253 offset:31744
    ds_read_b64 a[144:145], v254 offset:25600
    ds_read_b64 a[146:147], v255 offset:25600
    ds_read_b64 a[148:149], v254 offset:27648
    ds_read_b64 a[150:151], v255 offset:27648
    ds_read_b64 a[152:153], v254 offset:29696
    ds_read_b64 a[154:155], v255 offset:29696
    ds_read_b64 a[156:157], v254 offset:31744
    ds_read_b64 a[158:159], v255 offset:31744
    s_add_u32 m0, s73, 16768
    s_nop 0
    buffer_load_dwordx4 v23, s[28:31], s83 offen offset:640  lds
    s_add_u32 m0, s73, 17792
    s_nop 0
    buffer_load_dwordx4 v31, s[28:31], s83 offen offset:640  lds
    s_add_u32 m0, s73, 18816
    s_nop 0
    buffer_load_dwordx4 v23, s[28:31], s27 offen offset:640  lds
    s_add_u32 m0, s73, 19840
    s_nop 0
    buffer_load_dwordx4 v31, s[28:31], s27 offen offset:640  lds
    s_add_u32 m0, s73, 20864
    s_nop 0
    buffer_load_dwordx4 v23, s[28:31], s58 offen offset:640  lds
    s_waitcnt vmcnt(10)
    s_mov_b64 exec, 1
    buffer_store_dword v247, v22, s[44:47], s57 offen sc1
    s_mov_b64 exec, -1
    s_add_u32 m0, s73, 21888
    s_nop 0
    buffer_load_dwordx4 v31, s[28:31], s58 offen offset:640  lds
    s_add_u32 m0, s73, 22912
    s_nop 0
    buffer_load_dwordx4 v23, s[28:31], s72 offen offset:640  lds
    s_add_u32 m0, s73, 23936
    s_nop 0
    buffer_load_dwordx4 v31, s[28:31], s72 offen offset:640  lds
    s_waitcnt lgkmcnt(0)
    s_add_u32 m0, s73, 24704
    s_nop 0
    buffer_load_dwordx4 v23, s[28:31], s83 offen offset:896  lds
    s_add_u32 m0, s73, 25728
    s_nop 0
    buffer_load_dwordx4 v31, s[28:31], s83 offen offset:896  lds
    s_add_u32 m0, s73, 26752
    s_nop 0
    buffer_load_dwordx4 v23, s[28:31], s27 offen offset:896  lds
    s_add_u32 m0, s73, 27776
    s_nop 0
    buffer_load_dwordx4 v31, s[28:31], s27 offen offset:896  lds
    s_add_u32 s44, s24, 15466496
    s_addc_u32 s45, s25, 0
    s_mov_b32 s46, 196608
    s_mov_b32 s47, 0x20000
    s_lshl_b32 s100, s48, 13
    s_and_b32 s10, s2, 1
    s_lshl_b32 s10, s10, 10
    s_add_u32 s100, s100, s10
    s_mov_b32 s10, 0
    v_lshlrev_b32 v26, 11, v1
    v_lshl_add_u32 v26, v2, 6, v26
    buffer_load_dword v27, v26, s[44:47], s100 offen offset:0 sc1
    s_add_u32 m0, s73, 28800
    s_nop 0
    buffer_load_dwordx4 v23, s[28:31], s58 offen offset:896  lds
    s_add_u32 m0, s73, 29824
    s_nop 0
    buffer_load_dwordx4 v31, s[28:31], s58 offen offset:896  lds
    s_add_u32 m0, s73, 30848
    s_nop 0
    buffer_load_dwordx4 v23, s[28:31], s72 offen offset:896  lds
    s_add_u32 m0, s73, 31872
    s_nop 0
    buffer_load_dwordx4 v31, s[28:31], s72 offen offset:896  lds
    s_waitcnt vmcnt(4)
    v_cmp_ne_u32 vcc, s49, v27
    s_nop 3
    s_cbranch_vccnz L_F_ehB43
L_F_ehB43_go:
    v_add_u32 v6, 4096, v20
    s_bfe_u32 s75, s2, 0x20003
    s_and_b32 s11, s2, 1
    s_lshl_b32 s11, s11, 2
    s_add_u32 s75, s75, s11
    s_mul_i32 s75, s75, 7
    s_mul_i32 s11, s48, 896
    s_add_u32 s11, s11, s75
    s_lshl_b32 s11, s11, 10
    s_mov_b32 s32, s24
    s_mov_b32 s33, s25
    s_mov_b32 s34, 3670016
    s_mov_b32 s35, 0x20000
    s_add_u32 s75, s11, 0
    buffer_load_dwordx4 a[0:3], v20, s[32:35], s75 offen offset:0 sc1
    buffer_load_dwordx4 a[4:7], v20, s[32:35], s75 offen offset:1024 sc1
    buffer_load_dwordx4 a[8:11], v20, s[32:35], s75 offen offset:2048 sc1
    buffer_load_dwordx4 a[12:15], v20, s[32:35], s75 offen offset:3072 sc1
    buffer_load_dwordx4 a[16:19], v6, s[32:35], s75 offen offset:0 sc1
    buffer_load_dwordx4 a[20:23], v6, s[32:35], s75 offen offset:1024 sc1
    buffer_load_dwordx4 a[24:27], v6, s[32:35], s75 offen offset:2048 sc1
    s_add_u32 s75, s11, 57344
    buffer_load_dwordx4 a[28:31], v20, s[32:35], s75 offen offset:0 sc1
    buffer_load_dwordx4 a[32:35], v20, s[32:35], s75 offen offset:1024 sc1
    buffer_load_dwordx4 a[36:39], v20, s[32:35], s75 offen offset:2048 sc1
    buffer_load_dwordx4 a[40:43], v20, s[32:35], s75 offen offset:3072 sc1
    buffer_load_dwordx4 a[44:47], v6, s[32:35], s75 offen offset:0 sc1
    buffer_load_dwordx4 a[48:51], v6, s[32:35], s75 offen offset:1024 sc1
    buffer_load_dwordx4 a[52:55], v6, s[32:35], s75 offen offset:2048 sc1
    s_add_u32 s75, s11, 229376
    buffer_load_dwordx4 a[56:59], v20, s[32:35], s75 offen offset:0 sc1
    buffer_load_dwordx4 a[60:63], v20, s[32:35], s75 offen offset:1024 sc1
    buffer_load_dwordx4 a[64:67], v20, s[32:35], s75 offen offset:2048 sc1
    buffer_load_dwordx4 a[68:71], v20, s[32:35], s75 offen offset:3072 sc1
    buffer_load_dwordx4 a[72:75], v6, s[32:35], s75 offen offset:0 sc1
    buffer_load_dwordx4 a[76:79], v6, s[32:35], s75 offen offset:1024 sc1
    buffer_load_dwordx4 a[80:83], v6, s[32:35], s75 offen offset:2048 sc1
    s_lshl_b32 s59, s76, 3
    s_add_u32 s59, s59, s77
    s_lshl_b32 s59, s59, 5
    s_add_u32 s59, s59, 128
    s_lshl_b32 s60, s48, 2
    s_add_u32 s59, s59, s60
    s_add_u32 s59, s59, 65536
    s_branch L_F_p2A
L_F_B34:
    s_lshl_b32 s10, s48, 10
    s_mov_b32 s73, 47104
    s_add_u32 s74, s100, s3
    s_add_u32 s75, s100, s10
    s_add_u32 m0, s75, 18432
    s_nop 0
    buffer_load_dwordx4 v6, s[32:35], s83 offen offset:0 lds
    s_add_u32 m0, s75, 22464
    s_nop 0
    buffer_load_dwordx4 v6, s[32:35], s83 offen offset:64 lds
    s_add_u32 m0, s75, 26496
    s_nop 0
    buffer_load_dwordx4 v6, s[32:35], s83 offen offset:128 lds
    s_add_u32 s83, s83, 229376
    s_add_u32 m0, s75, 30720
    s_nop 0
    buffer_load_dwordx4 v6, s[32:35], s26 offen offset:0 lds
    s_add_u32 m0, s75, 34752
    s_nop 0
    buffer_load_dwordx4 v6, s[32:35], s26 offen offset:64 lds
    s_add_u32 s26, s26, 229376
    s_add_u32 m0, s74, 2048
    s_nop 0
    buffer_load_dwordx4 v4, s[28:31], s81 offen lds
    s_add_u32 m0, s74, 3072
    s_nop 0
    buffer_load_dwordx4 v5, s[28:31], s81 offen lds
    s_add_u32 s81, s81, 128
    s_add_u32 m0, s74, 4096
    s_nop 0
    buffer_load_dwordx4 v4, s[28:31], s82 offen lds
    s_add_u32 m0, s74, 5120
    s_nop 0
    buffer_load_dwordx4 v5, s[28:31], s82 offen lds
    s_add_u32 s82, s82, 128
    s_add_u32 s100, s100, 47104
    v_lshrrev_b32 v144, 1, v2
    v_xor_b32 v144, v144, v1
    v_lshlrev_b32 v144, 4, v144
    v_lshl_add_u32 v144, v2, 7, v144
    v_and_b32 v146, 1, v1
    v_lshlrev_b32 v146, 1, v146
    v_bfe_u32 v145, v0, 1, 1
    v_xor_b32 v146, v146, v145
    v_lshlrev_b32 v146, 4, v146
    v_bfe_u32 v145, v0, 2, 2
    v_lshl_add_u32 v145, v1, 3, v145
    v_lshl_add_u32 v146, v145, 6, v146
    v_and_b32 v145, 1, v0
    v_lshl_add_u32 v146, v145, 3, v146
    v_mov_b32 v22, 0
    v_and_b32 v148, 7, v0
    v_xor_b32 v148, v148, v1
    v_lshlrev_b32 v148, 4, v148
    v_lshrrev_b32 v149, 3, v0
    v_lshl_add_u32 v23, v149, 12, v148
    v_xor_b32 v31, 64, v23
    v_add_u32 v31, 0x8000, v31
    s_lshl_b32 s60, s79, 6
    v_xor_b32 v144, s60, v144
    s_lshl_b32 s60, s79, 12
    s_add_u32 s60, s60, 2048
    v_add_u32 v8, s60, v144
    s_lshl_b32 s62, s80, 13
    v_add_u32 v9, s62, v8
    v_xor_b32 v14, 64, v8
    v_xor_b32 v15, 64, v9
    s_lshl_b32 s61, s80, 12
    s_lshl_b32 s60, s79, 11
    s_add_u32 s60, s60, 18432
    s_add_u32 s63, s60, s62
    s_add_u32 s65, s60, s61
    s_lshl_b32 s64, s80, 5
    v_xor_b32 v145, s64, v146
    v_add_u32 v10, s65, v145
    v_xor_b32 v145, 32, v145
    v_add_u32 v11, s63, v145
    v_add_u32 v12, s65, v146
    v_xor_b32 v13, 32, v12
    s_lshl_b32 s60, s79, 12
    s_sub_u32 s60, 2048, s60
    v_add_u32 v16, s60, v10
    v_add_u32 v17, s60, v11
    v_add_u32 v29, s60, v12
    v_add_u32 v30, s60, v13
    s_add_u32 s74, s100, s3
    s_add_u32 s75, s100, s10
    s_add_u32 m0, s75, 18432
    s_nop 0
    buffer_load_dwordx4 v6, s[32:35], s83 offen offset:0 lds
    s_add_u32 m0, s75, 22464
    s_nop 0
    buffer_load_dwordx4 v6, s[32:35], s83 offen offset:64 lds
    s_add_u32 m0, s75, 26496
    s_nop 0
    buffer_load_dwordx4 v6, s[32:35], s83 offen offset:128 lds
    s_add_u32 s83, s83, 229376
    s_add_u32 m0, s75, 30720
    s_nop 0
    buffer_load_dwordx4 v6, s[32:35], s26 offen offset:0 lds
    s_add_u32 m0, s75, 34752
    s_nop 0
    buffer_load_dwordx4 v6, s[32:35], s26 offen offset:64 lds
    s_add_u32 s26, s26, 229376
    s_add_u32 m0, s74, 2048
    s_nop 0
    buffer_load_dwordx4 v4, s[28:31], s81 offen lds
    s_add_u32 m0, s74, 3072
    s_nop 0
    buffer_load_dwordx4 v5, s[28:31], s81 offen lds
    s_add_u32 s81, s81, 128
    s_add_u32 m0, s74, 4096
    s_nop 0
    buffer_load_dwordx4 v4, s[28:31], s82 offen lds
    s_add_u32 m0, s74, 5120
    s_nop 0
    buffer_load_dwordx4 v5, s[28:31], s82 offen lds
    s_add_u32 s82, s82, 128
    s_add_u32 s100, s100, 47104
    v_mov_b32 v24, 0x3f803f80
    v_mov_b32 v25, 0x3f803f80
    v_mov_b32 v26, 0x3f803f80
    v_mov_b32 v27, 0x3f803f80
    v_mov_b32 v32, 0
    v_mov_b32 v33, 0
    v_mov_b32 v34, 0
    v_mov_b32 v35, 0
    v_mov_b32 v36, 0
    v_mov_b32 v37, 0
    v_mov_b32 v38, 0
    v_mov_b32 v39, 0
    v_mov_b32 v40, 0
    v_mov_b32 v41, 0
    v_mov_b32 v42, 0
    v_mov_b32 v43, 0
    v_mov_b32 v44, 0
    v_mov_b32 v45, 0
    v_mov_b32 v46, 0
    v_mov_b32 v47, 0
    v_mov_b32 v48, 0
    v_mov_b32 v49, 0
    v_mov_b32 v50, 0
    v_mov_b32 v51, 0
    v_mov_b32 v52, 0
    v_mov_b32 v53, 0
    v_mov_b32 v54, 0
    v_mov_b32 v55, 0
    v_mov_b32 v56, 0
    v_mov_b32 v57, 0
    v_mov_b32 v58, 0
    v_mov_b32 v59, 0
    v_mov_b32 v60, 0
    v_mov_b32 v61, 0
    v_mov_b32 v62, 0
    v_mov_b32 v63, 0
    v_mov_b32 v64, 0
    v_mov_b32 v65, 0
    v_mov_b32 v66, 0
    v_mov_b32 v67, 0
    v_mov_b32 v68, 0
    v_mov_b32 v69, 0
    v_mov_b32 v70, 0
    v_mov_b32 v71, 0
    v_mov_b32 v72, 0
    v_mov_b32 v73, 0
    v_mov_b32 v74, 0
    v_mov_b32 v75, 0
    v_mov_b32 v76, 0
    v_mov_b32 v77, 0
    v_mov_b32 v78, 0
    v_mov_b32 v79, 0
    v_mov_b32 v80, 0
    v_mov_b32 v81, 0
    v_mov_b32 v82, 0
    v_mov_b32 v83, 0
    v_mov_b32 v84, 0
    v_mov_b32 v85, 0
    v_mov_b32 v86, 0
    v_mov_b32 v87, 0
    v_mov_b32 v88, 0
    v_mov_b32 v89, 0
    v_mov_b32 v90, 0
    v_mov_b32 v91, 0
    v_mov_b32 v92, 0
    v_mov_b32 v93, 0
    v_mov_b32 v94, 0
    v_mov_b32 v95, 0
    v_mov_b32 v96, 0
    v_mov_b32 v97, 0
    v_mov_b32 v98, 0
    v_mov_b32 v99, 0
    v_mov_b32 v100, 0
    v_mov_b32 v101, 0
    v_mov_b32 v102, 0
    v_mov_b32 v103, 0
    v_mov_b32 v104, 0
    v_mov_b32 v105, 0
    v_mov_b32 v106, 0
    v_mov_b32 v107, 0
    v_mov_b32 v108, 0
    v_mov_b32 v109, 0
    v_mov_b32 v110, 0
    v_mov_b32 v111, 0
    v_accvgpr_write_b32 a112, 0
    v_accvgpr_write_b32 a113, 0
    v_accvgpr_write_b32 a114, 0
    v_accvgpr_write_b32 a115, 0
    v_accvgpr_write_b32 a116, 0
    v_accvgpr_write_b32 a117, 0
    v_accvgpr_write_b32 a118, 0
    v_accvgpr_write_b32 a119, 0
    v_accvgpr_write_b32 a120, 0
    v_accvgpr_write_b32 a121, 0
    v_accvgpr_write_b32 a122, 0
    v_accvgpr_write_b32 a123, 0
    v_accvgpr_write_b32 a124, 0
    v_accvgpr_write_b32 a125, 0
    v_accvgpr_write_b32 a126, 0
    v_accvgpr_write_b32 a127, 0
    v_accvgpr_write_b32 a128, 0
    v_accvgpr_write_b32 a129, 0
    v_accvgpr_write_b32 a130, 0
    v_accvgpr_write_b32 a131, 0
    v_accvgpr_write_b32 a132, 0
    v_accvgpr_write_b32 a133, 0
    v_accvgpr_write_b32 a134, 0
    v_accvgpr_write_b32 a135, 0
    v_accvgpr_write_b32 a136, 0
    v_accvgpr_write_b32 a137, 0
    v_accvgpr_write_b32 a138, 0
    v_accvgpr_write_b32 a139, 0
    v_accvgpr_write_b32 a140, 0
    v_accvgpr_write_b32 a141, 0
    v_accvgpr_write_b32 a142, 0
    v_accvgpr_write_b32 a143, 0
    v_accvgpr_write_b32 a144, 0
    v_accvgpr_write_b32 a145, 0
    v_accvgpr_write_b32 a146, 0
    v_accvgpr_write_b32 a147, 0
    s_add_u32 s74, s100, s3
    s_add_u32 s75, s100, s10
    s_add_u32 m0, s75, 18432
    s_nop 0
    buffer_load_dwordx4 v6, s[32:35], s83 offen offset:0 lds
    s_add_u32 m0, s75, 22464
    s_nop 0
    buffer_load_dwordx4 v6, s[32:35], s83 offen offset:64 lds
    s_add_u32 m0, s75, 26496
    s_nop 0
    buffer_load_dwordx4 v6, s[32:35], s83 offen offset:128 lds
    s_add_u32 s83, s83, 229376
    s_add_u32 m0, s75, 30720
    s_nop 0
    buffer_load_dwordx4 v6, s[32:35], s26 offen offset:0 lds
    s_add_u32 m0, s75, 34752
    s_nop 0
    buffer_load_dwordx4 v6, s[32:35], s26 offen offset:64 lds
    s_add_u32 s26, s26, 229376
    s_mov_b32 s100, 0
    s_lshr_b32 s60, s2, 3
    s_lshl_b32 s61, s60, 2
    s_add_u32 s66, s61, s48
    v_lshlrev_b32 v18, 10, v0
    s_and_b32 s61, s66, 15
    s_lshl_b32 s61, s61, 13
    s_lshl_b32 s58, s76, 17
    s_add_u32 s58, s58, s61
    s_add_u32 s58, s58, 384
    v_mul_u32_u24 v145, 86, v0
    v_lshrrev_b32 v145, 8, v145
    v_mul_u32_u24 v146, 3, v145
    v_sub_u32 v146, v0, v146
    v_and_b32 v147, 1, v145
    v_mul_u32_u24 v147, 3584, v147
    s_and_b32 s61, s76, 7
    s_lshl_b32 s61, s61, 3
    s_mul_i32 s62, s48, -14
    s_add_u32 s61, s61, s62
    s_mul_i32 s61, s61, 3584
    v_lshlrev_b32 v146, 7, v146
    v_min_u32 v146, 192, v146
    v_add_u32 v147, v147, v146
    s_add_u32 s62, s61, s83
    s_add_u32 s63, s61, s26
    s_sub_u32 s63, s63, 320
    v_mov_b32 v146, s63
    v_mov_b32 v148, s62
    v_cmp_gt_u32 vcc, 6, v0
    s_nop 1
    v_cndmask_b32 v146, v146, v148, vcc
    v_add_u32 v19, v147, v146
    s_mov_b32 s72, 0
    s_mov_b64 exec, 0xff
    buffer_load_dword v28, v18, s[28:31], s58 offen
    s_mov_b64 exec, -1
    s_add_u32 s58, s58, 128
    s_mov_b64 exec, 4095
    buffer_load_dword v28, v19, s[32:35], s72 offen
    s_mov_b64 exec, -1
    s_add_u32 s72, s72, 229376
    s_mov_b64 exec, 0xff
    buffer_load_dword v28, v18, s[28:31], s58 offen
    s_mov_b64 exec, -1
    s_add_u32 s58, s58, 128
    s_mov_b64 exec, 4095
    buffer_load_dword v28, v19, s[32:35], s72 offen
    s_mov_b64 exec, -1
    s_add_u32 s72, s72, 229376
    s_mov_b32 s40, s14
    s_mov_b32 s41, s15
    s_mov_b32 s42, 8388608
    s_mov_b32 s43, 0x20000
    v_lshrrev_b32 v3, 2, v0
    v_and_b32 v145, 3, v0
    v_lshlrev_b32 v145, 10, v145
    v_lshl_add_u32 v3, v3, 12, v145
    s_bfe_u32 s59, s2, 0x20001
    s_lshl_b32 s59, s59, 21
    s_lshr_b32 s60, s2, 5
    s_lshl_b32 s60, s60, 1
    s_bfe_u32 s61, s2, 0x10003
    s_add_u32 s60, s60, s61
    s_lshl_b32 s60, s60, 2
    s_add_u32 s66, s60, s48
    s_lshl_b32 s66, s66, 15
    s_add_u32 s59, s59, s66
    s_mul_i32 s71, s48, 33792
    v_lshlrev_b32 v147, 2, v2
    v_add_u32 v147, 135168, v147
    v_lshlrev_b32 v151, 4, v1
    v_add_u32 v151, 135168, v151
    s_lshl_b32 s60, s80, 8
    s_lshl_b32 s63, s79, 7
    s_add_u32 s60, s60, s63
    s_add_u32 s60, s60, 64
    s_mul_i32 s61, s80, 192
    s_mul_i32 s64, s80, 128
    s_lshl_b32 s65, s79, 10
    s_add_u32 s62, s61, s65
    s_add_u32 s65, s64, s65
    v_add_u32 v148, s60, v147
    v_add_u32 v149, s62, v147
    v_add_u32 v150, s65, v147
    s_sub_u32 s59, s60, 64
    s_add_u32 s60, s63, 64
    v_add_u32 v240, s60, v151
    v_add_u32 v242, s60, v147
    v_add_u32 v244, s61, v147
    v_add_u32 v245, s64, v151
    v_xor_b32 v3, v2, v1
    v_lshrrev_b32 v3, 1, v3
    v_lshlrev_b32 v3, 4, v3
    v_lshl_add_u32 v3, v2, 7, v3
    v_and_b32 v7, 1, v1
    v_lshl_add_u32 v3, v7, 3, v3
    v_add_u32 v252, s71, v3
    v_xor_b32 v253, 32, v252
    v_xor_b32 v254, 64, v252
    v_xor_b32 v255, 96, v252
    s_lshl_b32 s56, s76, 2
    s_add_u32 s56, s56, s77
    s_lshl_b32 s56, s56, 3
    s_add_u32 s56, s56, s48
    s_lshl_b32 s56, s56, 6
    s_add_u32 s56, s56, 256
    s_lshl_b32 s57, s76, 2
    s_add_u32 s57, s57, s77
    s_lshl_b32 s57, s57, 3
    s_add_u32 s57, s57, s48
    s_lshl_b32 s57, s57, 2
    s_add_u32 s57, s57, 32784
    v_mov_b32 v250, 0xc0135761
    v_mov_b32 v251, 0xbdd2d3e8
    v_bfe_u32 v224, v2, 2, 1
    v_lshlrev_b32 v224, 8, v224
    v_lshrrev_b32 v225, 3, v2
    v_lshl_add_u32 v224, v225, 6, v224
    v_add_u32 v224, v224, v151
    s_lshl_b32 s66, s80, 9
    s_add_u32 s66, s66, s63
    v_add_u32 v241, s66, v224
    s_lshl_b32 s66, s48, 6
    v_add_u32 v243, s66, v147
    s_lshl_b32 s66, s48, 9
    v_add_u32 v133, s66, v151
    s_add_u32 s66, s66, 135168
    v_and_b32 v224, 31, v0
    v_lshl_add_u32 v132, v224, 2, s66
    v_lshrrev_b32 v134, 5, v0
    v_lshlrev_b32 v134, 11, v134
    v_lshl_add_u32 v134, v224, 4, v134
    s_mov_b32 s40, s24
    s_mov_b32 s41, s25
    s_mov_b32 s42, 3670016
    s_mov_b32 s43, 0x20000
    s_add_u32 s36, s24, 10485760
    s_addc_u32 s37, s25, 0
    s_mov_b32 s38, 3670016
    s_mov_b32 s39, 0x20000
    s_lshl_b32 s68, s76, 14
    s_lshl_b32 s66, s79, 9
    s_add_u32 s66, s66, s68
    s_lshl_b32 s63, s77, 12
    s_add_u32 s63, s63, 2048
    s_add_u32 s63, s63, s68
    s_lshl_b32 s67, s48, 8
    s_add_u32 s63, s63, s67
    s_add_u32 s67, s66, 4096
    s_add_u32 s68, s66, 8192
    s_add_u32 s69, s66, 12288
    s_lshl_b32 s60, s76, 2
    s_add_u32 s60, s60, s79
    s_mul_i32 s60, s60, 56
    s_mul_i32 s62, s77, 14
    s_add_u32 s60, s60, s62
    s_lshl_b32 s60, s60, 10
    s_lshl_b32 s61, s61, 4
    s_lshl_b32 s64, s64, 4
    s_add_u32 s65, s60, s64
    s_add_u32 s65, s65, 10240
    s_add_u32 s70, s65, 114688
    s_add_u32 s64, s60, s61
    s_add_u32 s64, s64, 8192
    s_add_u32 s62, s64, 114688
    s_mov_b32 s11, 0
    s_waitcnt vmcnt(18)
    s_barrier
    ds_read_b128 a[0:3], v8 offset:0
    ds_read_b128 a[4:7], v8 offset:2048
    ds_read_b128 a[8:11], v8 offset:8192
    ds_read_b128 a[12:15], v8 offset:10240
    ds_read_b64_tr_b16 a[16:17], v10 offset:0
    ds_read_b64_tr_b16 a[18:19], v10 offset:256
    ds_read_b64_tr_b16 a[20:21], v11 offset:0
    ds_read_b64_tr_b16 a[22:23], v11 offset:256
    ds_read_b64_tr_b16 a[24:25], v10 offset:4096
    ds_read_b64_tr_b16 a[26:27], v10 offset:4352
    ds_read_b64_tr_b16 a[28:29], v12 offset:12288
    ds_read_b64_tr_b16 a[30:31], v12 offset:12544
    ds_read_b64_tr_b16 a[32:33], v13 offset:12288
    ds_read_b64_tr_b16 a[34:35], v13 offset:12544
    ds_read_b128 a[40:43], v9 offset:0
    ds_read_b128 a[44:47], v9 offset:2048
    s_waitcnt lgkmcnt(0)
    .p2align 6
L_F_B34_loop:
    s_add_u32 m0, s74, 2048
    v_mfma_f32_16x16x32_bf16 v[32:35], a[0:3], a[16:19], v[32:35]
    buffer_load_dwordx4 v4, s[28:31], s81 offen lds
    ds_read_b128 a[56:59], v14 offset:0
    v_mfma_f32_16x16x32_bf16 v[36:39], a[4:7], a[16:19], v[36:39]
    ds_read_b128 a[60:63], v14 offset:2048
    v_mfma_f32_16x16x32_bf16 v[40:43], a[8:11], a[16:19], v[40:43]
    ds_read_b128 a[64:67], v14 offset:8192
    v_mfma_f32_16x16x32_bf16 v[44:47], a[12:15], a[16:19], v[44:47]
    ds_read_b128 a[68:71], v14 offset:10240
    v_mfma_f32_16x16x32_bf16 v[48:51], a[0:3], a[20:23], v[48:51]
    ds_read_b64_tr_b16 a[72:73], v16 offset:0
    v_mfma_f32_16x16x32_bf16 v[52:55], a[4:7], a[20:23], v[52:55]
    ds_read_b64_tr_b16 a[74:75], v16 offset:256
    v_mfma_f32_16x16x32_bf16 v[56:59], a[8:11], a[20:23], v[56:59]
    ds_read_b64_tr_b16 a[76:77], v17 offset:0
    s_add_u32 m0, s74, 3072
    v_mfma_f32_16x16x32_bf16 v[60:63], a[12:15], a[20:23], v[60:63]
    buffer_load_dwordx4 v5, s[28:31], s81 offen lds
    s_add_u32 s81, s81, 128
    ds_read_b64_tr_b16 a[78:79], v17 offset:256
    v_mfma_f32_16x16x32_bf16 v[64:67], a[0:3], a[24:27], v[64:67]
    ds_read_b64_tr_b16 a[80:81], v16 offset:4096
    v_mfma_f32_16x16x32_bf16 v[68:71], a[4:7], a[24:27], v[68:71]
    ds_read_b64_tr_b16 a[82:83], v16 offset:4352
    v_mfma_f32_16x16x32_bf16 v[72:75], a[8:11], a[24:27], v[72:75]
    ds_read_b64_tr_b16 a[84:85], v29 offset:12288
    v_mfma_f32_16x16x32_bf16 v[76:79], a[12:15], a[24:27], v[76:79]
    ds_read_b64_tr_b16 a[86:87], v29 offset:12544
    v_mfma_f32_16x16x32_bf16 v[80:83], a[28:31], a[0:3], v[80:83]
    ds_read_b64_tr_b16 a[88:89], v30 offset:12288
    v_mfma_f32_16x16x32_bf16 v[84:87], a[28:31], a[4:7], v[84:87]
    ds_read_b64_tr_b16 a[90:91], v30 offset:12544
    s_add_u32 m0, s74, 4096
    v_mfma_f32_16x16x32_bf16 v[88:91], a[28:31], a[8:11], v[88:91]
    buffer_load_dwordx4 v4, s[28:31], s82 offen lds
    ds_read_b128 a[96:99], v15 offset:0
    v_mfma_f32_16x16x32_bf16 v[92:95], a[28:31], a[12:15], v[92:95]
    ds_read_b128 a[100:103], v15 offset:2048
    v_mfma_f32_16x16x32_bf16 v[96:99], a[32:35], a[0:3], v[96:99]
    s_cmp_eq_u32 s100, 94208
    s_cselect_b32 s101, -94208, s73
    v_mfma_f32_16x16x32_bf16 v[100:103], a[32:35], a[4:7], v[100:103]
    v_add_u32 v8, s101, v8
    v_mfma_f32_16x16x32_bf16 v[104:107], a[32:35], a[8:11], v[104:107]
    v_add_u32 v9, s101, v9
    v_mfma_f32_16x16x32_bf16 v[108:111], a[32:35], a[12:15], v[108:111]
    v_add_u32 v10, s101, v10
    v_mfma_f32_16x16x32_bf16 a[128:131], v[24:27], a[16:19], a[128:131]
    v_add_u32 v11, s101, v11
    s_add_u32 m0, s74, 5120
    v_mfma_f32_16x16x32_bf16 a[132:135], v[24:27], a[20:23], a[132:135]
    buffer_load_dwordx4 v5, s[28:31], s82 offen lds
    s_add_u32 s82, s82, 128
    v_add_u32 v12, s101, v12
    v_mfma_f32_16x16x32_bf16 a[136:139], v[24:27], a[24:27], a[136:139]
    v_add_u32 v13, s101, v13
    v_mfma_f32_16x16x32_bf16 a[140:143], v[24:27], a[28:31], a[140:143]
    v_mfma_f32_16x16x32_bf16 a[144:147], v[24:27], a[32:35], a[144:147]
    v_mfma_f32_16x16x32_bf16 a[112:115], a[40:43], a[40:43], a[112:115]
    v_mfma_f32_16x16x32_bf16 a[116:119], v[24:27], a[40:43], a[116:119]
    v_mfma_f32_16x16x32_bf16 a[120:123], a[44:47], a[44:47], a[120:123]
    v_mfma_f32_16x16x32_bf16 a[124:127], v[24:27], a[44:47], a[124:127]
    s_cmp_eq_u32 s11, 5
    s_waitcnt lgkmcnt(0)
    s_waitcnt vmcnt(11)
    s_barrier
    s_cbranch_scc1 L_F_B34_five
    s_add_u32 s74, s100, s3
    s_add_u32 s75, s100, s10
    s_add_u32 m0, s75, 18432
    v_mfma_f32_16x16x32_bf16 v[32:35], a[56:59], a[72:75], v[32:35]
    buffer_load_dwordx4 v6, s[32:35], s83 offen offset:0 lds
    ds_read_b128 a[0:3], v8 offset:0
    v_mfma_f32_16x16x32_bf16 v[36:39], a[60:63], a[72:75], v[36:39]
    ds_read_b128 a[4:7], v8 offset:2048
    v_mfma_f32_16x16x32_bf16 v[40:43], a[64:67], a[72:75], v[40:43]
    ds_read_b128 a[8:11], v8 offset:8192
    s_add_u32 m0, s75, 22464
    v_mfma_f32_16x16x32_bf16 v[44:47], a[68:71], a[72:75], v[44:47]
    buffer_load_dwordx4 v6, s[32:35], s83 offen offset:64 lds
    ds_read_b128 a[12:15], v8 offset:10240
    v_mfma_f32_16x16x32_bf16 v[48:51], a[56:59], a[76:79], v[48:51]
    ds_read_b64_tr_b16 a[16:17], v10 offset:0
    v_mfma_f32_16x16x32_bf16 v[52:55], a[60:63], a[76:79], v[52:55]
    ds_read_b64_tr_b16 a[18:19], v10 offset:256
    s_add_u32 m0, s75, 26496
    v_mfma_f32_16x16x32_bf16 v[56:59], a[64:67], a[76:79], v[56:59]
    buffer_load_dwordx4 v6, s[32:35], s83 offen offset:128 lds
    s_add_u32 s83, s83, 229376
    ds_read_b64_tr_b16 a[20:21], v11 offset:0
    v_mfma_f32_16x16x32_bf16 v[60:63], a[68:71], a[76:79], v[60:63]
    ds_read_b64_tr_b16 a[22:23], v11 offset:256
    v_mfma_f32_16x16x32_bf16 v[64:67], a[56:59], a[80:83], v[64:67]
    ds_read_b64_tr_b16 a[24:25], v10 offset:4096
    s_add_u32 m0, s75, 30720
    v_mfma_f32_16x16x32_bf16 v[68:71], a[60:63], a[80:83], v[68:71]
    buffer_load_dwordx4 v6, s[32:35], s26 offen offset:0 lds
    ds_read_b64_tr_b16 a[26:27], v10 offset:4352
    v_mfma_f32_16x16x32_bf16 v[72:75], a[64:67], a[80:83], v[72:75]
    ds_read_b64_tr_b16 a[28:29], v12 offset:12288
    v_mfma_f32_16x16x32_bf16 v[76:79], a[68:71], a[80:83], v[76:79]
    ds_read_b64_tr_b16 a[30:31], v12 offset:12544
    v_mfma_f32_16x16x32_bf16 v[80:83], a[84:87], a[56:59], v[80:83]
    ds_read_b64_tr_b16 a[32:33], v13 offset:12288
    s_add_u32 m0, s75, 34752
    v_mfma_f32_16x16x32_bf16 v[84:87], a[84:87], a[60:63], v[84:87]
    buffer_load_dwordx4 v6, s[32:35], s26 offen offset:64 lds
    s_add_u32 s26, s26, 229376
    ds_read_b64_tr_b16 a[34:35], v13 offset:12544
    v_mfma_f32_16x16x32_bf16 v[88:91], a[84:87], a[64:67], v[88:91]
    ds_read_b128 a[40:43], v9 offset:0
    v_mfma_f32_16x16x32_bf16 v[92:95], a[84:87], a[68:71], v[92:95]
    ds_read_b128 a[44:47], v9 offset:2048
    v_mfma_f32_16x16x32_bf16 v[96:99], a[88:91], a[56:59], v[96:99]
    s_mov_b64 exec, 0xff
    buffer_load_dword v28, v18, s[28:31], s58 offen
    s_mov_b64 exec, -1
    s_add_u32 s58, s58, 128
    v_add_u32 v14, s101, v14
    v_mfma_f32_16x16x32_bf16 v[100:103], a[88:91], a[60:63], v[100:103]
    v_add_u32 v15, s101, v15
    v_mfma_f32_16x16x32_bf16 v[104:107], a[88:91], a[64:67], v[104:107]
    v_add_u32 v16, s101, v16
    v_mfma_f32_16x16x32_bf16 v[108:111], a[88:91], a[68:71], v[108:111]
    s_mov_b64 exec, 4095
    buffer_load_dword v28, v19, s[32:35], s72 offen
    s_mov_b64 exec, -1
    s_add_u32 s72, s72, 229376
    v_add_u32 v17, s101, v17
    v_mfma_f32_16x16x32_bf16 a[112:115], a[96:99], a[96:99], a[112:115]
    v_add_u32 v29, s101, v29
    v_mfma_f32_16x16x32_bf16 a[116:119], v[24:27], a[96:99], a[116:119]
    v_add_u32 v30, s101, v30
    v_mfma_f32_16x16x32_bf16 a[120:123], a[100:103], a[100:103], a[120:123]
    v_mfma_f32_16x16x32_bf16 a[124:127], v[24:27], a[100:103], a[124:127]
    s_add_u32 s100, s100, s101
    s_add_u32 s11, s11, 1
    s_cmp_lt_u32 s11, 8
    s_waitcnt lgkmcnt(0)
    s_branch L_F_B34_loop
L_F_B34_five:
    global_load_dword v21, v22, s[22:23] sc1
    s_and_b32 s71, s76, 3
    s_lshl_b32 s71, s71, 2
    s_and_b32 s81, s77, 1
    s_lshl_b32 s81, s81, 1
    v_mfma_f32_16x16x32_bf16 v[32:35], a[56:59], a[72:75], v[32:35]
    ds_read_b128 a[0:3], v8 offset:0
    s_add_u32 s71, s71, s81
    s_add_u32 s71, s71, 1
    s_lshr_b32 s81, s76, 2
    s_mul_i32 s82, s81, 7
    s_add_u32 s82, s82, 12
    v_mfma_f32_16x16x32_bf16 v[36:39], a[60:63], a[72:75], v[36:39]
    ds_read_b128 a[4:7], v8 offset:2048
    s_lshl_b32 s81, s81, 2
    s_cmp_lt_u32 s71, 4
    s_cselect_b32 s81, s81, s82
    s_add_u32 s81, s81, s71
    s_cmp_gt_u32 s71, 10
    v_mfma_f32_16x16x32_bf16 v[40:43], a[64:67], a[72:75], v[40:43]
    ds_read_b128 a[8:11], v8 offset:8192
    s_cselect_b32 s81, 64, s81
    s_lshr_b32 s71, s77, 1
    s_lshl_b32 s71, s71, 2
    s_add_u32 s71, s71, s48
    v_mfma_f32_16x16x32_bf16 v[44:47], a[68:71], a[72:75], v[44:47]
    ds_read_b128 a[12:15], v8 offset:10240
    s_lshl_b32 s26, s81, 3
    s_add_u32 s26, s26, s71
    s_lshl_b32 s26, s26, 12
    s_lshl_b32 s71, s71, 7
    s_sub_u32 s82, s81, 16
    v_mfma_f32_16x16x32_bf16 v[48:51], a[56:59], a[76:79], v[48:51]
    ds_read_b64_tr_b16 a[16:17], v10 offset:0
    s_cmp_lt_u32 s81, 16
    s_cselect_b32 s32, s8, s18
    s_cselect_b32 s33, s9, s19
    s_cselect_b32 s81, s81, s82
    s_mov_b32 s34, 917504
    v_mfma_f32_16x16x32_bf16 v[52:55], a[60:63], a[76:79], v[52:55]
    ds_read_b64_tr_b16 a[18:19], v10 offset:256
    s_cselect_b32 s34, 524288, s34
    s_mov_b32 s35, 0x20000
    s_lshl_b32 s81, s81, 15
    s_add_u32 s81, s81, s71
    s_add_u32 s82, s81, 16384
    v_mfma_f32_16x16x32_bf16 v[56:59], a[64:67], a[76:79], v[56:59]
    ds_read_b64_tr_b16 a[20:21], v11 offset:0
    s_lshl_b32 s71, s48, 12
    s_add_u32 s10, s71, 143360
    v_and_b32 v141, 1, v1
    v_lshlrev_b32 v141, 1, v141
    v_mfma_f32_16x16x32_bf16 v[60:63], a[68:71], a[76:79], v[60:63]
    ds_read_b64_tr_b16 a[22:23], v11 offset:256
    v_and_b32 v140, 3, v0
    v_xor_b32 v140, v140, v141
    v_lshlrev_b32 v140, 4, v140
    v_lshrrev_b32 v142, 2, v0
    v_lshl_add_u32 v140, v142, 10, v140
    v_mfma_f32_16x16x32_bf16 v[64:67], a[56:59], a[80:83], v[64:67]
    ds_read_b64_tr_b16 a[24:25], v10 offset:4096
    v_bfe_u32 v143, v0, 1, 1
    v_xor_b32 v141, v141, v143
    v_lshlrev_b32 v141, 4, v141
    v_lshl_add_u32 v141, v142, 6, v141
    v_and_b32 v143, 1, v0
    v_mfma_f32_16x16x32_bf16 v[68:71], a[60:63], a[80:83], v[68:71]
    ds_read_b64_tr_b16 a[26:27], v10 offset:4352
    v_lshl_add_u32 v141, v143, 3, v141
    v_add_u32 v141, s10, v141
    v_xor_b32 v142, 32, v141
    s_and_b32 s52, s2, 7
    v_mfma_f32_16x16x32_bf16 v[72:75], a[64:67], a[80:83], v[72:75]
    ds_read_b64_tr_b16 a[28:29], v12 offset:12288
    s_lshr_b32 s53, s2, 3
    s_lshr_b32 s50, s52, 1
    s_lshl_b32 s50, s50, 3
    s_lshr_b32 s54, s53, 2
    s_add_u32 s50, s50, s54
    v_mfma_f32_16x16x32_bf16 v[76:79], a[68:71], a[80:83], v[76:79]
    ds_read_b64_tr_b16 a[30:31], v12 offset:12544
    s_and_b32 s51, s52, 1
    s_lshl_b32 s51, s51, 2
    s_and_b32 s54, s53, 3
    s_add_u32 s51, s51, s54
    s_xor_b32 s52, s48, 0
    v_mfma_f32_16x16x32_bf16 v[80:83], a[84:87], a[56:59], v[80:83]
    ds_read_b64_tr_b16 a[32:33], v13 offset:12288
    s_lshl_b32 s53, s50, 2
    s_add_u32 s52, s52, s53
    s_lshl_b32 s52, s52, 16
    s_lshl_b32 s53, s48, 10
    s_add_u32 s83, s52, s53
    v_mfma_f32_16x16x32_bf16 v[84:87], a[84:87], a[60:63], v[84:87]
    ds_read_b64_tr_b16 a[34:35], v13 offset:12544
    s_xor_b32 s52, s48, 1
    s_lshl_b32 s53, s50, 2
    s_add_u32 s52, s52, s53
    s_lshl_b32 s52, s52, 16
    v_mfma_f32_16x16x32_bf16 v[88:91], a[84:87], a[64:67], v[88:91]
    ds_read_b128 a[40:43], v9 offset:0
    s_lshl_b32 s53, s48, 10
    s_add_u32 s27, s52, s53
    s_xor_b32 s52, s48, 2
    s_lshl_b32 s53, s50, 2
    s_add_u32 s52, s52, s53
    v_mfma_f32_16x16x32_bf16 v[92:95], a[84:87], a[68:71], v[92:95]
    ds_read_b128 a[44:47], v9 offset:2048
    s_lshl_b32 s52, s52, 16
    s_lshl_b32 s53, s48, 10
    s_add_u32 s58, s52, s53
    s_xor_b32 s52, s48, 3
    s_lshl_b32 s53, s50, 2
    v_mfma_f32_16x16x32_bf16 v[96:99], a[88:91], a[56:59], v[96:99]
    v_add_u32 v14, s101, v14
    s_add_u32 s52, s52, s53
    s_lshl_b32 s52, s52, 16
    s_lshl_b32 s53, s48, 10
    s_add_u32 s72, s52, s53
    v_mfma_f32_16x16x32_bf16 v[100:103], a[88:91], a[60:63], v[100:103]
    v_add_u32 v15, s101, v15
    s_add_u32 m0, s10, 0
    v_mfma_f32_16x16x32_bf16 v[104:107], a[88:91], a[64:67], v[104:107]
    buffer_load_dwordx4 v140, s[32:35], s81 offen offset:0 lds
    v_add_u32 v16, s101, v16
    s_add_u32 m0, s10, 1024
    v_mfma_f32_16x16x32_bf16 v[108:111], a[88:91], a[68:71], v[108:111]
    buffer_load_dwordx4 v140, s[32:35], s82 offen offset:0 lds
    v_add_u32 v17, s101, v17
    s_add_u32 m0, s10, 1984
    v_mfma_f32_16x16x32_bf16 a[112:115], a[96:99], a[96:99], a[112:115]
    buffer_load_dwordx4 v140, s[32:35], s81 offen offset:64 lds
    v_add_u32 v29, s101, v29
    s_add_u32 m0, s10, 3008
    v_mfma_f32_16x16x32_bf16 a[116:119], v[24:27], a[96:99], a[116:119]
    buffer_load_dwordx4 v140, s[32:35], s82 offen offset:64 lds
    v_add_u32 v30, s101, v30
    v_mfma_f32_16x16x32_bf16 a[120:123], a[100:103], a[100:103], a[120:123]
    v_mfma_f32_16x16x32_bf16 a[124:127], v[24:27], a[100:103], a[124:127]
    s_add_u32 s100, s100, s101
    s_add_u32 s11, s11, 1
    s_cmp_lt_u32 s11, 8
    s_waitcnt lgkmcnt(0)
L_F_B34_tail:
    v_mfma_f32_16x16x32_bf16 v[32:35], a[0:3], a[16:19], v[32:35]
    ds_read_b128 a[56:59], v14 offset:0
    v_mfma_f32_16x16x32_bf16 v[36:39], a[4:7], a[16:19], v[36:39]
    ds_read_b128 a[60:63], v14 offset:2048
    v_mfma_f32_16x16x32_bf16 v[40:43], a[8:11], a[16:19], v[40:43]
    ds_read_b128 a[64:67], v14 offset:8192
    v_mfma_f32_16x16x32_bf16 v[44:47], a[12:15], a[16:19], v[44:47]
    ds_read_b128 a[68:71], v14 offset:10240
    v_mfma_f32_16x16x32_bf16 v[48:51], a[0:3], a[20:23], v[48:51]
    ds_read_b64_tr_b16 a[72:73], v16 offset:0
    v_mfma_f32_16x16x32_bf16 v[52:55], a[4:7], a[20:23], v[52:55]
    ds_read_b64_tr_b16 a[74:75], v16 offset:256
    v_mfma_f32_16x16x32_bf16 v[56:59], a[8:11], a[20:23], v[56:59]
    ds_read_b64_tr_b16 a[76:77], v17 offset:0
    v_mfma_f32_16x16x32_bf16 v[60:63], a[12:15], a[20:23], v[60:63]
    ds_read_b64_tr_b16 a[78:79], v17 offset:256
    v_mfma_f32_16x16x32_bf16 v[64:67], a[0:3], a[24:27], v[64:67]
    ds_read_b64_tr_b16 a[80:81], v16 offset:4096
    v_mfma_f32_16x16x32_bf16 v[68:71], a[4:7], a[24:27], v[68:71]
    ds_read_b64_tr_b16 a[82:83], v16 offset:4352
    v_mfma_f32_16x16x32_bf16 v[72:75], a[8:11], a[24:27], v[72:75]
    ds_read_b64_tr_b16 a[84:85], v29 offset:12288
    v_mfma_f32_16x16x32_bf16 v[76:79], a[12:15], a[24:27], v[76:79]
    ds_read_b64_tr_b16 a[86:87], v29 offset:12544
    v_mfma_f32_16x16x32_bf16 v[80:83], a[28:31], a[0:3], v[80:83]
    ds_read_b64_tr_b16 a[88:89], v30 offset:12288
    v_mfma_f32_16x16x32_bf16 v[84:87], a[28:31], a[4:7], v[84:87]
    ds_read_b64_tr_b16 a[90:91], v30 offset:12544
    v_mfma_f32_16x16x32_bf16 v[88:91], a[28:31], a[8:11], v[88:91]
    ds_read_b128 a[96:99], v15 offset:0
    v_mfma_f32_16x16x32_bf16 v[92:95], a[28:31], a[12:15], v[92:95]
    ds_read_b128 a[100:103], v15 offset:2048
    v_mfma_f32_16x16x32_bf16 v[96:99], a[32:35], a[0:3], v[96:99]
    s_cmp_eq_u32 s100, 94208
    s_cselect_b32 s101, -94208, s73
    v_mfma_f32_16x16x32_bf16 v[100:103], a[32:35], a[4:7], v[100:103]
    v_add_u32 v8, s101, v8
    v_mfma_f32_16x16x32_bf16 v[104:107], a[32:35], a[8:11], v[104:107]
    v_add_u32 v9, s101, v9
    v_mfma_f32_16x16x32_bf16 v[108:111], a[32:35], a[12:15], v[108:111]
    v_add_u32 v10, s101, v10
    v_mfma_f32_16x16x32_bf16 a[128:131], v[24:27], a[16:19], a[128:131]
    v_add_u32 v11, s101, v11
    v_mfma_f32_16x16x32_bf16 a[132:135], v[24:27], a[20:23], a[132:135]
    v_add_u32 v12, s101, v12
    v_mfma_f32_16x16x32_bf16 a[136:139], v[24:27], a[24:27], a[136:139]
    v_add_u32 v13, s101, v13
    v_mfma_f32_16x16x32_bf16 a[140:143], v[24:27], a[28:31], a[140:143]
    v_mfma_f32_16x16x32_bf16 a[144:147], v[24:27], a[32:35], a[144:147]
    v_mfma_f32_16x16x32_bf16 a[112:115], a[40:43], a[40:43], a[112:115]
    v_mfma_f32_16x16x32_bf16 a[116:119], v[24:27], a[40:43], a[116:119]
    v_mfma_f32_16x16x32_bf16 a[120:123], a[44:47], a[44:47], a[120:123]
    v_mfma_f32_16x16x32_bf16 a[124:127], v[24:27], a[44:47], a[124:127]
    s_waitcnt lgkmcnt(0)
    s_waitcnt vmcnt(5)
    s_barrier
    v_mfma_f32_16x16x32_bf16 v[32:35], a[56:59], a[72:75], v[32:35]
    ds_read_b128 a[0:3], v8 offset:0
    v_mfma_f32_16x16x32_bf16 v[36:39], a[60:63], a[72:75], v[36:39]
    ds_read_b128 a[4:7], v8 offset:2048
    v_mfma_f32_16x16x32_bf16 v[40:43], a[64:67], a[72:75], v[40:43]
    ds_read_b128 a[8:11], v8 offset:8192
    v_mfma_f32_16x16x32_bf16 v[44:47], a[68:71], a[72:75], v[44:47]
    ds_read_b128 a[12:15], v8 offset:10240
    v_mfma_f32_16x16x32_bf16 v[48:51], a[56:59], a[76:79], v[48:51]
    ds_read_b64_tr_b16 a[16:17], v10 offset:0
    v_mfma_f32_16x16x32_bf16 v[52:55], a[60:63], a[76:79], v[52:55]
    ds_read_b64_tr_b16 a[18:19], v10 offset:256
    v_mfma_f32_16x16x32_bf16 v[56:59], a[64:67], a[76:79], v[56:59]
    ds_read_b64_tr_b16 a[20:21], v11 offset:0
    v_mfma_f32_16x16x32_bf16 v[60:63], a[68:71], a[76:79], v[60:63]
    ds_read_b64_tr_b16 a[22:23], v11 offset:256
    v_mfma_f32_16x16x32_bf16 v[64:67], a[56:59], a[80:83], v[64:67]
    ds_read_b64_tr_b16 a[24:25], v10 offset:4096
    v_mfma_f32_16x16x32_bf16 v[68:71], a[60:63], a[80:83], v[68:71]
    ds_read_b64_tr_b16 a[26:27], v10 offset:4352
    v_mfma_f32_16x16x32_bf16 v[72:75], a[64:67], a[80:83], v[72:75]
    ds_read_b64_tr_b16 a[28:29], v12 offset:12288
    v_mfma_f32_16x16x32_bf16 v[76:79], a[68:71], a[80:83], v[76:79]
    ds_read_b64_tr_b16 a[30:31], v12 offset:12544
    v_mfma_f32_16x16x32_bf16 v[80:83], a[84:87], a[56:59], v[80:83]
    ds_read_b64_tr_b16 a[32:33], v13 offset:12288
    v_mfma_f32_16x16x32_bf16 v[84:87], a[84:87], a[60:63], v[84:87]
    ds_read_b64_tr_b16 a[34:35], v13 offset:12544
    v_mfma_f32_16x16x32_bf16 v[88:91], a[84:87], a[64:67], v[88:91]
    ds_read_b128 a[40:43], v9 offset:0
    v_mfma_f32_16x16x32_bf16 v[92:95], a[84:87], a[68:71], v[92:95]
    ds_read_b128 a[44:47], v9 offset:2048
    v_mfma_f32_16x16x32_bf16 v[96:99], a[88:91], a[56:59], v[96:99]
    v_add_u32 v14, s101, v14
    v_mfma_f32_16x16x32_bf16 v[100:103], a[88:91], a[60:63], v[100:103]
    v_add_u32 v15, s101, v15
    v_mfma_f32_16x16x32_bf16 v[104:107], a[88:91], a[64:67], v[104:107]
    v_add_u32 v16, s101, v16
    v_mfma_f32_16x16x32_bf16 v[108:111], a[88:91], a[68:71], v[108:111]
    v_add_u32 v17, s101, v17
    v_mfma_f32_16x16x32_bf16 a[112:115], a[96:99], a[96:99], a[112:115]
    v_add_u32 v29, s101, v29
    v_mfma_f32_16x16x32_bf16 a[116:119], v[24:27], a[96:99], a[116:119]
    v_add_u32 v30, s101, v30
    v_mfma_f32_16x16x32_bf16 a[120:123], a[100:103], a[100:103], a[120:123]
    v_mfma_f32_16x16x32_bf16 a[124:127], v[24:27], a[100:103], a[124:127]
    s_add_u32 s100, s100, s101
    s_add_u32 s11, s11, 1
    s_cmp_lt_u32 s11, 8
    s_waitcnt lgkmcnt(0)
    s_cbranch_scc1 L_F_B34_tail
    s_barrier
    s_mul_i32 s73, s48, 33792
    s_mov_b32 s28, s14
    s_mov_b32 s29, s15
    s_mov_b32 s30, 8388608
    s_mov_b32 s31, 0x20000
    s_waitcnt vmcnt(4)
    s_mov_b32 s101, 0
    v_cmp_eq_u32 vcc, 0, v21
    s_nop 3
    s_cbranch_vccnz L_F_B34_nspin
L_F_B34_nspin_go:
    v_readfirstlane_b32 s49, v21
    v_mov_b32 v144, 0x3b000000
    v_mov_b32 v145, 0x3727c5ac
    v_and_b32 v146, 1, v0
    v_cmp_eq_u32 s[50:51], 1, v146
    v_and_b32 v146, 2, v0
    v_cmp_eq_u32 s[52:53], 2, v146
    v_lshrrev_b32 v146, 2, v2
    v_cmp_eq_u32 s[54:55], v1, v146
    s_waitcnt vmcnt(0)
    ds_read_b64_tr_b16 v[192:193], v141 offset:0
    ds_read_b64_tr_b16 v[194:195], v141 offset:1024
    ds_read_b64_tr_b16 v[196:197], v142 offset:0
    ds_read_b64_tr_b16 v[198:199], v142 offset:1024
    ds_read_b64_tr_b16 v[200:201], v141 offset:2048
    ds_read_b64_tr_b16 v[202:203], v141 offset:3072
    ds_read_b64_tr_b16 v[204:205], v142 offset:2048
    ds_read_b64_tr_b16 v[206:207], v142 offset:3072
    v_accvgpr_read_b32 v160, a112
    v_accvgpr_read_b32 v161, a113
    v_accvgpr_read_b32 v162, a114
    v_accvgpr_read_b32 v163, a115
    v_accvgpr_read_b32 v164, a116
    v_accvgpr_read_b32 v168, a120
    v_accvgpr_read_b32 v169, a121
    v_accvgpr_read_b32 v170, a122
    v_accvgpr_read_b32 v171, a123
    v_accvgpr_read_b32 v172, a124
    v_cndmask_b32 v160, v160, v161, s[50:51]
    v_cndmask_b32 v162, v162, v163, s[50:51]
    v_cndmask_b32 v168, v168, v169, s[50:51]
    v_cndmask_b32 v170, v170, v171, s[50:51]
    v_mul_f32 v164, v164, v144
    v_cndmask_b32 v160, v160, v162, s[52:53]
    v_mul_f32 v172, v172, v144
    v_cndmask_b32 v168, v168, v170, s[52:53]
    v_mul_f32 v160, v160, v144
    v_mul_f32 v168, v168, v144
    v_fma_f32 v160, -v164, v164, v160
    v_fma_f32 v168, -v172, v172, v168
    v_max_f32 v160, 0, v160
    v_max_f32 v168, 0, v168
    v_cvt_pk_bf16_f32 v160, v160, v160
    v_and_b32 v160, 0xffff0000, v160
    v_cvt_pk_bf16_f32 v168, v168, v168
    v_and_b32 v168, 0xffff0000, v168
    v_add_f32 v160, v160, v145
    v_add_f32 v168, v168, v145
    v_cvt_pk_bf16_f32 v160, v160, v160
    v_and_b32 v160, 0xffff0000, v160
    v_cvt_pk_bf16_f32 v168, v168, v168
    v_and_b32 v168, 0xffff0000, v168
    v_sqrt_f32 v160, v160
    v_sqrt_f32 v168, v168
    s_add_u32 s32, s24, 16777216
    s_addc_u32 s33, s25, 0
    s_mov_b32 s34, 1441792
    s_waitcnt lgkmcnt(0)
    buffer_store_dwordx4 v[192:195], v20, s[32:35], s26 offen offset:0 sc1
    buffer_store_dwordx4 v[196:199], v20, s[32:35], s26 offen offset:1024 sc1
    buffer_store_dwordx4 v[200:203], v20, s[32:35], s26 offen offset:2048 sc1
    buffer_store_dwordx4 v[204:207], v20, s[32:35], s26 offen offset:3072 sc1
    v_cvt_pk_bf16_f32 v164, v164, v164
    v_and_b32 v164, 0xffff0000, v164
    v_cvt_pk_bf16_f32 v172, v172, v172
    v_and_b32 v172, 0xffff0000, v172
    v_cvt_pk_bf16_f32 v160, v160, v160
    v_and_b32 v160, 0xffff0000, v160
    v_cvt_pk_bf16_f32 v168, v168, v168
    v_and_b32 v168, 0xffff0000, v168
    v_rcp_f32 v160, v160
    v_rcp_f32 v168, v168
    v_mul_f32 v164, -v164, v160
    v_mul_f32 v172, -v172, v168
    ds_write_b32 v149, a128 offset:2048
    ds_write_b32 v149, a132 offset:2112
    ds_write_b32 v149, a136 offset:2176
    ds_write_b32 v150, a140 offset:2560
    ds_write_b32 v150, a144 offset:2624
    s_mov_b64 exec, s[54:55]
    ds_write_b32 v148, v160 offset:0
    ds_write_b32 v148, v164 offset:1024
    ds_write_b32 v148, v168 offset:64
    ds_write_b32 v148, v172 offset:1088
    s_add_u32 s44, s24, 15204352
    s_addc_u32 s45, s25, 0
    s_mov_b32 s46, 131072
    s_mov_b32 s47, 0x20000
    s_lshl_b32 s100, s76, 2
    s_add_u32 s100, s100, s77
    s_lshl_b32 s100, s100, 11
    s_lshl_b32 s59, s59, 2
    s_add_u32 s100, s100, s59
    v_lshlrev_b32 v165, 4, v2
    v_mov_b32 v162, v164
    v_mov_b32 v161, s49
    v_mov_b32 v163, s49
    buffer_store_dwordx4 v[160:163], v165, s[44:47], s100 offen offset:0 sc1
    v_mov_b32 v170, v172
    v_mov_b32 v169, s49
    v_mov_b32 v171, s49
    buffer_store_dwordx4 v[168:171], v165, s[44:47], s100 offen offset:256 sc1
    s_mov_b64 exec, -1
    s_add_u32 s44, s24, 15466496
    s_addc_u32 s45, s25, 0
    s_mov_b32 s46, 196608
    s_mov_b32 s47, 0x20000
    s_waitcnt lgkmcnt(0)
    s_barrier
    ds_read_b128 v[152:155], v240 offset:0
    ds_read_b128 v[168:171], v240 offset:1024
    ds_read_b128 v[156:159], v240 offset:64
    ds_read_b128 v[172:175], v240 offset:1088
    ds_read_b32 v184, v244 offset:2048
    ds_read_b32 v185, v244 offset:3072
    ds_read_b32 v186, v244 offset:2112
    ds_read_b32 v187, v244 offset:3136
    ds_read_b32 v188, v244 offset:2176
    ds_read_b32 v189, v244 offset:3200
    s_add_u32 s32, s24, 14942208
    s_addc_u32 s33, s25, 0
    s_mov_b32 s34, 262144
    s_mov_b32 s35, 0x20000
    s_mov_b32 s71, 0
    v_mov_b32 v247, s49
    v_mov_b32 v249, s49
    s_waitcnt lgkmcnt(0)
    ds_read_b128 v[160:163], v240 offset:256
    ds_read_b128 v[176:179], v240 offset:1280
    ds_read_b128 v[164:167], v240 offset:320
    ds_read_b128 v[180:183], v240 offset:1344
    ds_read_b32 v232, v242 offset:0
    ds_read_b32 v236, v242 offset:1024
    ds_read_b32 v233, v242 offset:64
    ds_read_b32 v237, v242 offset:1088
    ds_read_b32 v234, v242 offset:256
    ds_read_b32 v238, v242 offset:1280
    ds_read_b32 v235, v242 offset:320
    ds_read_b32 v239, v242 offset:1344
    v_add_f32 v184, v184, v185
    v_add_f32 v186, v186, v187
    v_add_f32 v188, v188, v189
    v_pk_mul_f32 v[224:225], v[168:169], v[184:185] op_sel_hi:[1,0]
    v_pk_mul_f32 v[226:227], v[170:171], v[184:185] op_sel_hi:[1,0]
    v_pk_mul_f32 v[228:229], v[172:173], v[184:185] op_sel_hi:[1,0]
    v_pk_mul_f32 v[230:231], v[174:175], v[184:185] op_sel_hi:[1,0]
    v_pk_fma_f32 v[32:33], v[152:153], v[32:33], v[224:225]
    v_pk_fma_f32 v[34:35], v[154:155], v[34:35], v[226:227]
    v_pk_fma_f32 v[36:37], v[156:157], v[36:37], v[228:229]
    v_pk_fma_f32 v[38:39], v[158:159], v[38:39], v[230:231]
    v_pk_mul_f32 v[224:225], v[32:33], v[32:33]
    v_pk_mul_f32 v[226:227], v[34:35], v[34:35]
    v_pk_mul_f32 v[228:229], v[36:37], v[36:37]
    v_pk_mul_f32 v[230:231], v[38:39], v[38:39]
    v_pk_fma_f32 v[224:225], v[224:225], v[250:251], v[250:251] op_sel:[0,1,0] op_sel_hi:[1,1,0]
    v_pk_fma_f32 v[226:227], v[226:227], v[250:251], v[250:251] op_sel:[0,1,0] op_sel_hi:[1,1,0]
    v_pk_fma_f32 v[228:229], v[228:229], v[250:251], v[250:251] op_sel:[0,1,0] op_sel_hi:[1,1,0]
    v_pk_fma_f32 v[230:231], v[230:231], v[250:251], v[250:251] op_sel:[0,1,0] op_sel_hi:[1,1,0]
    v_pk_mul_f32 v[224:225], v[224:225], v[32:33]
    v_pk_mul_f32 v[226:227], v[226:227], v[34:35]
    v_pk_mul_f32 v[228:229], v[228:229], v[36:37]
    v_pk_mul_f32 v[230:231], v[230:231], v[38:39]
    v_exp_f32 v224, v224
    v_exp_f32 v225, v225
    s_add_u32 m0, s73, 1024
    s_nop 0
    buffer_load_dwordx4 v23, s[28:31], s83 offen offset:0  lds
    v_exp_f32 v226, v226
    v_exp_f32 v227, v227
    v_exp_f32 v228, v228
    v_exp_f32 v229, v229
    v_exp_f32 v230, v230
    v_exp_f32 v231, v231
    v_pk_add_f32 v[224:225], v[224:225], 1.0 op_sel_hi:[1,0]
    v_pk_add_f32 v[226:227], v[226:227], 1.0 op_sel_hi:[1,0]
    v_pk_add_f32 v[228:229], v[228:229], 1.0 op_sel_hi:[1,0]
    v_pk_add_f32 v[230:231], v[230:231], 1.0 op_sel_hi:[1,0]
    v_rcp_f32 v224, v224
    v_rcp_f32 v225, v225
    v_rcp_f32 v226, v226
    v_rcp_f32 v227, v227
    v_rcp_f32 v228, v228
    v_rcp_f32 v229, v229
    v_rcp_f32 v230, v230
    s_add_u32 m0, s73, 2048
    s_nop 0
    buffer_load_dwordx4 v31, s[28:31], s83 offen offset:0  lds
    v_rcp_f32 v231, v231
    v_pk_mul_f32 v[32:33], v[32:33], v[224:225]
    v_pk_mul_f32 v[34:35], v[34:35], v[226:227]
    v_pk_mul_f32 v[36:37], v[36:37], v[228:229]
    v_pk_mul_f32 v[38:39], v[38:39], v[230:231]
    v_mov_b32 v192, v32
    v_mov_b32 v193, v33
    v_pk_mul_f32 v[196:197], v[32:33], v[32:33]
    v_mov_b32 v194, v34
    v_mov_b32 v195, v35
    v_pk_mul_f32 v[198:199], v[34:35], v[34:35]
    v_mov_b32 v200, v36
    v_mov_b32 v201, v37
    v_pk_mul_f32 v[204:205], v[36:37], v[36:37]
    v_mov_b32 v202, v38
    v_mov_b32 v203, v39
    v_pk_mul_f32 v[206:207], v[38:39], v[38:39]
    v_pk_mul_f32 v[224:225], v[168:169], v[186:187] op_sel_hi:[1,0]
    v_pk_mul_f32 v[226:227], v[170:171], v[186:187] op_sel_hi:[1,0]
    v_pk_mul_f32 v[228:229], v[172:173], v[186:187] op_sel_hi:[1,0]
    v_pk_mul_f32 v[230:231], v[174:175], v[186:187] op_sel_hi:[1,0]
    v_pk_fma_f32 v[48:49], v[152:153], v[48:49], v[224:225]
    v_pk_fma_f32 v[50:51], v[154:155], v[50:51], v[226:227]
    v_pk_fma_f32 v[52:53], v[156:157], v[52:53], v[228:229]
    v_pk_fma_f32 v[54:55], v[158:159], v[54:55], v[230:231]
    v_pk_mul_f32 v[224:225], v[48:49], v[48:49]
    v_pk_mul_f32 v[226:227], v[50:51], v[50:51]
    v_pk_mul_f32 v[228:229], v[52:53], v[52:53]
    v_pk_mul_f32 v[230:231], v[54:55], v[54:55]
    s_add_u32 m0, s73, 3072
    s_nop 0
    buffer_load_dwordx4 v23, s[28:31], s27 offen offset:0  lds
    v_pk_fma_f32 v[224:225], v[224:225], v[250:251], v[250:251] op_sel:[0,1,0] op_sel_hi:[1,1,0]
    v_pk_fma_f32 v[226:227], v[226:227], v[250:251], v[250:251] op_sel:[0,1,0] op_sel_hi:[1,1,0]
    v_pk_fma_f32 v[228:229], v[228:229], v[250:251], v[250:251] op_sel:[0,1,0] op_sel_hi:[1,1,0]
    v_pk_fma_f32 v[230:231], v[230:231], v[250:251], v[250:251] op_sel:[0,1,0] op_sel_hi:[1,1,0]
    v_pk_mul_f32 v[224:225], v[224:225], v[48:49]
    v_pk_mul_f32 v[226:227], v[226:227], v[50:51]
    v_pk_mul_f32 v[228:229], v[228:229], v[52:53]
    v_pk_mul_f32 v[230:231], v[230:231], v[54:55]
    v_exp_f32 v224, v224
    v_exp_f32 v225, v225
    v_exp_f32 v226, v226
    v_exp_f32 v227, v227
    v_exp_f32 v228, v228
    v_exp_f32 v229, v229
    v_exp_f32 v230, v230
    v_exp_f32 v231, v231
    v_pk_add_f32 v[224:225], v[224:225], 1.0 op_sel_hi:[1,0]
    v_pk_add_f32 v[226:227], v[226:227], 1.0 op_sel_hi:[1,0]
    v_pk_add_f32 v[228:229], v[228:229], 1.0 op_sel_hi:[1,0]
    v_pk_add_f32 v[230:231], v[230:231], 1.0 op_sel_hi:[1,0]
    v_rcp_f32 v224, v224
    s_add_u32 m0, s73, 4096
    s_nop 0
    buffer_load_dwordx4 v31, s[28:31], s27 offen offset:0  lds
    v_rcp_f32 v225, v225
    v_rcp_f32 v226, v226
    v_rcp_f32 v227, v227
    v_rcp_f32 v228, v228
    v_rcp_f32 v229, v229
    v_rcp_f32 v230, v230
    v_rcp_f32 v231, v231
    v_pk_mul_f32 v[48:49], v[48:49], v[224:225]
    v_pk_mul_f32 v[50:51], v[50:51], v[226:227]
    v_pk_mul_f32 v[52:53], v[52:53], v[228:229]
    v_pk_mul_f32 v[54:55], v[54:55], v[230:231]
    v_pk_add_f32 v[192:193], v[192:193], v[48:49]
    v_pk_fma_f32 v[196:197], v[48:49], v[48:49], v[196:197]
    v_pk_add_f32 v[194:195], v[194:195], v[50:51]
    v_pk_fma_f32 v[198:199], v[50:51], v[50:51], v[198:199]
    v_pk_add_f32 v[200:201], v[200:201], v[52:53]
    v_pk_fma_f32 v[204:205], v[52:53], v[52:53], v[204:205]
    v_pk_add_f32 v[202:203], v[202:203], v[54:55]
    v_pk_fma_f32 v[206:207], v[54:55], v[54:55], v[206:207]
    v_pk_mul_f32 v[224:225], v[168:169], v[188:189] op_sel_hi:[1,0]
    v_pk_mul_f32 v[226:227], v[170:171], v[188:189] op_sel_hi:[1,0]
    v_pk_mul_f32 v[228:229], v[172:173], v[188:189] op_sel_hi:[1,0]
    v_pk_mul_f32 v[230:231], v[174:175], v[188:189] op_sel_hi:[1,0]
    s_add_u32 m0, s73, 5120
    s_nop 0
    buffer_load_dwordx4 v23, s[28:31], s58 offen offset:0  lds
    v_pk_fma_f32 v[64:65], v[152:153], v[64:65], v[224:225]
    v_pk_fma_f32 v[66:67], v[154:155], v[66:67], v[226:227]
    v_pk_fma_f32 v[68:69], v[156:157], v[68:69], v[228:229]
    v_pk_fma_f32 v[70:71], v[158:159], v[70:71], v[230:231]
    v_pk_mul_f32 v[224:225], v[64:65], v[64:65]
    v_pk_mul_f32 v[226:227], v[66:67], v[66:67]
    v_pk_mul_f32 v[228:229], v[68:69], v[68:69]
    v_pk_mul_f32 v[230:231], v[70:71], v[70:71]
    v_pk_fma_f32 v[224:225], v[224:225], v[250:251], v[250:251] op_sel:[0,1,0] op_sel_hi:[1,1,0]
    v_pk_fma_f32 v[226:227], v[226:227], v[250:251], v[250:251] op_sel:[0,1,0] op_sel_hi:[1,1,0]
    v_pk_fma_f32 v[228:229], v[228:229], v[250:251], v[250:251] op_sel:[0,1,0] op_sel_hi:[1,1,0]
    v_pk_fma_f32 v[230:231], v[230:231], v[250:251], v[250:251] op_sel:[0,1,0] op_sel_hi:[1,1,0]
    v_pk_mul_f32 v[224:225], v[224:225], v[64:65]
    v_pk_mul_f32 v[226:227], v[226:227], v[66:67]
    v_pk_mul_f32 v[228:229], v[228:229], v[68:69]
    v_pk_mul_f32 v[230:231], v[230:231], v[70:71]
    v_exp_f32 v224, v224
    v_exp_f32 v225, v225
    v_exp_f32 v226, v226
    v_exp_f32 v227, v227
    v_exp_f32 v228, v228
    v_exp_f32 v229, v229
    v_exp_f32 v230, v230
    s_add_u32 m0, s73, 6144
    s_nop 0
    buffer_load_dwordx4 v31, s[28:31], s58 offen offset:0  lds
    v_exp_f32 v231, v231
    v_pk_add_f32 v[224:225], v[224:225], 1.0 op_sel_hi:[1,0]
    v_pk_add_f32 v[226:227], v[226:227], 1.0 op_sel_hi:[1,0]
    v_pk_add_f32 v[228:229], v[228:229], 1.0 op_sel_hi:[1,0]
    v_pk_add_f32 v[230:231], v[230:231], 1.0 op_sel_hi:[1,0]
    v_rcp_f32 v224, v224
    v_rcp_f32 v225, v225
    v_rcp_f32 v226, v226
    v_rcp_f32 v227, v227
    v_rcp_f32 v228, v228
    v_rcp_f32 v229, v229
    v_rcp_f32 v230, v230
    v_rcp_f32 v231, v231
    v_pk_mul_f32 v[64:65], v[64:65], v[224:225]
    v_pk_mul_f32 v[66:67], v[66:67], v[226:227]
    v_pk_mul_f32 v[68:69], v[68:69], v[228:229]
    v_pk_mul_f32 v[70:71], v[70:71], v[230:231]
    v_pk_add_f32 v[192:193], v[192:193], v[64:65]
    v_pk_fma_f32 v[196:197], v[64:65], v[64:65], v[196:197]
    v_pk_add_f32 v[194:195], v[194:195], v[66:67]
    v_pk_fma_f32 v[198:199], v[66:67], v[66:67], v[198:199]
    s_add_u32 m0, s73, 7168
    s_nop 0
    buffer_load_dwordx4 v23, s[28:31], s72 offen offset:0  lds
    v_pk_add_f32 v[200:201], v[200:201], v[68:69]
    v_pk_fma_f32 v[204:205], v[68:69], v[68:69], v[204:205]
    v_pk_add_f32 v[202:203], v[202:203], v[70:71]
    v_pk_fma_f32 v[206:207], v[70:71], v[70:71], v[206:207]
    ds_read_b128 v[152:155], v245 offset:2560
    ds_read_b128 v[156:159], v245 offset:3584
    ds_read_b128 v[168:171], v245 offset:2624
    ds_read_b128 v[172:175], v245 offset:3648
    v_add_f32_dpp v192, v192, v192 row_mirror row_mask:0xf bank_mask:0x3
    v_add_f32_dpp v193, v193, v193 row_mirror row_mask:0xf bank_mask:0x3
    v_add_f32_dpp v194, v194, v194 row_mirror row_mask:0xf bank_mask:0x3
    v_add_f32_dpp v195, v195, v195 row_mirror row_mask:0xf bank_mask:0x3
    v_add_f32_dpp v196, v196, v196 row_mirror row_mask:0xf bank_mask:0x3
    v_add_f32_dpp v197, v197, v197 row_mirror row_mask:0xf bank_mask:0x3
    v_add_f32_dpp v198, v198, v198 row_mirror row_mask:0xf bank_mask:0x3
    v_add_f32_dpp v199, v199, v199 row_mirror row_mask:0xf bank_mask:0x3
    v_add_f32_dpp v192, v200, v200 row_mirror row_mask:0xf bank_mask:0xc
    v_add_f32_dpp v193, v201, v201 row_mirror row_mask:0xf bank_mask:0xc
    v_add_f32_dpp v194, v202, v202 row_mirror row_mask:0xf bank_mask:0xc
    v_add_f32_dpp v195, v203, v203 row_mirror row_mask:0xf bank_mask:0xc
    v_add_f32_dpp v196, v204, v204 row_mirror row_mask:0xf bank_mask:0xc
    v_add_f32_dpp v197, v205, v205 row_mirror row_mask:0xf bank_mask:0xc
    v_add_f32_dpp v198, v206, v206 row_mirror row_mask:0xf bank_mask:0xc
    v_add_f32_dpp v199, v207, v207 row_mirror row_mask:0xf bank_mask:0xc
    v_add_f32_dpp v192, v192, v192 row_half_mirror row_mask:0xf bank_mask:0x5
    v_add_f32_dpp v193, v193, v193 row_half_mirror row_mask:0xf bank_mask:0x5
    v_add_f32_dpp v194, v194, v194 row_half_mirror row_mask:0xf bank_mask:0x5
    v_add_f32_dpp v195, v195, v195 row_half_mirror row_mask:0xf bank_mask:0x5
    v_add_f32_dpp v192, v196, v196 row_half_mirror row_mask:0xf bank_mask:0xa
    v_add_f32_dpp v193, v197, v197 row_half_mirror row_mask:0xf bank_mask:0xa
    v_add_f32_dpp v194, v198, v198 row_half_mirror row_mask:0xf bank_mask:0xa
    v_add_f32_dpp v195, v199, v199 row_half_mirror row_mask:0xf bank_mask:0xa
    v_add_f32_dpp v192, v192, v192 quad_perm:[1,0,3,2] row_mask:0xf bank_mask:0xf
    v_add_f32_dpp v193, v193, v193 quad_perm:[1,0,3,2] row_mask:0xf bank_mask:0xf
    s_add_u32 m0, s73, 8192
    s_nop 0
    buffer_load_dwordx4 v31, s[28:31], s72 offen offset:0  lds
    v_add_f32_dpp v194, v194, v194 quad_perm:[1,0,3,2] row_mask:0xf bank_mask:0xf
    v_add_f32_dpp v195, v195, v195 quad_perm:[1,0,3,2] row_mask:0xf bank_mask:0xf
    v_add_f32_dpp v192, v192, v192 quad_perm:[2,3,0,1] row_mask:0xf bank_mask:0xf
    v_add_f32_dpp v193, v193, v193 quad_perm:[2,3,0,1] row_mask:0xf bank_mask:0xf
    v_add_f32_dpp v194, v194, v194 quad_perm:[2,3,0,1] row_mask:0xf bank_mask:0xf
    v_add_f32_dpp v195, v195, v195 quad_perm:[2,3,0,1] row_mask:0xf bank_mask:0xf
    ds_write_b128 v241, v[192:195] offset:4096
    s_waitcnt lgkmcnt(0)
    s_barrier
    ds_read_b32 v246, v243 offset:4096
    ds_read_b32 v248, v243 offset:4352
    ds_read_b32 v135, v243 offset:4608
    ds_read_b32 v136, v243 offset:4864
    v_pk_add_f32 v[152:153], v[152:153], v[156:157]
    v_pk_add_f32 v[154:155], v[154:155], v[158:159]
    v_pk_add_f32 v[168:169], v[168:169], v[172:173]
    v_pk_add_f32 v[170:171], v[170:171], v[174:175]
    s_waitcnt lgkmcnt(0)
    v_add_f32 v246, v246, v135
    v_add_f32 v248, v248, v136
    s_mov_b64 exec, 0xffff
    buffer_store_dwordx4 v[246:249], v20, s[32:35], s63 offen offset:0 sc1
    s_mov_b64 exec, -1
    v_pk_mul_f32 v[224:225], v[176:177], v[184:185] op_sel_hi:[1,0]
    v_pk_mul_f32 v[226:227], v[178:179], v[184:185] op_sel_hi:[1,0]
    v_pk_mul_f32 v[228:229], v[180:181], v[184:185] op_sel_hi:[1,0]
    v_pk_mul_f32 v[230:231], v[182:183], v[184:185] op_sel_hi:[1,0]
    v_pk_fma_f32 v[40:41], v[160:161], v[40:41], v[224:225]
    v_pk_fma_f32 v[42:43], v[162:163], v[42:43], v[226:227]
    v_pk_fma_f32 v[44:45], v[164:165], v[44:45], v[228:229]
    v_pk_fma_f32 v[46:47], v[166:167], v[46:47], v[230:231]
    v_pk_mul_f32 v[224:225], v[40:41], v[40:41]
    v_pk_mul_f32 v[226:227], v[42:43], v[42:43]
    v_pk_mul_f32 v[228:229], v[44:45], v[44:45]
    v_pk_mul_f32 v[230:231], v[46:47], v[46:47]
    v_pk_fma_f32 v[224:225], v[224:225], v[250:251], v[250:251] op_sel:[0,1,0] op_sel_hi:[1,1,0]
    s_add_u32 m0, s73, 8960
    s_nop 0
    buffer_load_dwordx4 v23, s[28:31], s83 offen offset:256  lds
    v_pk_fma_f32 v[226:227], v[226:227], v[250:251], v[250:251] op_sel:[0,1,0] op_sel_hi:[1,1,0]
    v_pk_fma_f32 v[228:229], v[228:229], v[250:251], v[250:251] op_sel:[0,1,0] op_sel_hi:[1,1,0]
    v_pk_fma_f32 v[230:231], v[230:231], v[250:251], v[250:251] op_sel:[0,1,0] op_sel_hi:[1,1,0]
    v_pk_mul_f32 v[224:225], v[224:225], v[40:41]
    v_pk_mul_f32 v[226:227], v[226:227], v[42:43]
    v_pk_mul_f32 v[228:229], v[228:229], v[44:45]
    v_pk_mul_f32 v[230:231], v[230:231], v[46:47]
    v_exp_f32 v224, v224
    v_exp_f32 v225, v225
    v_exp_f32 v226, v226
    v_exp_f32 v227, v227
    v_exp_f32 v228, v228
    v_exp_f32 v229, v229
    v_exp_f32 v230, v230
    v_exp_f32 v231, v231
    v_pk_add_f32 v[224:225], v[224:225], 1.0 op_sel_hi:[1,0]
    v_pk_add_f32 v[226:227], v[226:227], 1.0 op_sel_hi:[1,0]
    s_add_u32 m0, s73, 9984
    s_nop 0
    buffer_load_dwordx4 v31, s[28:31], s83 offen offset:256  lds
    v_pk_add_f32 v[228:229], v[228:229], 1.0 op_sel_hi:[1,0]
    v_pk_add_f32 v[230:231], v[230:231], 1.0 op_sel_hi:[1,0]
    v_rcp_f32 v224, v224
    v_rcp_f32 v225, v225
    v_rcp_f32 v226, v226
    v_rcp_f32 v227, v227
    v_rcp_f32 v228, v228
    v_rcp_f32 v229, v229
    v_rcp_f32 v230, v230
    v_rcp_f32 v231, v231
    v_pk_mul_f32 v[40:41], v[40:41], v[224:225]
    v_pk_mul_f32 v[42:43], v[42:43], v[226:227]
    v_pk_mul_f32 v[44:45], v[44:45], v[228:229]
    v_pk_mul_f32 v[46:47], v[46:47], v[230:231]
    v_mov_b32 v192, v40
    v_mov_b32 v193, v41
    v_pk_mul_f32 v[196:197], v[40:41], v[40:41]
    s_add_u32 m0, s73, 11008
    s_nop 0
    buffer_load_dwordx4 v23, s[28:31], s27 offen offset:256  lds
    v_mov_b32 v194, v42
    v_mov_b32 v195, v43
    v_pk_mul_f32 v[198:199], v[42:43], v[42:43]
    v_mov_b32 v200, v44
    v_mov_b32 v201, v45
    v_pk_mul_f32 v[204:205], v[44:45], v[44:45]
    v_mov_b32 v202, v46
    v_mov_b32 v203, v47
    v_pk_mul_f32 v[206:207], v[46:47], v[46:47]
    v_pk_mul_f32 v[224:225], v[176:177], v[186:187] op_sel_hi:[1,0]
    v_pk_mul_f32 v[226:227], v[178:179], v[186:187] op_sel_hi:[1,0]
    v_pk_mul_f32 v[228:229], v[180:181], v[186:187] op_sel_hi:[1,0]
    v_pk_mul_f32 v[230:231], v[182:183], v[186:187] op_sel_hi:[1,0]
    v_pk_fma_f32 v[56:57], v[160:161], v[56:57], v[224:225]
    v_pk_fma_f32 v[58:59], v[162:163], v[58:59], v[226:227]
    v_pk_fma_f32 v[60:61], v[164:165], v[60:61], v[228:229]
    v_pk_fma_f32 v[62:63], v[166:167], v[62:63], v[230:231]
    v_pk_mul_f32 v[224:225], v[56:57], v[56:57]
    v_pk_mul_f32 v[226:227], v[58:59], v[58:59]
    v_pk_mul_f32 v[228:229], v[60:61], v[60:61]
    v_pk_mul_f32 v[230:231], v[62:63], v[62:63]
    v_pk_fma_f32 v[224:225], v[224:225], v[250:251], v[250:251] op_sel:[0,1,0] op_sel_hi:[1,1,0]
    v_pk_fma_f32 v[226:227], v[226:227], v[250:251], v[250:251] op_sel:[0,1,0] op_sel_hi:[1,1,0]
    v_pk_fma_f32 v[228:229], v[228:229], v[250:251], v[250:251] op_sel:[0,1,0] op_sel_hi:[1,1,0]
    v_pk_fma_f32 v[230:231], v[230:231], v[250:251], v[250:251] op_sel:[0,1,0] op_sel_hi:[1,1,0]
    s_add_u32 m0, s73, 12032
    s_nop 0
    buffer_load_dwordx4 v31, s[28:31], s27 offen offset:256  lds
    v_pk_mul_f32 v[224:225], v[224:225], v[56:57]
    v_pk_mul_f32 v[226:227], v[226:227], v[58:59]
    v_pk_mul_f32 v[228:229], v[228:229], v[60:61]
    v_pk_mul_f32 v[230:231], v[230:231], v[62:63]
    v_exp_f32 v224, v224
    v_exp_f32 v225, v225
    v_exp_f32 v226, v226
    v_exp_f32 v227, v227
    v_exp_f32 v228, v228
    v_exp_f32 v229, v229
    v_exp_f32 v230, v230
    v_exp_f32 v231, v231
    v_pk_add_f32 v[224:225], v[224:225], 1.0 op_sel_hi:[1,0]
    v_pk_add_f32 v[226:227], v[226:227], 1.0 op_sel_hi:[1,0]
    v_pk_add_f32 v[228:229], v[228:229], 1.0 op_sel_hi:[1,0]
    v_pk_add_f32 v[230:231], v[230:231], 1.0 op_sel_hi:[1,0]
    v_rcp_f32 v224, v224
    s_add_u32 m0, s73, 13056
    s_nop 0
    buffer_load_dwordx4 v23, s[28:31], s58 offen offset:256  lds
    v_rcp_f32 v225, v225
    v_rcp_f32 v226, v226
    v_rcp_f32 v227, v227
    v_rcp_f32 v228, v228
    v_rcp_f32 v229, v229
    v_rcp_f32 v230, v230
    v_rcp_f32 v231, v231
    v_pk_mul_f32 v[56:57], v[56:57], v[224:225]
    v_pk_mul_f32 v[58:59], v[58:59], v[226:227]
    v_pk_mul_f32 v[60:61], v[60:61], v[228:229]
    v_pk_mul_f32 v[62:63], v[62:63], v[230:231]
    v_pk_add_f32 v[192:193], v[192:193], v[56:57]
    v_pk_fma_f32 v[196:197], v[56:57], v[56:57], v[196:197]
    v_pk_add_f32 v[194:195], v[194:195], v[58:59]
    v_pk_fma_f32 v[198:199], v[58:59], v[58:59], v[198:199]
    v_pk_add_f32 v[200:201], v[200:201], v[60:61]
    v_pk_fma_f32 v[204:205], v[60:61], v[60:61], v[204:205]
    v_pk_add_f32 v[202:203], v[202:203], v[62:63]
    s_add_u32 m0, s73, 14080
    s_nop 0
    buffer_load_dwordx4 v31, s[28:31], s58 offen offset:256  lds
    v_pk_fma_f32 v[206:207], v[62:63], v[62:63], v[206:207]
    v_pk_mul_f32 v[224:225], v[176:177], v[188:189] op_sel_hi:[1,0]
    v_pk_mul_f32 v[226:227], v[178:179], v[188:189] op_sel_hi:[1,0]
    v_pk_mul_f32 v[228:229], v[180:181], v[188:189] op_sel_hi:[1,0]
    v_pk_mul_f32 v[230:231], v[182:183], v[188:189] op_sel_hi:[1,0]
    v_pk_fma_f32 v[72:73], v[160:161], v[72:73], v[224:225]
    v_pk_fma_f32 v[74:75], v[162:163], v[74:75], v[226:227]
    v_pk_fma_f32 v[76:77], v[164:165], v[76:77], v[228:229]
    v_pk_fma_f32 v[78:79], v[166:167], v[78:79], v[230:231]
    v_pk_mul_f32 v[224:225], v[72:73], v[72:73]
    v_pk_mul_f32 v[226:227], v[74:75], v[74:75]
    v_pk_mul_f32 v[228:229], v[76:77], v[76:77]
    v_pk_mul_f32 v[230:231], v[78:79], v[78:79]
    v_pk_fma_f32 v[224:225], v[224:225], v[250:251], v[250:251] op_sel:[0,1,0] op_sel_hi:[1,1,0]
    v_pk_fma_f32 v[226:227], v[226:227], v[250:251], v[250:251] op_sel:[0,1,0] op_sel_hi:[1,1,0]
    v_pk_fma_f32 v[228:229], v[228:229], v[250:251], v[250:251] op_sel:[0,1,0] op_sel_hi:[1,1,0]
    v_pk_fma_f32 v[230:231], v[230:231], v[250:251], v[250:251] op_sel:[0,1,0] op_sel_hi:[1,1,0]
    v_pk_mul_f32 v[224:225], v[224:225], v[72:73]
    v_pk_mul_f32 v[226:227], v[226:227], v[74:75]
    v_pk_mul_f32 v[228:229], v[228:229], v[76:77]
    v_pk_mul_f32 v[230:231], v[230:231], v[78:79]
    v_exp_f32 v224, v224
    v_exp_f32 v225, v225
    s_add_u32 m0, s73, 15104
    s_nop 0
    buffer_load_dwordx4 v23, s[28:31], s72 offen offset:256  lds
    v_exp_f32 v226, v226
    v_exp_f32 v227, v227
    v_exp_f32 v228, v228
    v_exp_f32 v229, v229
    v_exp_f32 v230, v230
    v_exp_f32 v231, v231
    v_pk_add_f32 v[224:225], v[224:225], 1.0 op_sel_hi:[1,0]
    v_pk_add_f32 v[226:227], v[226:227], 1.0 op_sel_hi:[1,0]
    v_pk_add_f32 v[228:229], v[228:229], 1.0 op_sel_hi:[1,0]
    v_pk_add_f32 v[230:231], v[230:231], 1.0 op_sel_hi:[1,0]
    v_rcp_f32 v224, v224
    v_rcp_f32 v225, v225
    v_rcp_f32 v226, v226
    v_rcp_f32 v227, v227
    v_rcp_f32 v228, v228
    s_add_u32 m0, s73, 16128
    s_nop 0
    buffer_load_dwordx4 v31, s[28:31], s72 offen offset:256  lds
    v_rcp_f32 v229, v229
    v_rcp_f32 v230, v230
    v_rcp_f32 v231, v231
    v_pk_mul_f32 v[72:73], v[72:73], v[224:225]
    v_pk_mul_f32 v[74:75], v[74:75], v[226:227]
    v_pk_mul_f32 v[76:77], v[76:77], v[228:229]
    v_pk_mul_f32 v[78:79], v[78:79], v[230:231]
    v_pk_add_f32 v[192:193], v[192:193], v[72:73]
    v_pk_fma_f32 v[196:197], v[72:73], v[72:73], v[196:197]
    v_pk_add_f32 v[194:195], v[194:195], v[74:75]
    v_pk_fma_f32 v[198:199], v[74:75], v[74:75], v[198:199]
    v_pk_add_f32 v[200:201], v[200:201], v[76:77]
    v_pk_fma_f32 v[204:205], v[76:77], v[76:77], v[204:205]
    v_pk_add_f32 v[202:203], v[202:203], v[78:79]
    v_pk_fma_f32 v[206:207], v[78:79], v[78:79], v[206:207]
    v_add_f32_dpp v192, v192, v192 row_mirror row_mask:0xf bank_mask:0x3
    v_add_f32_dpp v193, v193, v193 row_mirror row_mask:0xf bank_mask:0x3
    v_add_f32_dpp v194, v194, v194 row_mirror row_mask:0xf bank_mask:0x3
    v_add_f32_dpp v195, v195, v195 row_mirror row_mask:0xf bank_mask:0x3
    v_add_f32_dpp v196, v196, v196 row_mirror row_mask:0xf bank_mask:0x3
    v_add_f32_dpp v197, v197, v197 row_mirror row_mask:0xf bank_mask:0x3
    v_add_f32_dpp v198, v198, v198 row_mirror row_mask:0xf bank_mask:0x3
    s_add_u32 m0, s73, 16896
    s_nop 0
    buffer_load_dwordx4 v23, s[28:31], s83 offen offset:512  lds
    v_add_f32_dpp v199, v199, v199 row_mirror row_mask:0xf bank_mask:0x3
    v_add_f32_dpp v192, v200, v200 row_mirror row_mask:0xf bank_mask:0xc
    v_add_f32_dpp v193, v201, v201 row_mirror row_mask:0xf bank_mask:0xc
    v_add_f32_dpp v194, v202, v202 row_mirror row_mask:0xf bank_mask:0xc
    v_add_f32_dpp v195, v203, v203 row_mirror row_mask:0xf bank_mask:0xc
    v_add_f32_dpp v196, v204, v204 row_mirror row_mask:0xf bank_mask:0xc
    v_add_f32_dpp v197, v205, v205 row_mirror row_mask:0xf bank_mask:0xc
    v_add_f32_dpp v198, v206, v206 row_mirror row_mask:0xf bank_mask:0xc
    v_add_f32_dpp v199, v207, v207 row_mirror row_mask:0xf bank_mask:0xc
    v_add_f32_dpp v192, v192, v192 row_half_mirror row_mask:0xf bank_mask:0x5
    v_add_f32_dpp v193, v193, v193 row_half_mirror row_mask:0xf bank_mask:0x5
    v_add_f32_dpp v194, v194, v194 row_half_mirror row_mask:0xf bank_mask:0x5
    v_add_f32_dpp v195, v195, v195 row_half_mirror row_mask:0xf bank_mask:0x5
    v_add_f32_dpp v192, v196, v196 row_half_mirror row_mask:0xf bank_mask:0xa
    v_add_f32_dpp v193, v197, v197 row_half_mirror row_mask:0xf bank_mask:0xa
    v_add_f32_dpp v194, v198, v198 row_half_mirror row_mask:0xf bank_mask:0xa
    v_add_f32_dpp v195, v199, v199 row_half_mirror row_mask:0xf bank_mask:0xa
    v_add_f32_dpp v192, v192, v192 quad_perm:[1,0,3,2] row_mask:0xf bank_mask:0xf
    v_add_f32_dpp v193, v193, v193 quad_perm:[1,0,3,2] row_mask:0xf bank_mask:0xf
    v_add_f32_dpp v194, v194, v194 quad_perm:[1,0,3,2] row_mask:0xf bank_mask:0xf
    v_add_f32_dpp v195, v195, v195 quad_perm:[1,0,3,2] row_mask:0xf bank_mask:0xf
    v_add_f32_dpp v192, v192, v192 quad_perm:[2,3,0,1] row_mask:0xf bank_mask:0xf
    v_add_f32_dpp v193, v193, v193 quad_perm:[2,3,0,1] row_mask:0xf bank_mask:0xf
    v_add_f32_dpp v194, v194, v194 quad_perm:[2,3,0,1] row_mask:0xf bank_mask:0xf
    v_add_f32_dpp v195, v195, v195 quad_perm:[2,3,0,1] row_mask:0xf bank_mask:0xf
    s_add_u32 m0, s73, 17920
    s_nop 0
    buffer_load_dwordx4 v31, s[28:31], s83 offen offset:512  lds
    ds_write_b128 v241, v[192:195] offset:5120
    s_waitcnt lgkmcnt(0)
    s_barrier
    ds_read_b32 v246, v243 offset:5120
    ds_read_b32 v248, v243 offset:5376
    ds_read_b32 v135, v243 offset:5632
    ds_read_b32 v136, v243 offset:5888
    buffer_load_dwordx4 v[208:211], v134, s[32:35], s66 offen offset:0 sc1
    buffer_load_dwordx4 v[212:215], v134, s[32:35], s67 offen offset:0 sc1
    buffer_load_dwordx4 v[216:219], v134, s[32:35], s68 offen offset:0 sc1
    buffer_load_dwordx4 v[220:223], v134, s[32:35], s69 offen offset:0 sc1
    s_waitcnt lgkmcnt(0)
    v_add_f32 v246, v246, v135
    v_add_f32 v248, v248, v136
    s_mov_b64 exec, 0xffff
    buffer_store_dwordx4 v[246:249], v20, s[32:35], s63 offen offset:1024 sc1
    s_mov_b64 exec, -1
    v_pk_mul_f32 v[224:225], v[152:153], v[236:237] op_sel_hi:[1,0]
    v_pk_mul_f32 v[226:227], v[154:155], v[236:237] op_sel_hi:[1,0]
    v_pk_mul_f32 v[228:229], v[152:153], v[236:237] op_sel:[0,1]
    v_pk_mul_f32 v[230:231], v[154:155], v[236:237] op_sel:[0,1]
    v_pk_fma_f32 v[80:81], v[80:81], v[232:233], v[224:225] op_sel_hi:[1,0,1]
    v_pk_fma_f32 v[82:83], v[82:83], v[232:233], v[226:227] op_sel_hi:[1,0,1]
    v_pk_fma_f32 v[84:85], v[84:85], v[232:233], v[228:229] op_sel:[0,1,0]
    v_pk_fma_f32 v[86:87], v[86:87], v[232:233], v[230:231] op_sel:[0,1,0]
    v_pk_mul_f32 v[224:225], v[80:81], v[80:81]
    v_pk_mul_f32 v[226:227], v[82:83], v[82:83]
    v_pk_mul_f32 v[228:229], v[84:85], v[84:85]
    v_pk_mul_f32 v[230:231], v[86:87], v[86:87]
    v_pk_fma_f32 v[224:225], v[224:225], v[250:251], v[250:251] op_sel:[0,1,0] op_sel_hi:[1,1,0]
    v_pk_fma_f32 v[226:227], v[226:227], v[250:251], v[250:251] op_sel:[0,1,0] op_sel_hi:[1,1,0]
    v_pk_fma_f32 v[228:229], v[228:229], v[250:251], v[250:251] op_sel:[0,1,0] op_sel_hi:[1,1,0]
    v_pk_fma_f32 v[230:231], v[230:231], v[250:251], v[250:251] op_sel:[0,1,0] op_sel_hi:[1,1,0]
    v_pk_mul_f32 v[224:225], v[224:225], v[80:81]
    v_pk_mul_f32 v[226:227], v[226:227], v[82:83]
    s_add_u32 m0, s73, 18944
    s_nop 0
    buffer_load_dwordx4 v23, s[28:31], s27 offen offset:512  lds
    v_pk_mul_f32 v[228:229], v[228:229], v[84:85]
    v_pk_mul_f32 v[230:231], v[230:231], v[86:87]
    v_exp_f32 v224, v224
    v_exp_f32 v225, v225
    v_exp_f32 v226, v226
    v_exp_f32 v227, v227
    v_exp_f32 v228, v228
    v_exp_f32 v229, v229
    v_exp_f32 v230, v230
    v_exp_f32 v231, v231
    v_pk_add_f32 v[224:225], v[224:225], 1.0 op_sel_hi:[1,0]
    v_pk_add_f32 v[226:227], v[226:227], 1.0 op_sel_hi:[1,0]
    s_add_u32 m0, s73, 19968
    s_nop 0
    buffer_load_dwordx4 v31, s[28:31], s27 offen offset:512  lds
    v_pk_add_f32 v[228:229], v[228:229], 1.0 op_sel_hi:[1,0]
    v_pk_add_f32 v[230:231], v[230:231], 1.0 op_sel_hi:[1,0]
    v_rcp_f32 v224, v224
    v_rcp_f32 v225, v225
    v_rcp_f32 v226, v226
    v_rcp_f32 v227, v227
    v_rcp_f32 v228, v228
    v_rcp_f32 v229, v229
    v_rcp_f32 v230, v230
    v_rcp_f32 v231, v231
    v_pk_mul_f32 v[80:81], v[80:81], v[224:225]
    v_pk_mul_f32 v[82:83], v[82:83], v[226:227]
    s_add_u32 m0, s73, 20992
    s_nop 0
    buffer_load_dwordx4 v23, s[28:31], s58 offen offset:512  lds
    v_pk_mul_f32 v[84:85], v[84:85], v[228:229]
    v_pk_mul_f32 v[86:87], v[86:87], v[230:231]
    v_cvt_pk_bf16_f32 v80, v80, v81
    v_cvt_pk_bf16_f32 v81, v82, v83
    v_cvt_pk_bf16_f32 v82, v84, v85
    v_cvt_pk_bf16_f32 v83, v86, v87
    buffer_store_dwordx4 v[80:83], v20, s[36:39], s65 offen offset:0 sc1
    s_add_u32 m0, s73, 22016
    s_nop 0
    buffer_load_dwordx4 v31, s[28:31], s58 offen offset:512  lds
    s_add_u32 m0, s73, 23040
    s_nop 0
    buffer_load_dwordx4 v23, s[28:31], s72 offen offset:512  lds
    s_add_u32 m0, s73, 24064
    s_nop 0
    buffer_load_dwordx4 v31, s[28:31], s72 offen offset:512  lds
    s_add_u32 m0, s73, 24832
    s_nop 0
    buffer_load_dwordx4 v23, s[28:31], s83 offen offset:768  lds
    s_waitcnt vmcnt(9)
    v_xor_b32 v209, s49, v209
    v_xor_b32 v211, s49, v211
    v_xor_b32 v213, s49, v213
    v_xor_b32 v215, s49, v215
    v_xor_b32 v217, s49, v217
    v_xor_b32 v219, s49, v219
    v_xor_b32 v221, s49, v221
    v_xor_b32 v223, s49, v223
    v_or3_b32 v209, v209, v211, v213
    v_or3_b32 v215, v215, v217, v219
    v_or3_b32 v209, v209, v221, v223
    v_or_b32 v209, v209, v215
    v_cmp_ne_u32 vcc, 0, v209
    s_nop 3
    s_cbranch_vccnz L_F_B34_slow0
L_F_B34_slow0_go:
    v_add_f32 v208, v208, v212
    v_add_f32 v210, v210, v214
    v_add_f32 v216, v216, v220
    v_add_f32 v218, v218, v222
    v_add_f32 v208, v208, v216
    v_add_f32 v209, v210, v218
    v_mov_b32 v210, v208
    v_mov_b32 v211, v209
    s_nop 0
    v_permlane32_swap_b32 v208, v210
    v_permlane32_swap_b32 v209, v211
    v_add_f32 v208, v208, v210
    v_add_f32 v209, v209, v211
    v_mul_f32 v208, 0x3a924925, v208
    v_mul_f32 v209, 0x3a924925, v209
    v_fma_f32 v209, -v208, v208, v209
    v_max_f32 v209, 0, v209
    v_cvt_pk_bf16_f32 v209, v209, v209
    v_and_b32 v209, 0xffff0000, v209
    v_add_f32 v209, 0x3727c5ac, v209
    v_cvt_pk_bf16_f32 v209, v209, v209
    v_and_b32 v209, 0xffff0000, v209
    v_sqrt_f32 v209, v209
    v_cvt_pk_bf16_f32 v208, v208, v208
    v_and_b32 v208, 0xffff0000, v208
    v_cvt_pk_bf16_f32 v209, v209, v209
    v_and_b32 v209, 0xffff0000, v209
    v_rcp_f32 v209, v209
    s_nop 0
    v_mul_f32 v208, -v208, v209
    ds_write_b32 v132, v209 offset:6144
    ds_write_b32 v132, v208 offset:6400
    s_waitcnt lgkmcnt(0)
    ds_read_b128 v[192:195], v133 offset:6144
    ds_read_b128 v[200:203], v133 offset:6400
    ds_read_b128 v[196:199], v133 offset:6208
    ds_read_b128 v[204:207], v133 offset:6464
    s_waitcnt lgkmcnt(0)
    v_pk_fma_f32 v[32:33], v[32:33], v[192:193], v[200:201]
    v_pk_fma_f32 v[34:35], v[34:35], v[194:195], v[202:203]
    v_pk_fma_f32 v[36:37], v[36:37], v[196:197], v[204:205]
    v_pk_fma_f32 v[38:39], v[38:39], v[198:199], v[206:207]
    v_cvt_pk_bf16_f32 v32, v32, v33
    v_cvt_pk_bf16_f32 v33, v34, v35
    v_cvt_pk_bf16_f32 v34, v36, v37
    v_cvt_pk_bf16_f32 v35, v38, v39
    buffer_store_dwordx4 v[32:35], v20, s[40:43], s64 offen offset:0 sc1
    v_pk_fma_f32 v[48:49], v[48:49], v[192:193], v[200:201]
    v_pk_fma_f32 v[50:51], v[50:51], v[194:195], v[202:203]
    v_pk_fma_f32 v[52:53], v[52:53], v[196:197], v[204:205]
    v_pk_fma_f32 v[54:55], v[54:55], v[198:199], v[206:207]
    v_cvt_pk_bf16_f32 v48, v48, v49
    v_cvt_pk_bf16_f32 v49, v50, v51
    v_cvt_pk_bf16_f32 v50, v52, v53
    v_cvt_pk_bf16_f32 v51, v54, v55
    buffer_store_dwordx4 v[48:51], v20, s[40:43], s64 offen offset:1024 sc1
    v_pk_fma_f32 v[64:65], v[64:65], v[192:193], v[200:201]
    v_pk_fma_f32 v[66:67], v[66:67], v[194:195], v[202:203]
    v_pk_fma_f32 v[68:69], v[68:69], v[196:197], v[204:205]
    v_pk_fma_f32 v[70:71], v[70:71], v[198:199], v[206:207]
    v_cvt_pk_bf16_f32 v64, v64, v65
    v_cvt_pk_bf16_f32 v65, v66, v67
    v_cvt_pk_bf16_f32 v66, v68, v69
    v_cvt_pk_bf16_f32 v67, v70, v71
    buffer_store_dwordx4 v[64:67], v20, s[40:43], s64 offen offset:2048 sc1
    v_pk_mul_f32 v[224:225], v[152:153], v[238:239] op_sel_hi:[1,0]
    v_pk_mul_f32 v[226:227], v[154:155], v[238:239] op_sel_hi:[1,0]
    v_pk_mul_f32 v[228:229], v[152:153], v[238:239] op_sel:[0,1]
    v_pk_mul_f32 v[230:231], v[154:155], v[238:239] op_sel:[0,1]
    v_pk_fma_f32 v[88:89], v[88:89], v[234:235], v[224:225] op_sel_hi:[1,0,1]
    v_pk_fma_f32 v[90:91], v[90:91], v[234:235], v[226:227] op_sel_hi:[1,0,1]
    v_pk_fma_f32 v[92:93], v[92:93], v[234:235], v[228:229] op_sel:[0,1,0]
    v_pk_fma_f32 v[94:95], v[94:95], v[234:235], v[230:231] op_sel:[0,1,0]
    v_pk_mul_f32 v[224:225], v[88:89], v[88:89]
    v_pk_mul_f32 v[226:227], v[90:91], v[90:91]
    v_pk_mul_f32 v[228:229], v[92:93], v[92:93]
    v_pk_mul_f32 v[230:231], v[94:95], v[94:95]
    v_pk_fma_f32 v[224:225], v[224:225], v[250:251], v[250:251] op_sel:[0,1,0] op_sel_hi:[1,1,0]
    v_pk_fma_f32 v[226:227], v[226:227], v[250:251], v[250:251] op_sel:[0,1,0] op_sel_hi:[1,1,0]
    s_add_u32 m0, s73, 25856
    s_nop 0
    buffer_load_dwordx4 v31, s[28:31], s83 offen offset:768  lds
    v_pk_fma_f32 v[228:229], v[228:229], v[250:251], v[250:251] op_sel:[0,1,0] op_sel_hi:[1,1,0]
    v_pk_fma_f32 v[230:231], v[230:231], v[250:251], v[250:251] op_sel:[0,1,0] op_sel_hi:[1,1,0]
    v_pk_mul_f32 v[224:225], v[224:225], v[88:89]
    v_pk_mul_f32 v[226:227], v[226:227], v[90:91]
    v_pk_mul_f32 v[228:229], v[228:229], v[92:93]
    v_pk_mul_f32 v[230:231], v[230:231], v[94:95]
    v_exp_f32 v224, v224
    v_exp_f32 v225, v225
    v_exp_f32 v226, v226
    v_exp_f32 v227, v227
    v_exp_f32 v228, v228
    v_exp_f32 v229, v229
    v_exp_f32 v230, v230
    s_add_u32 m0, s73, 26880
    s_nop 0
    buffer_load_dwordx4 v23, s[28:31], s27 offen offset:768  lds
    v_exp_f32 v231, v231
    v_pk_add_f32 v[224:225], v[224:225], 1.0 op_sel_hi:[1,0]
    v_pk_add_f32 v[226:227], v[226:227], 1.0 op_sel_hi:[1,0]
    v_pk_add_f32 v[228:229], v[228:229], 1.0 op_sel_hi:[1,0]
    v_pk_add_f32 v[230:231], v[230:231], 1.0 op_sel_hi:[1,0]
    v_rcp_f32 v224, v224
    v_rcp_f32 v225, v225
    v_rcp_f32 v226, v226
    v_rcp_f32 v227, v227
    v_rcp_f32 v228, v228
    v_rcp_f32 v229, v229
    v_rcp_f32 v230, v230
    s_add_u32 m0, s73, 27904
    s_nop 0
    buffer_load_dwordx4 v31, s[28:31], s27 offen offset:768  lds
    v_rcp_f32 v231, v231
    v_pk_mul_f32 v[88:89], v[88:89], v[224:225]
    v_pk_mul_f32 v[90:91], v[90:91], v[226:227]
    v_pk_mul_f32 v[92:93], v[92:93], v[228:229]
    v_pk_mul_f32 v[94:95], v[94:95], v[230:231]
    v_cvt_pk_bf16_f32 v88, v88, v89
    v_cvt_pk_bf16_f32 v89, v90, v91
    v_cvt_pk_bf16_f32 v90, v92, v93
    v_cvt_pk_bf16_f32 v91, v94, v95
    buffer_store_dwordx4 v[88:91], v20, s[36:39], s70 offen offset:0 sc1
    s_add_u32 m0, s73, 28928
    s_nop 0
    buffer_load_dwordx4 v23, s[28:31], s58 offen offset:768  lds
    s_add_u32 m0, s73, 29952
    s_nop 0
    buffer_load_dwordx4 v31, s[28:31], s58 offen offset:768  lds
    s_add_u32 m0, s73, 30976
    s_nop 0
    buffer_load_dwordx4 v23, s[28:31], s72 offen offset:768  lds
    s_add_u32 m0, s73, 32000
    s_nop 0
    buffer_load_dwordx4 v31, s[28:31], s72 offen offset:768  lds
    ds_read_b64 a[160:161], v252 offset:1024
    ds_read_b64 a[162:163], v253 offset:1024
    ds_read_b64 a[164:165], v252 offset:3072
    ds_read_b64 a[166:167], v253 offset:3072
    ds_read_b64 a[168:169], v252 offset:5120
    ds_read_b64 a[170:171], v253 offset:5120
    ds_read_b64 a[172:173], v252 offset:7168
    ds_read_b64 a[174:175], v253 offset:7168
    ds_read_b64 a[176:177], v254 offset:1024
    ds_read_b64 a[178:179], v255 offset:1024
    ds_read_b64 a[180:181], v254 offset:3072
    ds_read_b64 a[182:183], v255 offset:3072
    ds_read_b64 a[184:185], v254 offset:5120
    ds_read_b64 a[186:187], v255 offset:5120
    ds_read_b64 a[188:189], v254 offset:7168
    ds_read_b64 a[190:191], v255 offset:7168
    ds_read_b64 a[192:193], v252 offset:9216
    ds_read_b64 a[194:195], v253 offset:9216
    ds_read_b64 a[196:197], v252 offset:11264
    ds_read_b64 a[198:199], v253 offset:11264
    ds_read_b64 a[200:201], v252 offset:13312
    ds_read_b64 a[202:203], v253 offset:13312
    ds_read_b64 a[204:205], v252 offset:15360
    ds_read_b64 a[206:207], v253 offset:15360
    ds_read_b64 a[208:209], v254 offset:9216
    ds_read_b64 a[210:211], v255 offset:9216
    ds_read_b64 a[212:213], v254 offset:11264
    ds_read_b64 a[214:215], v255 offset:11264
    ds_read_b64 a[216:217], v254 offset:13312
    ds_read_b64 a[218:219], v255 offset:13312
    ds_read_b64 a[220:221], v254 offset:15360
    ds_read_b64 a[222:223], v255 offset:15360
    s_waitcnt lgkmcnt(15)
    s_add_u32 m0, s73, 896
    s_nop 0
    buffer_load_dwordx4 v23, s[28:31], s83 offen offset:128  lds
    s_add_u32 m0, s73, 1920
    s_nop 0
    buffer_load_dwordx4 v31, s[28:31], s83 offen offset:128  lds
    s_add_u32 m0, s73, 2944
    s_nop 0
    buffer_load_dwordx4 v23, s[28:31], s27 offen offset:128  lds
    s_add_u32 m0, s73, 3968
    s_nop 0
    buffer_load_dwordx4 v31, s[28:31], s27 offen offset:128  lds
    s_add_u32 m0, s73, 4992
    s_nop 0
    buffer_load_dwordx4 v23, s[28:31], s58 offen offset:128  lds
    s_add_u32 m0, s73, 6016
    s_nop 0
    buffer_load_dwordx4 v31, s[28:31], s58 offen offset:128  lds
    s_add_u32 m0, s73, 7040
    s_nop 0
    buffer_load_dwordx4 v23, s[28:31], s72 offen offset:128  lds
    s_add_u32 m0, s73, 8064
    s_nop 0
    buffer_load_dwordx4 v31, s[28:31], s72 offen offset:128  lds
    buffer_load_dwordx4 v[208:211], v134, s[32:35], s66 offen offset:1024 sc1
    buffer_load_dwordx4 v[212:215], v134, s[32:35], s67 offen offset:1024 sc1
    buffer_load_dwordx4 v[216:219], v134, s[32:35], s68 offen offset:1024 sc1
    buffer_load_dwordx4 v[220:223], v134, s[32:35], s69 offen offset:1024 sc1
    s_waitcnt vmcnt(0)
    s_mov_b64 exec, 1
    buffer_store_dword v247, v22, s[44:47], s56 offen sc1
    s_mov_b64 exec, -1
    v_xor_b32 v209, s49, v209
    v_xor_b32 v211, s49, v211
    v_xor_b32 v213, s49, v213
    v_xor_b32 v215, s49, v215
    v_xor_b32 v217, s49, v217
    v_xor_b32 v219, s49, v219
    v_xor_b32 v221, s49, v221
    v_xor_b32 v223, s49, v223
    v_or3_b32 v209, v209, v211, v213
    v_or3_b32 v215, v215, v217, v219
    v_or3_b32 v209, v209, v221, v223
    v_or_b32 v209, v209, v215
    v_cmp_ne_u32 vcc, 0, v209
    s_nop 3
    s_cbranch_vccnz L_F_B34_slow1
L_F_B34_slow1_go:
    v_add_f32 v208, v208, v212
    v_add_f32 v210, v210, v214
    v_add_f32 v216, v216, v220
    v_add_f32 v218, v218, v222
    v_add_f32 v208, v208, v216
    v_add_f32 v209, v210, v218
    v_mov_b32 v210, v208
    v_mov_b32 v211, v209
    s_nop 0
    v_permlane32_swap_b32 v208, v210
    v_permlane32_swap_b32 v209, v211
    v_add_f32 v208, v208, v210
    v_add_f32 v209, v209, v211
    v_mul_f32 v208, 0x3a924925, v208
    v_mul_f32 v209, 0x3a924925, v209
    v_fma_f32 v209, -v208, v208, v209
    v_max_f32 v209, 0, v209
    v_cvt_pk_bf16_f32 v209, v209, v209
    v_and_b32 v209, 0xffff0000, v209
    v_add_f32 v209, 0x3727c5ac, v209
    v_cvt_pk_bf16_f32 v209, v209, v209
    v_and_b32 v209, 0xffff0000, v209
    v_sqrt_f32 v209, v209
    v_cvt_pk_bf16_f32 v208, v208, v208
    v_and_b32 v208, 0xffff0000, v208
    v_cvt_pk_bf16_f32 v209, v209, v209
    v_and_b32 v209, 0xffff0000, v209
    v_rcp_f32 v209, v209
    s_nop 0
    v_mul_f32 v208, -v208, v209
    ds_write_b32 v132, v209 offset:6144
    ds_write_b32 v132, v208 offset:6400
    s_waitcnt lgkmcnt(0)
    ds_read_b128 v[192:195], v133 offset:6144
    ds_read_b128 v[200:203], v133 offset:6400
    ds_read_b128 v[196:199], v133 offset:6208
    ds_read_b128 v[204:207], v133 offset:6464
    s_waitcnt lgkmcnt(0)
    v_pk_fma_f32 v[40:41], v[40:41], v[192:193], v[200:201]
    v_pk_fma_f32 v[42:43], v[42:43], v[194:195], v[202:203]
    v_pk_fma_f32 v[44:45], v[44:45], v[196:197], v[204:205]
    v_pk_fma_f32 v[46:47], v[46:47], v[198:199], v[206:207]
    v_cvt_pk_bf16_f32 v40, v40, v41
    v_cvt_pk_bf16_f32 v41, v42, v43
    v_cvt_pk_bf16_f32 v42, v44, v45
    v_cvt_pk_bf16_f32 v43, v46, v47
    buffer_store_dwordx4 v[40:43], v20, s[40:43], s62 offen offset:0 sc1
    v_pk_fma_f32 v[56:57], v[56:57], v[192:193], v[200:201]
    v_pk_fma_f32 v[58:59], v[58:59], v[194:195], v[202:203]
    v_pk_fma_f32 v[60:61], v[60:61], v[196:197], v[204:205]
    v_pk_fma_f32 v[62:63], v[62:63], v[198:199], v[206:207]
    v_cvt_pk_bf16_f32 v56, v56, v57
    v_cvt_pk_bf16_f32 v57, v58, v59
    v_cvt_pk_bf16_f32 v58, v60, v61
    v_cvt_pk_bf16_f32 v59, v62, v63
    buffer_store_dwordx4 v[56:59], v20, s[40:43], s62 offen offset:1024 sc1
    v_pk_fma_f32 v[72:73], v[72:73], v[192:193], v[200:201]
    v_pk_fma_f32 v[74:75], v[74:75], v[194:195], v[202:203]
    v_pk_fma_f32 v[76:77], v[76:77], v[196:197], v[204:205]
    v_pk_fma_f32 v[78:79], v[78:79], v[198:199], v[206:207]
    v_cvt_pk_bf16_f32 v72, v72, v73
    v_cvt_pk_bf16_f32 v73, v74, v75
    v_cvt_pk_bf16_f32 v74, v76, v77
    v_cvt_pk_bf16_f32 v75, v78, v79
    buffer_store_dwordx4 v[72:75], v20, s[40:43], s62 offen offset:2048 sc1
    v_pk_mul_f32 v[224:225], v[168:169], v[236:237] op_sel_hi:[1,0]
    v_pk_mul_f32 v[226:227], v[170:171], v[236:237] op_sel_hi:[1,0]
    v_pk_mul_f32 v[228:229], v[168:169], v[236:237] op_sel:[0,1]
    v_pk_mul_f32 v[230:231], v[170:171], v[236:237] op_sel:[0,1]
    v_pk_fma_f32 v[96:97], v[96:97], v[232:233], v[224:225] op_sel_hi:[1,0,1]
    v_pk_fma_f32 v[98:99], v[98:99], v[232:233], v[226:227] op_sel_hi:[1,0,1]
    v_pk_fma_f32 v[100:101], v[100:101], v[232:233], v[228:229] op_sel:[0,1,0]
    v_pk_fma_f32 v[102:103], v[102:103], v[232:233], v[230:231] op_sel:[0,1,0]
    v_pk_mul_f32 v[224:225], v[96:97], v[96:97]
    v_pk_mul_f32 v[226:227], v[98:99], v[98:99]
    ds_read_b64 a[224:225], v252 offset:17408
    ds_read_b64 a[226:227], v253 offset:17408
    ds_read_b64 a[228:229], v252 offset:19456
    ds_read_b64 a[230:231], v253 offset:19456
    ds_read_b64 a[232:233], v252 offset:21504
    ds_read_b64 a[234:235], v253 offset:21504
    ds_read_b64 a[236:237], v252 offset:23552
    ds_read_b64 a[238:239], v253 offset:23552
    v_pk_mul_f32 v[228:229], v[100:101], v[100:101]
    v_pk_mul_f32 v[230:231], v[102:103], v[102:103]
    v_pk_fma_f32 v[224:225], v[224:225], v[250:251], v[250:251] op_sel:[0,1,0] op_sel_hi:[1,1,0]
    v_pk_fma_f32 v[226:227], v[226:227], v[250:251], v[250:251] op_sel:[0,1,0] op_sel_hi:[1,1,0]
    v_pk_fma_f32 v[228:229], v[228:229], v[250:251], v[250:251] op_sel:[0,1,0] op_sel_hi:[1,1,0]
    v_pk_fma_f32 v[230:231], v[230:231], v[250:251], v[250:251] op_sel:[0,1,0] op_sel_hi:[1,1,0]
    v_pk_mul_f32 v[224:225], v[224:225], v[96:97]
    v_pk_mul_f32 v[226:227], v[226:227], v[98:99]
    v_pk_mul_f32 v[228:229], v[228:229], v[100:101]
    v_pk_mul_f32 v[230:231], v[230:231], v[102:103]
    v_exp_f32 v224, v224
    v_exp_f32 v225, v225
    v_exp_f32 v226, v226
    v_exp_f32 v227, v227
    v_exp_f32 v228, v228
    ds_read_b64 a[240:241], v254 offset:17408
    ds_read_b64 a[242:243], v255 offset:17408
    ds_read_b64 a[244:245], v254 offset:19456
    ds_read_b64 a[246:247], v255 offset:19456
    ds_read_b64 a[248:249], v254 offset:21504
    ds_read_b64 a[250:251], v255 offset:21504
    ds_read_b64 a[252:253], v254 offset:23552
    ds_read_b64 a[254:255], v255 offset:23552
    v_exp_f32 v229, v229
    v_exp_f32 v230, v230
    v_exp_f32 v231, v231
    v_pk_add_f32 v[224:225], v[224:225], 1.0 op_sel_hi:[1,0]
    v_pk_add_f32 v[226:227], v[226:227], 1.0 op_sel_hi:[1,0]
    v_pk_add_f32 v[228:229], v[228:229], 1.0 op_sel_hi:[1,0]
    v_pk_add_f32 v[230:231], v[230:231], 1.0 op_sel_hi:[1,0]
    v_rcp_f32 v224, v224
    v_rcp_f32 v225, v225
    v_rcp_f32 v226, v226
    v_rcp_f32 v227, v227
    v_rcp_f32 v228, v228
    s_add_u32 m0, s73, 8832
    s_nop 0
    buffer_load_dwordx4 v23, s[28:31], s83 offen offset:384  lds
    v_rcp_f32 v229, v229
    v_rcp_f32 v230, v230
    v_rcp_f32 v231, v231
    v_pk_mul_f32 v[96:97], v[96:97], v[224:225]
    v_pk_mul_f32 v[98:99], v[98:99], v[226:227]
    v_pk_mul_f32 v[100:101], v[100:101], v[228:229]
    v_pk_mul_f32 v[102:103], v[102:103], v[230:231]
    v_cvt_pk_bf16_f32 v96, v96, v97
    v_cvt_pk_bf16_f32 v97, v98, v99
    v_cvt_pk_bf16_f32 v98, v100, v101
    v_cvt_pk_bf16_f32 v99, v102, v103
    buffer_store_dwordx4 v[96:99], v20, s[36:39], s65 offen offset:1024 sc1
    v_pk_mul_f32 v[224:225], v[168:169], v[238:239] op_sel_hi:[1,0]
    v_pk_mul_f32 v[226:227], v[170:171], v[238:239] op_sel_hi:[1,0]
    v_pk_mul_f32 v[228:229], v[168:169], v[238:239] op_sel:[0,1]
    v_pk_mul_f32 v[230:231], v[170:171], v[238:239] op_sel:[0,1]
    v_pk_fma_f32 v[104:105], v[104:105], v[234:235], v[224:225] op_sel_hi:[1,0,1]
    v_pk_fma_f32 v[106:107], v[106:107], v[234:235], v[226:227] op_sel_hi:[1,0,1]
    s_add_u32 m0, s73, 9856
    s_nop 0
    buffer_load_dwordx4 v31, s[28:31], s83 offen offset:384  lds
    v_pk_fma_f32 v[108:109], v[108:109], v[234:235], v[228:229] op_sel:[0,1,0]
    v_pk_fma_f32 v[110:111], v[110:111], v[234:235], v[230:231] op_sel:[0,1,0]
    v_pk_mul_f32 v[224:225], v[104:105], v[104:105]
    v_pk_mul_f32 v[226:227], v[106:107], v[106:107]
    v_pk_mul_f32 v[228:229], v[108:109], v[108:109]
    v_pk_mul_f32 v[230:231], v[110:111], v[110:111]
    v_pk_fma_f32 v[224:225], v[224:225], v[250:251], v[250:251] op_sel:[0,1,0] op_sel_hi:[1,1,0]
    v_pk_fma_f32 v[226:227], v[226:227], v[250:251], v[250:251] op_sel:[0,1,0] op_sel_hi:[1,1,0]
    v_pk_fma_f32 v[228:229], v[228:229], v[250:251], v[250:251] op_sel:[0,1,0] op_sel_hi:[1,1,0]
    v_pk_fma_f32 v[230:231], v[230:231], v[250:251], v[250:251] op_sel:[0,1,0] op_sel_hi:[1,1,0]
    v_pk_mul_f32 v[224:225], v[224:225], v[104:105]
    v_pk_mul_f32 v[226:227], v[226:227], v[106:107]
    v_pk_mul_f32 v[228:229], v[228:229], v[108:109]
    v_pk_mul_f32 v[230:231], v[230:231], v[110:111]
    v_exp_f32 v224, v224
    v_exp_f32 v225, v225
    v_exp_f32 v226, v226
    s_add_u32 m0, s73, 10880
    s_nop 0
    buffer_load_dwordx4 v23, s[28:31], s27 offen offset:384  lds
    v_exp_f32 v227, v227
    v_exp_f32 v228, v228
    v_exp_f32 v229, v229
    v_exp_f32 v230, v230
    v_exp_f32 v231, v231
    v_pk_add_f32 v[224:225], v[224:225], 1.0 op_sel_hi:[1,0]
    v_pk_add_f32 v[226:227], v[226:227], 1.0 op_sel_hi:[1,0]
    v_pk_add_f32 v[228:229], v[228:229], 1.0 op_sel_hi:[1,0]
    v_pk_add_f32 v[230:231], v[230:231], 1.0 op_sel_hi:[1,0]
    v_rcp_f32 v224, v224
    v_rcp_f32 v225, v225
    v_rcp_f32 v226, v226
    s_add_u32 m0, s73, 11904
    s_nop 0
    buffer_load_dwordx4 v31, s[28:31], s27 offen offset:384  lds
    v_rcp_f32 v227, v227
    v_rcp_f32 v228, v228
    v_rcp_f32 v229, v229
    v_rcp_f32 v230, v230
    v_rcp_f32 v231, v231
    v_pk_mul_f32 v[104:105], v[104:105], v[224:225]
    v_pk_mul_f32 v[106:107], v[106:107], v[226:227]
    v_pk_mul_f32 v[108:109], v[108:109], v[228:229]
    v_pk_mul_f32 v[110:111], v[110:111], v[230:231]
    v_cvt_pk_bf16_f32 v104, v104, v105
    v_cvt_pk_bf16_f32 v105, v106, v107
    v_cvt_pk_bf16_f32 v106, v108, v109
    v_cvt_pk_bf16_f32 v107, v110, v111
    buffer_store_dwordx4 v[104:107], v20, s[36:39], s70 offen offset:1024 sc1
    s_add_u32 m0, s73, 12928
    s_nop 0
    buffer_load_dwordx4 v23, s[28:31], s58 offen offset:384  lds
    s_add_u32 m0, s73, 13952
    s_nop 0
    buffer_load_dwordx4 v31, s[28:31], s58 offen offset:384  lds
    s_add_u32 m0, s73, 14976
    s_nop 0
    buffer_load_dwordx4 v23, s[28:31], s72 offen offset:384  lds
    s_add_u32 m0, s73, 16000
    s_nop 0
    buffer_load_dwordx4 v31, s[28:31], s72 offen offset:384  lds
    ds_read_b64 a[128:129], v252 offset:25600
    ds_read_b64 a[130:131], v253 offset:25600
    ds_read_b64 a[132:133], v252 offset:27648
    ds_read_b64 a[134:135], v253 offset:27648
    ds_read_b64 a[136:137], v252 offset:29696
    ds_read_b64 a[138:139], v253 offset:29696
    ds_read_b64 a[140:141], v252 offset:31744
    ds_read_b64 a[142:143], v253 offset:31744
    ds_read_b64 a[144:145], v254 offset:25600
    ds_read_b64 a[146:147], v255 offset:25600
    ds_read_b64 a[148:149], v254 offset:27648
    ds_read_b64 a[150:151], v255 offset:27648
    ds_read_b64 a[152:153], v254 offset:29696
    ds_read_b64 a[154:155], v255 offset:29696
    ds_read_b64 a[156:157], v254 offset:31744
    ds_read_b64 a[158:159], v255 offset:31744
    s_waitcnt lgkmcnt(15)
    s_add_u32 m0, s73, 16768
    s_nop 0
    buffer_load_dwordx4 v23, s[28:31], s83 offen offset:640  lds
    s_add_u32 m0, s73, 17792
    s_nop 0
    buffer_load_dwordx4 v31, s[28:31], s83 offen offset:640  lds
    s_add_u32 m0, s73, 18816
    s_nop 0
    buffer_load_dwordx4 v23, s[28:31], s27 offen offset:640  lds
    s_add_u32 m0, s73, 19840
    s_nop 0
    buffer_load_dwordx4 v31, s[28:31], s27 offen offset:640  lds
    s_add_u32 m0, s73, 20864
    s_nop 0
    buffer_load_dwordx4 v23, s[28:31], s58 offen offset:640  lds
    s_add_u32 m0, s73, 21888
    s_nop 0
    buffer_load_dwordx4 v31, s[28:31], s58 offen offset:640  lds
    s_waitcnt vmcnt(16)
    s_mov_b64 exec, 1
    buffer_store_dword v247, v22, s[44:47], s57 offen sc1
    s_mov_b64 exec, -1
    s_add_u32 m0, s73, 22912
    s_nop 0
    buffer_load_dwordx4 v23, s[28:31], s72 offen offset:640  lds
    s_add_u32 m0, s73, 23936
    s_nop 0
    buffer_load_dwordx4 v31, s[28:31], s72 offen offset:640  lds
    s_waitcnt lgkmcnt(0)
    s_add_u32 m0, s73, 24704
    s_nop 0
    buffer_load_dwordx4 v23, s[28:31], s83 offen offset:896  lds
    s_add_u32 m0, s73, 25728
    s_nop 0
    buffer_load_dwordx4 v31, s[28:31], s83 offen offset:896  lds
    s_add_u32 m0, s73, 26752
    s_nop 0
    buffer_load_dwordx4 v23, s[28:31], s27 offen offset:896  lds
    s_add_u32 m0, s73, 27776
    s_nop 0
    buffer_load_dwordx4 v31, s[28:31], s27 offen offset:896  lds
    s_add_u32 s44, s24, 15466496
    s_addc_u32 s45, s25, 0
    s_mov_b32 s46, 196608
    s_mov_b32 s47, 0x20000
    s_lshl_b32 s100, s48, 13
    s_and_b32 s10, s2, 1
    s_lshl_b32 s10, s10, 10
    s_add_u32 s100, s100, s10
    s_mov_b32 s10, 0
    v_lshlrev_b32 v26, 11, v1
    v_lshl_add_u32 v26, v2, 6, v26
    buffer_load_dword v27, v26, s[44:47], s100 offen offset:0 sc1
    s_add_u32 m0, s73, 28800
    s_nop 0
    buffer_load_dwordx4 v23, s[28:31], s58 offen offset:896  lds
    s_add_u32 m0, s73, 29824
    s_nop 0
    buffer_load_dwordx4 v31, s[28:31], s58 offen offset:896  lds
    s_add_u32 m0, s73, 30848
    s_nop 0
    buffer_load_dwordx4 v23, s[28:31], s72 offen offset:896  lds
    s_add_u32 m0, s73, 31872
    s_nop 0
    buffer_load_dwordx4 v31, s[28:31], s72 offen offset:896  lds
    s_waitcnt vmcnt(4)
    v_cmp_ne_u32 vcc, s49, v27
    s_nop 3
    s_cbranch_vccnz L_F_ehB34
L_F_ehB34_go:
    v_add_u32 v6, 4096, v20
    s_bfe_u32 s75, s2, 0x20003
    s_and_b32 s11, s2, 1
    s_lshl_b32 s11, s11, 2
    s_add_u32 s75, s75, s11
    s_mul_i32 s75, s75, 7
    s_mul_i32 s11, s48, 896
    s_add_u32 s11, s11, s75
    s_lshl_b32 s11, s11, 10
    s_mov_b32 s32, s24
    s_mov_b32 s33, s25
    s_mov_b32 s34, 3670016
    s_mov_b32 s35, 0x20000
    s_add_u32 s75, s11, 0
    buffer_load_dwordx4 a[0:3], v20, s[32:35], s75 offen offset:0 sc1
    buffer_load_dwordx4 a[4:7], v20, s[32:35], s75 offen offset:1024 sc1
    buffer_load_dwordx4 a[8:11], v20, s[32:35], s75 offen offset:2048 sc1
    buffer_load_dwordx4 a[12:15], v20, s[32:35], s75 offen offset:3072 sc1
    buffer_load_dwordx4 a[16:19], v6, s[32:35], s75 offen offset:0 sc1
    buffer_load_dwordx4 a[20:23], v6, s[32:35], s75 offen offset:1024 sc1
    buffer_load_dwordx4 a[24:27], v6, s[32:35], s75 offen offset:2048 sc1
    s_add_u32 s75, s11, 57344
    buffer_load_dwordx4 a[28:31], v20, s[32:35], s75 offen offset:0 sc1
    buffer_load_dwordx4 a[32:35], v20, s[32:35], s75 offen offset:1024 sc1
    buffer_load_dwordx4 a[36:39], v20, s[32:35], s75 offen offset:2048 sc1
    buffer_load_dwordx4 a[40:43], v20, s[32:35], s75 offen offset:3072 sc1
    buffer_load_dwordx4 a[44:47], v6, s[32:35], s75 offen offset:0 sc1
    buffer_load_dwordx4 a[48:51], v6, s[32:35], s75 offen offset:1024 sc1
    buffer_load_dwordx4 a[52:55], v6, s[32:35], s75 offen offset:2048 sc1
    s_add_u32 s75, s11, 229376
    buffer_load_dwordx4 a[56:59], v20, s[32:35], s75 offen offset:0 sc1
    buffer_load_dwordx4 a[60:63], v20, s[32:35], s75 offen offset:1024 sc1
    buffer_load_dwordx4 a[64:67], v20, s[32:35], s75 offen offset:2048 sc1
    buffer_load_dwordx4 a[68:71], v20, s[32:35], s75 offen offset:3072 sc1
    buffer_load_dwordx4 a[72:75], v6, s[32:35], s75 offen offset:0 sc1
    buffer_load_dwordx4 a[76:79], v6, s[32:35], s75 offen offset:1024 sc1
    buffer_load_dwordx4 a[80:83], v6, s[32:35], s75 offen offset:2048 sc1
    s_lshl_b32 s59, s76, 3
    s_add_u32 s59, s59, s77
    s_lshl_b32 s59, s59, 5
    s_add_u32 s59, s59, 144
    s_lshl_b32 s60, s48, 2
    s_add_u32 s59, s59, s60
    s_add_u32 s59, s59, 65536
    s_branch L_F_p2A
L_F_A:
    v_mul_u32_u24 v14, 3584, v146
    v_add_u32 v14, v14, v144
    v_mul_u32_u24 v146, 3072, v146
    v_add_u32 v6, v146, v144
    s_mov_b32 s73, 51200
    s_mul_i32 s26, s48, 57344
    s_mul_i32 s66, s77, 448
    s_add_u32 s26, s26, s66
    s_lshl_b32 s66, s78, 7
    s_add_u32 s26, s26, s66
    s_lshl_b32 s66, s77, 1
    s_add_u32 s78, s78, s66
    s_mul_i32 s83, s48, 49152
    s_lshl_b32 s66, s78, 7
    s_add_u32 s83, s83, s66
    s_lshl_b32 s66, s48, 1
    v_add_u32 v144, s66, v1
    v_xor_b32 v144, v144, v3
    v_lshlrev_b32 v144, 4, v144
    v_lshl_add_u32 v7, v145, 10, v144
    s_lshl_b32 s27, s76, 7
    s_sub_u32 s27, s27, 16
    s_max_i32 s27, s27, 0
    s_lshl_b32 s66, s48, 2
    s_add_u32 s27, s27, s66
    s_lshl_b32 s27, s27, 10
    s_waitcnt lgkmcnt(0)
    s_mov_b32 s28, s4
    s_mov_b32 s29, s5
    s_mov_b32 s30, 2097152
    s_mov_b32 s31, 0x20000
    s_mov_b32 s32, s6
    s_mov_b32 s33, s7
    s_mov_b32 s34, 1572864
    s_mov_b32 s35, 0x20000
    s_mov_b32 s36, s12
    s_mov_b32 s37, s13
    s_mov_b32 s38, 1835008
    s_mov_b32 s39, 0x20000
    s_lshl_b32 s10, s48, 10
    s_add_u32 s74, s100, s3
    s_add_u32 s75, s100, s10
    s_add_u32 m0, s75, 18432
    s_nop 0
    buffer_load_dwordx4 v6, s[32:35], s83 offen offset:0 lds
    s_add_u32 m0, s75, 22464
    s_nop 0
    buffer_load_dwordx4 v6, s[32:35], s83 offen offset:64 lds
    s_add_u32 m0, s75, 25600
    s_nop 0
    buffer_load_dwordx4 v6, s[32:35], s83 offen offset:1024 lds
    s_add_u32 m0, s75, 29632
    s_nop 0
    buffer_load_dwordx4 v6, s[32:35], s83 offen offset:1088 lds
    s_add_u32 m0, s75, 32768
    s_nop 0
    buffer_load_dwordx4 v6, s[32:35], s83 offen offset:2048 lds
    s_add_u32 m0, s75, 36800
    s_nop 0
    buffer_load_dwordx4 v6, s[32:35], s83 offen offset:2112 lds
    s_add_u32 s83, s83, 196608
    s_add_u32 m0, s74, 2048
    s_nop 0
    buffer_load_dwordx4 v4, s[28:31], s81 offen lds
    s_add_u32 m0, s74, 3072
    s_nop 0
    buffer_load_dwordx4 v5, s[28:31], s81 offen lds
    s_add_u32 s81, s81, 128
    s_add_u32 m0, s75, 43008
    s_nop 0
    buffer_load_dwordx4 v14, s[36:39], s26 offen offset:0 lds
    s_add_u32 m0, s74, 4096
    s_nop 0
    buffer_load_dwordx4 v4, s[28:31], s82 offen lds
    s_add_u32 m0, s75, 47040
    s_nop 0
    buffer_load_dwordx4 v14, s[36:39], s26 offen offset:64 lds
    s_add_u32 s26, s26, 229376
    s_add_u32 m0, s74, 5120
    s_nop 0
    buffer_load_dwordx4 v5, s[28:31], s82 offen lds
    s_add_u32 s82, s82, 128
    s_lshr_b32 s60, s10, 1
    s_sub_u32 m0, s75, s60
    s_mov_b64 exec, 0xffffffff
    buffer_load_dwordx4 v7, s[28:31], s27 offen lds
    s_mov_b64 exec, -1
    s_add_u32 s27, s27, 128
    s_add_u32 s100, s100, 51200
    s_or_b32 s60, s2, s48
    s_cmp_lg_u32 s60, 0
    s_cbranch_scc1 L_F_A_nn
    s_memrealtime s[60:61]
    v_mov_b32 v144, 0
    s_waitcnt lgkmcnt(0)
    s_or_b32 s60, s60, 1
    v_mov_b32 v145, s60
    s_mov_b64 exec, 1
    global_store_dword v144, v145, s[22:23] sc1
    s_mov_b64 exec, -1
L_F_A_nn:
    v_lshrrev_b32 v144, 1, v2
    v_xor_b32 v144, v144, v1
    v_lshlrev_b32 v144, 4, v144
    v_lshl_add_u32 v144, v2, 7, v144
    v_and_b32 v146, 1, v1
    v_lshlrev_b32 v146, 1, v146
    v_bfe_u32 v145, v0, 1, 1
    v_xor_b32 v146, v146, v145
    v_lshlrev_b32 v146, 4, v146
    v_bfe_u32 v145, v0, 2, 2
    v_lshl_add_u32 v145, v1, 3, v145
    v_lshl_add_u32 v146, v145, 6, v146
    v_and_b32 v145, 1, v0
    v_lshl_add_u32 v146, v145, 3, v146
    v_mov_b32 v22, 0
    v_and_b32 v148, 7, v0
    v_xor_b32 v148, v148, v1
    v_lshlrev_b32 v148, 4, v148
    v_lshrrev_b32 v149, 3, v0
    v_lshl_add_u32 v23, v149, 12, v148
    v_xor_b32 v31, 64, v23
    v_add_u32 v31, 0x8000, v31
    v_mov_b32 v8, v144
    v_xor_b32 v11, 64, v144
    s_and_b32 s60, s48, 1
    s_lshl_b32 s60, s60, 5
    v_xor_b32 v146, s60, v146
    s_lshr_b32 s60, s48, 1
    s_lshl_b32 s60, s60, 12
    s_add_u32 s60, s60, 18432
    v_add_u32 v10, s60, v146
    v_add_u32 v13, 2048, v10
    s_add_u32 s74, s100, s3
    s_add_u32 s75, s100, s10
    s_add_u32 m0, s75, 18432
    s_nop 0
    buffer_load_dwordx4 v6, s[32:35], s83 offen offset:0 lds
    s_add_u32 m0, s75, 22464
    s_nop 0
    buffer_load_dwordx4 v6, s[32:35], s83 offen offset:64 lds
    s_add_u32 m0, s75, 25600
    s_nop 0
    buffer_load_dwordx4 v6, s[32:35], s83 offen offset:1024 lds
    s_add_u32 m0, s75, 29632
    s_nop 0
    buffer_load_dwordx4 v6, s[32:35], s83 offen offset:1088 lds
    s_add_u32 m0, s75, 32768
    s_nop 0
    buffer_load_dwordx4 v6, s[32:35], s83 offen offset:2048 lds
    s_add_u32 m0, s75, 36800
    s_nop 0
    buffer_load_dwordx4 v6, s[32:35], s83 offen offset:2112 lds
    s_add_u32 s83, s83, 196608
    s_add_u32 m0, s74, 2048
    s_nop 0
    buffer_load_dwordx4 v4, s[28:31], s81 offen lds
    s_add_u32 m0, s74, 3072
    s_nop 0
    buffer_load_dwordx4 v5, s[28:31], s81 offen lds
    s_add_u32 s81, s81, 128
    s_add_u32 m0, s75, 43008
    s_nop 0
    buffer_load_dwordx4 v14, s[36:39], s26 offen offset:0 lds
    s_add_u32 m0, s74, 4096
    s_nop 0
    buffer_load_dwordx4 v4, s[28:31], s82 offen lds
    s_add_u32 m0, s75, 47040
    s_nop 0
    buffer_load_dwordx4 v14, s[36:39], s26 offen offset:64 lds
    s_add_u32 s26, s26, 229376
    s_add_u32 m0, s74, 5120
    s_nop 0
    buffer_load_dwordx4 v5, s[28:31], s82 offen lds
    s_add_u32 s82, s82, 128
    s_lshr_b32 s60, s10, 1
    s_sub_u32 m0, s75, s60
    s_mov_b64 exec, 0xffffffff
    buffer_load_dwordx4 v7, s[28:31], s27 offen lds
    s_mov_b64 exec, -1
    s_add_u32 s27, s27, 128
    s_add_u32 s100, s100, 51200
    v_mov_b32 v24, 0x3f803f80
    v_mov_b32 v25, 0x3f803f80
    v_mov_b32 v26, 0x3f803f80
    v_mov_b32 v27, 0x3f803f80
    v_mov_b32 v32, 0
    v_mov_b32 v33, 0
    v_mov_b32 v34, 0
    v_mov_b32 v35, 0
    v_mov_b32 v36, 0
    v_mov_b32 v37, 0
    v_mov_b32 v38, 0
    v_mov_b32 v39, 0
    v_mov_b32 v40, 0
    v_mov_b32 v41, 0
    v_mov_b32 v42, 0
    v_mov_b32 v43, 0
    v_mov_b32 v44, 0
    v_mov_b32 v45, 0
    v_mov_b32 v46, 0
    v_mov_b32 v47, 0
    v_mov_b32 v48, 0
    v_mov_b32 v49, 0
    v_mov_b32 v50, 0
    v_mov_b32 v51, 0
    v_mov_b32 v52, 0
    v_mov_b32 v53, 0
    v_mov_b32 v54, 0
    v_mov_b32 v55, 0
    v_mov_b32 v56, 0
    v_mov_b32 v57, 0
    v_mov_b32 v58, 0
    v_mov_b32 v59, 0
    v_mov_b32 v60, 0
    v_mov_b32 v61, 0
    v_mov_b32 v62, 0
    v_mov_b32 v63, 0
    v_mov_b32 v64, 0
    v_mov_b32 v65, 0
    v_mov_b32 v66, 0
    v_mov_b32 v67, 0
    v_mov_b32 v68, 0
    v_mov_b32 v69, 0
    v_mov_b32 v70, 0
    v_mov_b32 v71, 0
    v_mov_b32 v72, 0
    v_mov_b32 v73, 0
    v_mov_b32 v74, 0
    v_mov_b32 v75, 0
    v_mov_b32 v76, 0
    v_mov_b32 v77, 0
    v_mov_b32 v78, 0
    v_mov_b32 v79, 0
    v_mov_b32 v80, 0
    v_mov_b32 v81, 0
    v_mov_b32 v82, 0
    v_mov_b32 v83, 0
    v_mov_b32 v84, 0
    v_mov_b32 v85, 0
    v_mov_b32 v86, 0
    v_mov_b32 v87, 0
    v_mov_b32 v88, 0
    v_mov_b32 v89, 0
    v_mov_b32 v90, 0
    v_mov_b32 v91, 0
    v_mov_b32 v92, 0
    v_mov_b32 v93, 0
    v_mov_b32 v94, 0
    v_mov_b32 v95, 0
    v_mov_b32 v96, 0
    v_mov_b32 v97, 0
    v_mov_b32 v98, 0
    v_mov_b32 v99, 0
    v_mov_b32 v100, 0
    v_mov_b32 v101, 0
    v_mov_b32 v102, 0
    v_mov_b32 v103, 0
    v_mov_b32 v104, 0
    v_mov_b32 v105, 0
    v_mov_b32 v106, 0
    v_mov_b32 v107, 0
    v_mov_b32 v108, 0
    v_mov_b32 v109, 0
    v_mov_b32 v110, 0
    v_mov_b32 v111, 0
    v_mov_b32 v112, 0
    v_mov_b32 v113, 0
    v_mov_b32 v114, 0
    v_mov_b32 v115, 0
    v_mov_b32 v116, 0
    v_mov_b32 v117, 0
    v_mov_b32 v118, 0
    v_mov_b32 v119, 0
    v_mov_b32 v120, 0
    v_mov_b32 v121, 0
    v_mov_b32 v122, 0
    v_mov_b32 v123, 0
    v_mov_b32 v124, 0
    v_mov_b32 v125, 0
    v_mov_b32 v126, 0
    v_mov_b32 v127, 0
    v_mov_b32 v128, 0
    v_mov_b32 v129, 0
    v_mov_b32 v130, 0
    v_mov_b32 v131, 0
    v_mov_b32 v132, 0
    v_mov_b32 v133, 0
    v_mov_b32 v134, 0
    v_mov_b32 v135, 0
    v_mov_b32 v220, 0
    v_mov_b32 v221, 0
    v_mov_b32 v222, 0
    v_mov_b32 v223, 0
    v_mov_b32 v224, 0
    v_mov_b32 v225, 0
    v_mov_b32 v226, 0
    v_mov_b32 v227, 0
    v_mov_b32 v228, 0
    v_mov_b32 v229, 0
    v_mov_b32 v230, 0
    v_mov_b32 v231, 0
    v_mov_b32 v232, 0
    v_mov_b32 v233, 0
    v_mov_b32 v234, 0
    v_mov_b32 v235, 0
    v_mov_b32 v236, 0
    v_mov_b32 v237, 0
    v_mov_b32 v238, 0
    v_mov_b32 v239, 0
    v_mov_b32 v240, 0
    v_mov_b32 v241, 0
    v_mov_b32 v242, 0
    v_mov_b32 v243, 0
    v_mov_b32 v244, 0
    v_mov_b32 v245, 0
    v_mov_b32 v246, 0
    v_mov_b32 v247, 0
    v_mov_b32 v248, 0
    v_mov_b32 v249, 0
    v_mov_b32 v250, 0
    v_mov_b32 v251, 0
    v_accvgpr_write_b32 a144, 0
    v_accvgpr_write_b32 a145, 0
    v_accvgpr_write_b32 a146, 0
    v_accvgpr_write_b32 a147, 0
    v_accvgpr_write_b32 a148, 0
    v_accvgpr_write_b32 a149, 0
    v_accvgpr_write_b32 a150, 0
    v_accvgpr_write_b32 a151, 0
    v_accvgpr_write_b32 a152, 0
    v_accvgpr_write_b32 a153, 0
    v_accvgpr_write_b32 a154, 0
    v_accvgpr_write_b32 a155, 0
    v_accvgpr_write_b32 a156, 0
    v_accvgpr_write_b32 a157, 0
    v_accvgpr_write_b32 a158, 0
    v_accvgpr_write_b32 a159, 0
    s_add_u32 s74, s100, s3
    s_add_u32 s75, s100, s10
    s_add_u32 m0, s75, 18432
    s_nop 0
    buffer_load_dwordx4 v6, s[32:35], s83 offen offset:0 lds
    s_add_u32 m0, s75, 22464
    s_nop 0
    buffer_load_dwordx4 v6, s[32:35], s83 offen offset:64 lds
    s_add_u32 m0, s75, 25600
    s_nop 0
    buffer_load_dwordx4 v6, s[32:35], s83 offen offset:1024 lds
    s_add_u32 m0, s75, 29632
    s_nop 0
    buffer_load_dwordx4 v6, s[32:35], s83 offen offset:1088 lds
    s_add_u32 m0, s75, 32768
    s_nop 0
    buffer_load_dwordx4 v6, s[32:35], s83 offen offset:2048 lds
    s_add_u32 m0, s75, 36800
    s_nop 0
    buffer_load_dwordx4 v6, s[32:35], s83 offen offset:2112 lds
    s_add_u32 s83, s83, 196608
    s_mov_b32 s100, 0
    s_lshr_b32 s60, s2, 3
    s_lshl_b32 s61, s60, 2
    s_add_u32 s66, s61, s48
    v_lshlrev_b32 v18, 10, v0
    s_and_b32 s61, s66, 15
    s_lshl_b32 s61, s61, 13
    s_lshl_b32 s58, s76, 17
    s_add_u32 s58, s58, s61
    s_add_u32 s58, s58, 384
    v_mul_u32_u24 v145, 86, v0
    v_lshrrev_b32 v145, 8, v145
    v_mul_u32_u24 v146, 3, v145
    v_sub_u32 v146, v0, v146
    v_and_b32 v147, 1, v145
    v_mul_u32_u24 v147, 3072, v147
    s_and_b32 s61, s76, 7
    s_lshl_b32 s61, s61, 3
    s_mul_i32 s62, s48, -14
    s_add_u32 s61, s61, s62
    s_mul_i32 s61, s61, 3072
    v_lshl_add_u32 v19, v146, 10, v147
    s_add_u32 s72, s61, s83
    s_mov_b64 exec, 0xff
    buffer_load_dword v28, v18, s[28:31], s58 offen
    s_mov_b64 exec, -1
    s_add_u32 s58, s58, 128
    s_mov_b64 exec, 63
    buffer_load_dword v28, v19, s[32:35], s72 offen
    s_mov_b64 exec, -1
    s_add_u32 s72, s72, 196608
    s_mov_b64 exec, 0xff
    buffer_load_dword v28, v18, s[28:31], s58 offen
    s_mov_b64 exec, -1
    s_add_u32 s58, s58, 128
    s_mov_b64 exec, 63
    buffer_load_dword v28, v19, s[32:35], s72 offen
    s_mov_b64 exec, -1
    s_add_u32 s72, s72, 196608
    s_mov_b32 s40, s14
    s_mov_b32 s41, s15
    s_mov_b32 s42, 8388608
    s_mov_b32 s43, 0x20000
    v_lshrrev_b32 v3, 2, v0
    v_and_b32 v145, 3, v0
    v_lshlrev_b32 v145, 10, v145
    v_lshl_add_u32 v3, v3, 12, v145
    s_bfe_u32 s59, s2, 0x20001
    s_lshl_b32 s59, s59, 21
    s_lshr_b32 s60, s2, 5
    s_lshl_b32 s60, s60, 1
    s_bfe_u32 s61, s2, 0x10003
    s_add_u32 s60, s60, s61
    s_lshl_b32 s60, s60, 2
    s_add_u32 s66, s60, s48
    s_lshl_b32 s66, s66, 15
    s_add_u32 s59, s59, s66
    s_add_u32 s44, s24, 15204352
    s_addc_u32 s45, s25, 0
    s_mov_b32 s46, 131072
    s_mov_b32 s47, 0x20000
    s_lshl_b32 s68, s76, 2
    s_add_u32 s68, s68, s77
    s_lshl_b32 s68, s68, 11
    s_mul_i32 s60, s48, 36
    v_add_u32 v165, s60, v0
    s_cmp_eq_u32 s76, 0
    s_cselect_b32 s61, 0, -6400
    v_lshlrev_b32 v164, 4, v165
    v_add_u32 v166, s61, v164
    v_add_u32 v164, -256, v164
    v_cmp_gt_u32 vcc, 16, v165
    s_nop 1
    v_cndmask_b32 v164, v164, v166, vcc
    v_add_u32 v164, s68, v164
    v_lshlrev_b32 v165, 2, v165
    v_add_u32 v165, 135168, v165
    s_mov_b32 s11, 0
    s_waitcnt vmcnt(23)
    s_barrier
    ds_read_b64_tr_b16 a[36:37], v10 offset:0
    ds_read_b64_tr_b16 a[38:39], v10 offset:256
    ds_read_b64_tr_b16 a[40:41], v10 offset:8192
    ds_read_b64_tr_b16 a[42:43], v10 offset:8448
    ds_read_b64_tr_b16 a[44:45], v10 offset:16384
    ds_read_b64_tr_b16 a[46:47], v10 offset:16640
    ds_read_b64_tr_b16 a[48:49], v10 offset:24576
    ds_read_b64_tr_b16 a[50:51], v10 offset:24832
    ds_read_b128 a[0:3], v8 offset:0
    ds_read_b128 a[4:7], v8 offset:2048
    ds_read_b128 a[8:11], v8 offset:4096
    ds_read_b128 a[12:15], v8 offset:6144
    ds_read_b128 a[16:19], v8 offset:8192
    ds_read_b128 a[20:23], v8 offset:10240
    ds_read_b128 a[24:27], v8 offset:12288
    ds_read_b128 a[28:31], v8 offset:14336
    ds_read_b128 a[32:35], v8 offset:16384
    s_waitcnt lgkmcnt(0)
    .p2align 6
L_F_A_loop:
    s_add_u32 m0, s74, 2048
    v_mfma_f32_16x16x32_bf16 v[64:67], a[40:43], a[0:3], v[64:67]
    buffer_load_dwordx4 v4, s[28:31], s81 offen lds
    ds_read_b64_tr_b16 a[96:97], v13 offset:0
    v_mfma_f32_16x16x32_bf16 v[100:103], a[0:3], a[44:47], v[100:103]
    ds_read_b64_tr_b16 a[98:99], v13 offset:256
    v_mfma_f32_16x16x32_bf16 v[32:35], a[36:39], a[4:7], v[32:35]
    ds_read_b64_tr_b16 a[100:101], v13 offset:8192
    v_mfma_f32_16x16x32_bf16 v[68:71], a[40:43], a[4:7], v[68:71]
    ds_read_b64_tr_b16 a[102:103], v13 offset:8448
    v_mfma_f32_16x16x32_bf16 v[104:107], a[4:7], a[44:47], v[104:107]
    ds_read_b64_tr_b16 a[104:105], v13 offset:16384
    s_add_u32 m0, s74, 3072
    v_mfma_f32_16x16x32_bf16 v[220:223], a[48:51], a[4:7], v[220:223]
    buffer_load_dwordx4 v5, s[28:31], s81 offen lds
    s_add_u32 s81, s81, 128
    ds_read_b64_tr_b16 a[106:107], v13 offset:16640
    v_mfma_f32_16x16x32_bf16 v[36:39], a[36:39], a[8:11], v[36:39]
    ds_read_b64_tr_b16 a[108:109], v13 offset:24576
    v_mfma_f32_16x16x32_bf16 v[72:75], a[40:43], a[8:11], v[72:75]
    ds_read_b64_tr_b16 a[110:111], v13 offset:24832
    v_mfma_f32_16x16x32_bf16 v[108:111], a[8:11], a[44:47], v[108:111]
    ds_read_b128 a[60:63], v11 offset:0
    v_mfma_f32_16x16x32_bf16 v[224:227], a[48:51], a[8:11], v[224:227]
    ds_read_b128 a[64:67], v11 offset:2048
    s_add_u32 m0, s75, 43008
    v_mfma_f32_16x16x32_bf16 v[40:43], a[36:39], a[12:15], v[40:43]
    buffer_load_dwordx4 v14, s[36:39], s26 offen offset:0 lds
    ds_read_b128 a[68:71], v11 offset:4096
    v_mfma_f32_16x16x32_bf16 v[76:79], a[40:43], a[12:15], v[76:79]
    ds_read_b128 a[72:75], v11 offset:6144
    v_mfma_f32_16x16x32_bf16 v[112:115], a[12:15], a[44:47], v[112:115]
    ds_read_b128 a[76:79], v11 offset:8192
    v_mfma_f32_16x16x32_bf16 v[228:231], a[48:51], a[12:15], v[228:231]
    ds_read_b128 a[80:83], v11 offset:10240
    v_mfma_f32_16x16x32_bf16 v[44:47], a[36:39], a[16:19], v[44:47]
    ds_read_b128 a[84:87], v11 offset:12288
    s_add_u32 m0, s74, 4096
    v_mfma_f32_16x16x32_bf16 v[80:83], a[40:43], a[16:19], v[80:83]
    buffer_load_dwordx4 v4, s[28:31], s82 offen lds
    ds_read_b128 a[88:91], v11 offset:14336
    v_mfma_f32_16x16x32_bf16 v[116:119], a[16:19], a[44:47], v[116:119]
    ds_read_b128 a[92:95], v11 offset:16384
    v_mfma_f32_16x16x32_bf16 v[232:235], a[48:51], a[16:19], v[232:235]
    s_cmp_eq_u32 s100, 102400
    s_cselect_b32 s101, -102400, s73
    v_mfma_f32_16x16x32_bf16 v[48:51], a[36:39], a[20:23], v[48:51]
    v_add_u32 v8, s101, v8
    v_mfma_f32_16x16x32_bf16 v[84:87], a[40:43], a[20:23], v[84:87]
    v_add_u32 v10, s101, v10
    v_mfma_f32_16x16x32_bf16 v[120:123], a[20:23], a[44:47], v[120:123]
    s_add_u32 m0, s75, 47040
    v_mfma_f32_16x16x32_bf16 v[236:239], a[48:51], a[20:23], v[236:239]
    buffer_load_dwordx4 v14, s[36:39], s26 offen offset:64 lds
    s_add_u32 s26, s26, 229376
    v_mfma_f32_16x16x32_bf16 v[52:55], a[36:39], a[24:27], v[52:55]
    v_mfma_f32_16x16x32_bf16 v[88:91], a[40:43], a[24:27], v[88:91]
    v_mfma_f32_16x16x32_bf16 v[124:127], a[24:27], a[44:47], v[124:127]
    v_mfma_f32_16x16x32_bf16 v[240:243], a[48:51], a[24:27], v[240:243]
    s_add_u32 m0, s74, 5120
    v_mfma_f32_16x16x32_bf16 v[56:59], a[36:39], a[28:31], v[56:59]
    buffer_load_dwordx4 v5, s[28:31], s82 offen lds
    s_add_u32 s82, s82, 128
    v_mfma_f32_16x16x32_bf16 v[92:95], a[40:43], a[28:31], v[92:95]
    v_mfma_f32_16x16x32_bf16 v[128:131], a[28:31], a[44:47], v[128:131]
    v_mfma_f32_16x16x32_bf16 v[244:247], a[48:51], a[28:31], v[244:247]
    v_mfma_f32_16x16x32_bf16 v[60:63], a[36:39], a[32:35], v[60:63]
    s_lshr_b32 s60, s10, 1
    s_sub_u32 m0, s75, s60
    v_mfma_f32_16x16x32_bf16 v[96:99], a[40:43], a[32:35], v[96:99]
    s_mov_b64 exec, 0xffffffff
    buffer_load_dwordx4 v7, s[28:31], s27 offen lds
    s_mov_b64 exec, -1
    s_add_u32 s27, s27, 128
    v_mfma_f32_16x16x32_bf16 v[132:135], a[32:35], a[44:47], v[132:135]
    v_mfma_f32_16x16x32_bf16 v[248:251], a[48:51], a[32:35], v[248:251]
    v_mfma_f32_16x16x32_bf16 a[144:147], v[24:27], a[36:39], a[144:147]
    v_mfma_f32_16x16x32_bf16 a[148:151], v[24:27], a[40:43], a[148:151]
    v_mfma_f32_16x16x32_bf16 a[152:155], v[24:27], a[44:47], a[152:155]
    v_mfma_f32_16x16x32_bf16 a[156:159], v[24:27], a[48:51], a[156:159]
    s_cmp_eq_u32 s11, 5
    s_waitcnt lgkmcnt(0)
    s_waitcnt vmcnt(16)
    s_barrier
    s_cbranch_scc1 L_F_A_five
    s_add_u32 s74, s100, s3
    s_add_u32 s75, s100, s10
    s_add_u32 m0, s75, 18432
    v_mfma_f32_16x16x32_bf16 v[64:67], a[100:103], a[60:63], v[64:67]
    buffer_load_dwordx4 v6, s[32:35], s83 offen offset:0 lds
    ds_read_b64_tr_b16 a[36:37], v10 offset:0
    v_mfma_f32_16x16x32_bf16 v[100:103], a[60:63], a[104:107], v[100:103]
    ds_read_b64_tr_b16 a[38:39], v10 offset:256
    v_mfma_f32_16x16x32_bf16 v[32:35], a[96:99], a[64:67], v[32:35]
    ds_read_b64_tr_b16 a[40:41], v10 offset:8192
    v_mfma_f32_16x16x32_bf16 v[68:71], a[100:103], a[64:67], v[68:71]
    ds_read_b64_tr_b16 a[42:43], v10 offset:8448
    s_add_u32 m0, s75, 22464
    v_mfma_f32_16x16x32_bf16 v[104:107], a[64:67], a[104:107], v[104:107]
    buffer_load_dwordx4 v6, s[32:35], s83 offen offset:64 lds
    ds_read_b64_tr_b16 a[44:45], v10 offset:16384
    v_mfma_f32_16x16x32_bf16 v[220:223], a[108:111], a[64:67], v[220:223]
    ds_read_b64_tr_b16 a[46:47], v10 offset:16640
    v_mfma_f32_16x16x32_bf16 v[36:39], a[96:99], a[68:71], v[36:39]
    ds_read_b64_tr_b16 a[48:49], v10 offset:24576
    v_mfma_f32_16x16x32_bf16 v[72:75], a[100:103], a[68:71], v[72:75]
    ds_read_b64_tr_b16 a[50:51], v10 offset:24832
    s_add_u32 m0, s75, 25600
    v_mfma_f32_16x16x32_bf16 v[108:111], a[68:71], a[104:107], v[108:111]
    buffer_load_dwordx4 v6, s[32:35], s83 offen offset:1024 lds
    ds_read_b128 a[0:3], v8 offset:0
    v_mfma_f32_16x16x32_bf16 v[224:227], a[108:111], a[68:71], v[224:227]
    ds_read_b128 a[4:7], v8 offset:2048
    v_mfma_f32_16x16x32_bf16 v[40:43], a[96:99], a[72:75], v[40:43]
    ds_read_b128 a[8:11], v8 offset:4096
    v_mfma_f32_16x16x32_bf16 v[76:79], a[100:103], a[72:75], v[76:79]
    ds_read_b128 a[12:15], v8 offset:6144
    s_add_u32 m0, s75, 29632
    v_mfma_f32_16x16x32_bf16 v[112:115], a[72:75], a[104:107], v[112:115]
    buffer_load_dwordx4 v6, s[32:35], s83 offen offset:1088 lds
    ds_read_b128 a[16:19], v8 offset:8192
    v_mfma_f32_16x16x32_bf16 v[228:231], a[108:111], a[72:75], v[228:231]
    ds_read_b128 a[20:23], v8 offset:10240
    v_mfma_f32_16x16x32_bf16 v[44:47], a[96:99], a[76:79], v[44:47]
    ds_read_b128 a[24:27], v8 offset:12288
    v_mfma_f32_16x16x32_bf16 v[80:83], a[100:103], a[76:79], v[80:83]
    ds_read_b128 a[28:31], v8 offset:14336
    s_add_u32 m0, s75, 32768
    v_mfma_f32_16x16x32_bf16 v[116:119], a[76:79], a[104:107], v[116:119]
    buffer_load_dwordx4 v6, s[32:35], s83 offen offset:2048 lds
    ds_read_b128 a[32:35], v8 offset:16384
    v_mfma_f32_16x16x32_bf16 v[232:235], a[108:111], a[76:79], v[232:235]
    v_add_u32 v11, s101, v11
    v_mfma_f32_16x16x32_bf16 v[48:51], a[96:99], a[80:83], v[48:51]
    v_add_u32 v13, s101, v13
    v_mfma_f32_16x16x32_bf16 v[84:87], a[100:103], a[80:83], v[84:87]
    s_add_u32 m0, s75, 36800
    v_mfma_f32_16x16x32_bf16 v[120:123], a[80:83], a[104:107], v[120:123]
    buffer_load_dwordx4 v6, s[32:35], s83 offen offset:2112 lds
    s_add_u32 s83, s83, 196608
    v_mfma_f32_16x16x32_bf16 v[236:239], a[108:111], a[80:83], v[236:239]
    v_mfma_f32_16x16x32_bf16 v[52:55], a[96:99], a[84:87], v[52:55]
    v_mfma_f32_16x16x32_bf16 v[88:91], a[100:103], a[84:87], v[88:91]
    v_mfma_f32_16x16x32_bf16 v[124:127], a[84:87], a[104:107], v[124:127]
    s_mov_b64 exec, 0xff
    buffer_load_dword v28, v18, s[28:31], s58 offen
    s_mov_b64 exec, -1
    s_add_u32 s58, s58, 128
    v_mfma_f32_16x16x32_bf16 v[240:243], a[108:111], a[84:87], v[240:243]
    v_mfma_f32_16x16x32_bf16 v[56:59], a[96:99], a[88:91], v[56:59]
    v_mfma_f32_16x16x32_bf16 v[92:95], a[100:103], a[88:91], v[92:95]
    v_mfma_f32_16x16x32_bf16 v[128:131], a[88:91], a[104:107], v[128:131]
    s_mov_b64 exec, 63
    buffer_load_dword v28, v19, s[32:35], s72 offen
    s_mov_b64 exec, -1
    s_add_u32 s72, s72, 196608
    v_mfma_f32_16x16x32_bf16 v[244:247], a[108:111], a[88:91], v[244:247]
    v_mfma_f32_16x16x32_bf16 v[60:63], a[96:99], a[92:95], v[60:63]
    v_mfma_f32_16x16x32_bf16 v[96:99], a[100:103], a[92:95], v[96:99]
    v_mfma_f32_16x16x32_bf16 v[132:135], a[92:95], a[104:107], v[132:135]
    s_sub_u32 s61, s11, 2
    s_cmp_eq_u32 s61, 3
    s_cselect_b32 s62, -896, 0
    s_add_u32 s62, s62, 256
    s_cmp_ge_u32 s61, 8
    s_cselect_b32 s61, 0x7fff0000, s59
    s_cselect_b32 s62, 0, s62
    s_mov_b64 exec, 0xffffffff
    buffer_load_dword v28, v3, s[40:43], s61 offen
    s_mov_b64 exec, -1
    s_add_u32 s59, s59, s62
    v_mfma_f32_16x16x32_bf16 v[248:251], a[108:111], a[92:95], v[248:251]
    v_mfma_f32_16x16x32_bf16 a[144:147], v[24:27], a[96:99], a[144:147]
    v_mfma_f32_16x16x32_bf16 a[148:151], v[24:27], a[100:103], a[148:151]
    v_mfma_f32_16x16x32_bf16 a[152:155], v[24:27], a[104:107], a[152:155]
    v_mfma_f32_16x16x32_bf16 a[156:159], v[24:27], a[108:111], a[156:159]
    s_add_u32 s100, s100, s101
    s_add_u32 s11, s11, 1
    s_cmp_lt_u32 s11, 8
    s_waitcnt lgkmcnt(0)
    s_branch L_F_A_loop
L_F_A_five:
    global_load_dword v21, v22, s[22:23] sc1
    s_and_b32 s66, s2, 7
    v_mfma_f32_16x16x32_bf16 v[64:67], a[100:103], a[60:63], v[64:67]
    ds_read_b64_tr_b16 a[36:37], v10 offset:0
    s_lshr_b32 s67, s2, 3
    s_lshr_b32 s64, s66, 1
    v_mfma_f32_16x16x32_bf16 v[100:103], a[60:63], a[104:107], v[100:103]
    ds_read_b64_tr_b16 a[38:39], v10 offset:256
    s_lshl_b32 s64, s64, 3
    s_lshr_b32 s68, s67, 2
    v_mfma_f32_16x16x32_bf16 v[32:35], a[96:99], a[64:67], v[32:35]
    ds_read_b64_tr_b16 a[40:41], v10 offset:8192
    s_add_u32 s64, s64, s68
    s_and_b32 s65, s66, 1
    v_mfma_f32_16x16x32_bf16 v[68:71], a[100:103], a[64:67], v[68:71]
    ds_read_b64_tr_b16 a[42:43], v10 offset:8448
    s_lshl_b32 s65, s65, 2
    s_and_b32 s68, s67, 3
    v_mfma_f32_16x16x32_bf16 v[104:107], a[64:67], a[104:107], v[104:107]
    ds_read_b64_tr_b16 a[44:45], v10 offset:16384
    s_add_u32 s65, s65, s68
    s_xor_b32 s66, s48, 0
    v_mfma_f32_16x16x32_bf16 v[220:223], a[108:111], a[64:67], v[220:223]
    ds_read_b64_tr_b16 a[46:47], v10 offset:16640
    s_lshl_b32 s67, s64, 2
    s_add_u32 s66, s66, s67
    v_mfma_f32_16x16x32_bf16 v[36:39], a[96:99], a[68:71], v[36:39]
    ds_read_b64_tr_b16 a[48:49], v10 offset:24576
    s_lshl_b32 s66, s66, 16
    s_lshl_b32 s67, s48, 10
    v_mfma_f32_16x16x32_bf16 v[72:75], a[100:103], a[68:71], v[72:75]
    ds_read_b64_tr_b16 a[50:51], v10 offset:24832
    s_add_u32 s83, s66, s67
    s_xor_b32 s66, s48, 1
    v_mfma_f32_16x16x32_bf16 v[108:111], a[68:71], a[104:107], v[108:111]
    ds_read_b128 a[0:3], v8 offset:0
    s_lshl_b32 s67, s64, 2
    s_add_u32 s66, s66, s67
    v_mfma_f32_16x16x32_bf16 v[224:227], a[108:111], a[68:71], v[224:227]
    ds_read_b128 a[4:7], v8 offset:2048
    s_lshl_b32 s66, s66, 16
    s_lshl_b32 s67, s48, 10
    v_mfma_f32_16x16x32_bf16 v[40:43], a[96:99], a[72:75], v[40:43]
    ds_read_b128 a[8:11], v8 offset:4096
    s_add_u32 s27, s66, s67
    s_xor_b32 s66, s48, 2
    v_mfma_f32_16x16x32_bf16 v[76:79], a[100:103], a[72:75], v[76:79]
    ds_read_b128 a[12:15], v8 offset:6144
    s_lshl_b32 s67, s64, 2
    s_add_u32 s66, s66, s67
    v_mfma_f32_16x16x32_bf16 v[112:115], a[72:75], a[104:107], v[112:115]
    ds_read_b128 a[16:19], v8 offset:8192
    s_lshl_b32 s66, s66, 16
    s_lshl_b32 s67, s48, 10
    v_mfma_f32_16x16x32_bf16 v[228:231], a[108:111], a[72:75], v[228:231]
    ds_read_b128 a[20:23], v8 offset:10240
    s_add_u32 s58, s66, s67
    s_xor_b32 s66, s48, 3
    v_mfma_f32_16x16x32_bf16 v[44:47], a[96:99], a[76:79], v[44:47]
    ds_read_b128 a[24:27], v8 offset:12288
    s_lshl_b32 s67, s64, 2
    s_add_u32 s66, s66, s67
    v_mfma_f32_16x16x32_bf16 v[80:83], a[100:103], a[76:79], v[80:83]
    ds_read_b128 a[28:31], v8 offset:14336
    s_lshl_b32 s66, s66, 16
    s_lshl_b32 s67, s48, 10
    v_mfma_f32_16x16x32_bf16 v[116:119], a[76:79], a[104:107], v[116:119]
    ds_read_b128 a[32:35], v8 offset:16384
    s_add_u32 s72, s66, s67
    s_mov_b32 s28, s14
    v_mfma_f32_16x16x32_bf16 v[232:235], a[108:111], a[76:79], v[232:235]
    v_add_u32 v11, s101, v11
    s_mov_b32 s29, s15
    s_mov_b32 s30, 8388608
    v_mfma_f32_16x16x32_bf16 v[48:51], a[96:99], a[80:83], v[48:51]
    v_add_u32 v13, s101, v13
    s_mov_b32 s31, 0x20000
    v_mfma_f32_16x16x32_bf16 v[84:87], a[100:103], a[80:83], v[84:87]
    s_lshl_b32 s74, s3, 1
    s_add_u32 s74, s74, s100
    s_add_u32 m0, s74, 0
    v_mfma_f32_16x16x32_bf16 v[120:123], a[80:83], a[104:107], v[120:123]
    buffer_load_dwordx4 v23, s[28:31], s83 offen lds
    s_add_u32 m0, s74, 1024
    v_mfma_f32_16x16x32_bf16 v[236:239], a[108:111], a[80:83], v[236:239]
    buffer_load_dwordx4 v31, s[28:31], s83 offen lds
    s_add_u32 s83, s83, 256
    v_mfma_f32_16x16x32_bf16 v[52:55], a[96:99], a[84:87], v[52:55]
    s_add_u32 m0, s74, 2048
    v_mfma_f32_16x16x32_bf16 v[88:91], a[100:103], a[84:87], v[88:91]
    buffer_load_dwordx4 v23, s[28:31], s27 offen lds
    v_mfma_f32_16x16x32_bf16 v[124:127], a[84:87], a[104:107], v[124:127]
    s_add_u32 m0, s74, 3072
    v_mfma_f32_16x16x32_bf16 v[240:243], a[108:111], a[84:87], v[240:243]
    buffer_load_dwordx4 v31, s[28:31], s27 offen lds
    s_add_u32 s27, s27, 256
    v_mfma_f32_16x16x32_bf16 v[56:59], a[96:99], a[88:91], v[56:59]
    s_add_u32 m0, s74, 4096
    v_mfma_f32_16x16x32_bf16 v[92:95], a[100:103], a[88:91], v[92:95]
    buffer_load_dwordx4 v23, s[28:31], s58 offen lds
    v_mfma_f32_16x16x32_bf16 v[128:131], a[88:91], a[104:107], v[128:131]
    s_add_u32 m0, s74, 5120
    v_mfma_f32_16x16x32_bf16 v[244:247], a[108:111], a[88:91], v[244:247]
    buffer_load_dwordx4 v31, s[28:31], s58 offen lds
    s_add_u32 s58, s58, 256
    v_mfma_f32_16x16x32_bf16 v[60:63], a[96:99], a[92:95], v[60:63]
    s_add_u32 m0, s74, 6144
    v_mfma_f32_16x16x32_bf16 v[96:99], a[100:103], a[92:95], v[96:99]
    buffer_load_dwordx4 v23, s[28:31], s72 offen lds
    v_mfma_f32_16x16x32_bf16 v[132:135], a[92:95], a[104:107], v[132:135]
    s_add_u32 m0, s74, 7168
    v_mfma_f32_16x16x32_bf16 v[248:251], a[108:111], a[92:95], v[248:251]
    buffer_load_dwordx4 v31, s[28:31], s72 offen lds
    s_add_u32 s72, s72, 256
    v_mfma_f32_16x16x32_bf16 a[144:147], v[24:27], a[96:99], a[144:147]
    v_mfma_f32_16x16x32_bf16 a[148:151], v[24:27], a[100:103], a[148:151]
    s_sub_u32 s61, s11, 2
    s_cmp_eq_u32 s61, 3
    s_cselect_b32 s62, -896, 0
    s_add_u32 s62, s62, 256
    s_cmp_ge_u32 s61, 8
    s_cselect_b32 s61, 0x7fff0000, s59
    s_cselect_b32 s62, 0, s62
    s_mov_b64 exec, 0xffffffff
    buffer_load_dword v28, v3, s[40:43], s61 offen
    s_mov_b64 exec, -1
    s_add_u32 s59, s59, s62
    v_mfma_f32_16x16x32_bf16 a[152:155], v[24:27], a[104:107], a[152:155]
    v_mfma_f32_16x16x32_bf16 a[156:159], v[24:27], a[108:111], a[156:159]
    s_add_u32 s100, s100, s101
    s_add_u32 s11, s11, 1
    s_cmp_lt_u32 s11, 8
    s_waitcnt lgkmcnt(0)
L_F_A_tail:
    v_mfma_f32_16x16x32_bf16 v[64:67], a[40:43], a[0:3], v[64:67]
    ds_read_b64_tr_b16 a[96:97], v13 offset:0
    v_mfma_f32_16x16x32_bf16 v[100:103], a[0:3], a[44:47], v[100:103]
    ds_read_b64_tr_b16 a[98:99], v13 offset:256
    v_mfma_f32_16x16x32_bf16 v[32:35], a[36:39], a[4:7], v[32:35]
    ds_read_b64_tr_b16 a[100:101], v13 offset:8192
    v_mfma_f32_16x16x32_bf16 v[68:71], a[40:43], a[4:7], v[68:71]
    ds_read_b64_tr_b16 a[102:103], v13 offset:8448
    v_mfma_f32_16x16x32_bf16 v[104:107], a[4:7], a[44:47], v[104:107]
    ds_read_b64_tr_b16 a[104:105], v13 offset:16384
    v_mfma_f32_16x16x32_bf16 v[220:223], a[48:51], a[4:7], v[220:223]
    ds_read_b64_tr_b16 a[106:107], v13 offset:16640
    v_mfma_f32_16x16x32_bf16 v[36:39], a[36:39], a[8:11], v[36:39]
    ds_read_b64_tr_b16 a[108:109], v13 offset:24576
    v_mfma_f32_16x16x32_bf16 v[72:75], a[40:43], a[8:11], v[72:75]
    ds_read_b64_tr_b16 a[110:111], v13 offset:24832
    v_mfma_f32_16x16x32_bf16 v[108:111], a[8:11], a[44:47], v[108:111]
    ds_read_b128 a[60:63], v11 offset:0
    v_mfma_f32_16x16x32_bf16 v[224:227], a[48:51], a[8:11], v[224:227]
    ds_read_b128 a[64:67], v11 offset:2048
    v_mfma_f32_16x16x32_bf16 v[40:43], a[36:39], a[12:15], v[40:43]
    ds_read_b128 a[68:71], v11 offset:4096
    v_mfma_f32_16x16x32_bf16 v[76:79], a[40:43], a[12:15], v[76:79]
    ds_read_b128 a[72:75], v11 offset:6144
    v_mfma_f32_16x16x32_bf16 v[112:115], a[12:15], a[44:47], v[112:115]
    ds_read_b128 a[76:79], v11 offset:8192
    v_mfma_f32_16x16x32_bf16 v[228:231], a[48:51], a[12:15], v[228:231]
    ds_read_b128 a[80:83], v11 offset:10240
    v_mfma_f32_16x16x32_bf16 v[44:47], a[36:39], a[16:19], v[44:47]
    ds_read_b128 a[84:87], v11 offset:12288
    v_mfma_f32_16x16x32_bf16 v[80:83], a[40:43], a[16:19], v[80:83]
    ds_read_b128 a[88:91], v11 offset:14336
    v_mfma_f32_16x16x32_bf16 v[116:119], a[16:19], a[44:47], v[116:119]
    ds_read_b128 a[92:95], v11 offset:16384
    v_mfma_f32_16x16x32_bf16 v[232:235], a[48:51], a[16:19], v[232:235]
    s_cmp_eq_u32 s100, 102400
    s_cselect_b32 s101, -102400, s73
    v_mfma_f32_16x16x32_bf16 v[48:51], a[36:39], a[20:23], v[48:51]
    v_add_u32 v8, s101, v8
    v_mfma_f32_16x16x32_bf16 v[84:87], a[40:43], a[20:23], v[84:87]
    v_add_u32 v10, s101, v10
    v_mfma_f32_16x16x32_bf16 v[120:123], a[20:23], a[44:47], v[120:123]
    v_mfma_f32_16x16x32_bf16 v[236:239], a[48:51], a[20:23], v[236:239]
    v_mfma_f32_16x16x32_bf16 v[52:55], a[36:39], a[24:27], v[52:55]
    v_mfma_f32_16x16x32_bf16 v[88:91], a[40:43], a[24:27], v[88:91]
    v_mfma_f32_16x16x32_bf16 v[124:127], a[24:27], a[44:47], v[124:127]
    v_mfma_f32_16x16x32_bf16 v[240:243], a[48:51], a[24:27], v[240:243]
    v_mfma_f32_16x16x32_bf16 v[56:59], a[36:39], a[28:31], v[56:59]
    v_mfma_f32_16x16x32_bf16 v[92:95], a[40:43], a[28:31], v[92:95]
    v_mfma_f32_16x16x32_bf16 v[128:131], a[28:31], a[44:47], v[128:131]
    v_mfma_f32_16x16x32_bf16 v[244:247], a[48:51], a[28:31], v[244:247]
    v_mfma_f32_16x16x32_bf16 v[60:63], a[36:39], a[32:35], v[60:63]
    v_mfma_f32_16x16x32_bf16 v[96:99], a[40:43], a[32:35], v[96:99]
    v_mfma_f32_16x16x32_bf16 v[132:135], a[32:35], a[44:47], v[132:135]
    v_mfma_f32_16x16x32_bf16 v[248:251], a[48:51], a[32:35], v[248:251]
    v_mfma_f32_16x16x32_bf16 a[144:147], v[24:27], a[36:39], a[144:147]
    v_mfma_f32_16x16x32_bf16 a[148:151], v[24:27], a[40:43], a[148:151]
    v_mfma_f32_16x16x32_bf16 a[152:155], v[24:27], a[44:47], a[152:155]
    v_mfma_f32_16x16x32_bf16 a[156:159], v[24:27], a[48:51], a[156:159]
    s_waitcnt lgkmcnt(0)
    s_waitcnt vmcnt(10)
    s_barrier
    s_lshl_b32 s74, s3, 1
    s_add_u32 s74, s74, s100
    s_add_u32 m0, s74, 0
    v_mfma_f32_16x16x32_bf16 v[64:67], a[100:103], a[60:63], v[64:67]
    buffer_load_dwordx4 v23, s[28:31], s83 offen lds
    ds_read_b64_tr_b16 a[36:37], v10 offset:0
    v_mfma_f32_16x16x32_bf16 v[100:103], a[60:63], a[104:107], v[100:103]
    ds_read_b64_tr_b16 a[38:39], v10 offset:256
    v_mfma_f32_16x16x32_bf16 v[32:35], a[96:99], a[64:67], v[32:35]
    ds_read_b64_tr_b16 a[40:41], v10 offset:8192
    v_mfma_f32_16x16x32_bf16 v[68:71], a[100:103], a[64:67], v[68:71]
    ds_read_b64_tr_b16 a[42:43], v10 offset:8448
    s_add_u32 m0, s74, 1024
    v_mfma_f32_16x16x32_bf16 v[104:107], a[64:67], a[104:107], v[104:107]
    buffer_load_dwordx4 v31, s[28:31], s83 offen lds
    s_add_u32 s83, s83, 256
    ds_read_b64_tr_b16 a[44:45], v10 offset:16384
    v_mfma_f32_16x16x32_bf16 v[220:223], a[108:111], a[64:67], v[220:223]
    ds_read_b64_tr_b16 a[46:47], v10 offset:16640
    v_mfma_f32_16x16x32_bf16 v[36:39], a[96:99], a[68:71], v[36:39]
    ds_read_b64_tr_b16 a[48:49], v10 offset:24576
    v_mfma_f32_16x16x32_bf16 v[72:75], a[100:103], a[68:71], v[72:75]
    ds_read_b64_tr_b16 a[50:51], v10 offset:24832
    s_add_u32 m0, s74, 2048
    v_mfma_f32_16x16x32_bf16 v[108:111], a[68:71], a[104:107], v[108:111]
    buffer_load_dwordx4 v23, s[28:31], s27 offen lds
    ds_read_b128 a[0:3], v8 offset:0
    v_mfma_f32_16x16x32_bf16 v[224:227], a[108:111], a[68:71], v[224:227]
    ds_read_b128 a[4:7], v8 offset:2048
    v_mfma_f32_16x16x32_bf16 v[40:43], a[96:99], a[72:75], v[40:43]
    ds_read_b128 a[8:11], v8 offset:4096
    v_mfma_f32_16x16x32_bf16 v[76:79], a[100:103], a[72:75], v[76:79]
    ds_read_b128 a[12:15], v8 offset:6144
    s_add_u32 m0, s74, 3072
    v_mfma_f32_16x16x32_bf16 v[112:115], a[72:75], a[104:107], v[112:115]
    buffer_load_dwordx4 v31, s[28:31], s27 offen lds
    s_add_u32 s27, s27, 256
    ds_read_b128 a[16:19], v8 offset:8192
    v_mfma_f32_16x16x32_bf16 v[228:231], a[108:111], a[72:75], v[228:231]
    ds_read_b128 a[20:23], v8 offset:10240
    v_mfma_f32_16x16x32_bf16 v[44:47], a[96:99], a[76:79], v[44:47]
    ds_read_b128 a[24:27], v8 offset:12288
    v_mfma_f32_16x16x32_bf16 v[80:83], a[100:103], a[76:79], v[80:83]
    ds_read_b128 a[28:31], v8 offset:14336
    s_add_u32 m0, s74, 4096
    v_mfma_f32_16x16x32_bf16 v[116:119], a[76:79], a[104:107], v[116:119]
    buffer_load_dwordx4 v23, s[28:31], s58 offen lds
    ds_read_b128 a[32:35], v8 offset:16384
    v_mfma_f32_16x16x32_bf16 v[232:235], a[108:111], a[76:79], v[232:235]
    v_add_u32 v11, s101, v11
    v_mfma_f32_16x16x32_bf16 v[48:51], a[96:99], a[80:83], v[48:51]
    v_add_u32 v13, s101, v13
    v_mfma_f32_16x16x32_bf16 v[84:87], a[100:103], a[80:83], v[84:87]
    s_add_u32 m0, s74, 5120
    v_mfma_f32_16x16x32_bf16 v[120:123], a[80:83], a[104:107], v[120:123]
    buffer_load_dwordx4 v31, s[28:31], s58 offen lds
    s_add_u32 s58, s58, 256
    v_mfma_f32_16x16x32_bf16 v[236:239], a[108:111], a[80:83], v[236:239]
    v_mfma_f32_16x16x32_bf16 v[52:55], a[96:99], a[84:87], v[52:55]
    v_mfma_f32_16x16x32_bf16 v[88:91], a[100:103], a[84:87], v[88:91]
    s_add_u32 m0, s74, 6144
    v_mfma_f32_16x16x32_bf16 v[124:127], a[84:87], a[104:107], v[124:127]
    buffer_load_dwordx4 v23, s[28:31], s72 offen lds
    v_mfma_f32_16x16x32_bf16 v[240:243], a[108:111], a[84:87], v[240:243]
    v_mfma_f32_16x16x32_bf16 v[56:59], a[96:99], a[88:91], v[56:59]
    v_mfma_f32_16x16x32_bf16 v[92:95], a[100:103], a[88:91], v[92:95]
    s_add_u32 m0, s74, 7168
    v_mfma_f32_16x16x32_bf16 v[128:131], a[88:91], a[104:107], v[128:131]
    buffer_load_dwordx4 v31, s[28:31], s72 offen lds
    s_add_u32 s72, s72, 256
    v_mfma_f32_16x16x32_bf16 v[244:247], a[108:111], a[88:91], v[244:247]
    v_mfma_f32_16x16x32_bf16 v[60:63], a[96:99], a[92:95], v[60:63]
    v_mfma_f32_16x16x32_bf16 v[96:99], a[100:103], a[92:95], v[96:99]
    v_mfma_f32_16x16x32_bf16 v[132:135], a[92:95], a[104:107], v[132:135]
    s_sub_u32 s61, s11, 2
    s_cmp_eq_u32 s61, 3
    s_cselect_b32 s62, -896, 0
    s_add_u32 s62, s62, 256
    s_cmp_ge_u32 s61, 8
    s_cselect_b32 s61, 0x7fff0000, s59
    s_cselect_b32 s62, 0, s62
    s_mov_b64 exec, 0xffffffff
    buffer_load_dword v28, v3, s[40:43], s61 offen
    s_mov_b64 exec, -1
    s_add_u32 s59, s59, s62
    v_mfma_f32_16x16x32_bf16 v[248:251], a[108:111], a[92:95], v[248:251]
    v_mfma_f32_16x16x32_bf16 a[144:147], v[24:27], a[96:99], a[144:147]
    v_mfma_f32_16x16x32_bf16 a[148:151], v[24:27], a[100:103], a[148:151]
    v_mfma_f32_16x16x32_bf16 a[152:155], v[24:27], a[104:107], a[152:155]
    v_mfma_f32_16x16x32_bf16 a[156:159], v[24:27], a[108:111], a[156:159]
    s_add_u32 s100, s100, s101
    s_add_u32 s11, s11, 1
    s_cmp_lt_u32 s11, 8
    s_waitcnt lgkmcnt(0)
    s_cbranch_scc1 L_F_A_tail
    s_mov_b32 exec_hi, 15
    buffer_load_dwordx4 v[160:163], v164, s[44:47], 0 offen sc1
    s_mov_b64 exec, -1
    s_mov_b32 s101, 0
    v_cmp_eq_u32 vcc, 0, v21
    s_nop 3
    s_cbranch_vccnz L_F_A_nspin
L_F_A_nspin_go:
    v_readfirstlane_b32 s49, v21
    s_barrier
    s_mov_b64 exec, 4294967295
    buffer_load_dword v28, v3, s[40:43], s59 offen
    s_mov_b64 exec, -1
    s_add_u32 s59, s59, 256
    s_mov_b64 exec, 4294967295
    buffer_load_dword v28, v3, s[40:43], s59 offen
    s_mov_b64 exec, -1
    s_add_u32 s59, s59, 256
    s_lshl_b32 s101, s48, 13
    s_mul_i32 s73, s48, 33792
    v_xor_b32 v3, v2, v1
    v_lshrrev_b32 v3, 1, v3
    v_lshlrev_b32 v3, 4, v3
    v_lshl_add_u32 v3, v2, 7, v3
    v_and_b32 v7, 1, v1
    v_lshl_add_u32 v3, v7, 3, v3
    v_add_u32 v252, s101, v3
    v_xor_b32 v253, 32, v252
    v_xor_b32 v254, 64, v252
    v_xor_b32 v255, 96, v252
    s_sub_u32 s83, s83, 768
    s_sub_u32 s27, s27, 768
    s_sub_u32 s58, s58, 768
    s_sub_u32 s72, s72, 768
    v_and_b32 v146, 1, v0
    v_cmp_eq_u32 s[50:51], 1, v146
    v_lshlrev_b32 v147, 2, v2
    v_add_u32 v147, 135168, v147
    s_lshl_b32 s61, s48, 8
    v_add_u32 v149, s61, v147
    ds_write_b32 v149, a144 offset:2048
    ds_write_b32 v149, a148 offset:2112
    ds_write_b32 v149, a152 offset:2176
    ds_write_b32 v149, a156 offset:2240
    v_add_u32 v252, 51200, v252
    v_add_u32 v253, 51200, v253
    v_add_u32 v254, 51200, v254
    v_add_u32 v255, 51200, v255
    s_waitcnt vmcnt(19)
    ds_read_b64 a[160:161], v252 offset:51200
    ds_read_b64 a[162:163], v253 offset:51200
    ds_read_b64 a[164:165], v252 offset:53248
    ds_read_b64 a[166:167], v253 offset:53248
    ds_read_b64 a[168:169], v252 offset:55296
    ds_read_b64 a[170:171], v253 offset:55296
    ds_read_b64 a[172:173], v252 offset:57344
    ds_read_b64 a[174:175], v253 offset:57344
    ds_read_b64 a[176:177], v254 offset:51200
    ds_read_b64 a[178:179], v255 offset:51200
    ds_read_b64 a[180:181], v254 offset:53248
    ds_read_b64 a[182:183], v255 offset:53248
    ds_read_b64 a[184:185], v254 offset:55296
    ds_read_b64 a[186:187], v255 offset:55296
    ds_read_b64 a[188:189], v254 offset:57344
    ds_read_b64 a[190:191], v255 offset:57344
    v_add_u32 v252, -51200, v252
    v_add_u32 v253, -51200, v253
    v_add_u32 v254, -51200, v254
    v_add_u32 v255, -51200, v255
    s_waitcnt vmcnt(11)
    ds_read_b64 a[192:193], v252 offset:0
    ds_read_b64 a[194:195], v253 offset:0
    ds_read_b64 a[196:197], v252 offset:2048
    ds_read_b64 a[198:199], v253 offset:2048
    ds_read_b64 a[200:201], v252 offset:4096
    ds_read_b64 a[202:203], v253 offset:4096
    ds_read_b64 a[204:205], v252 offset:6144
    ds_read_b64 a[206:207], v253 offset:6144
    ds_read_b64 a[208:209], v254 offset:0
    ds_read_b64 a[210:211], v255 offset:0
    ds_read_b64 a[212:213], v254 offset:2048
    ds_read_b64 a[214:215], v255 offset:2048
    ds_read_b64 a[216:217], v254 offset:4096
    ds_read_b64 a[218:219], v255 offset:4096
    ds_read_b64 a[220:221], v254 offset:6144
    ds_read_b64 a[222:223], v255 offset:6144
    s_waitcnt vmcnt(3)
    ds_read_b64 a[224:225], v252 offset:51200
    ds_read_b64 a[226:227], v253 offset:51200
    ds_read_b64 a[228:229], v252 offset:53248
    ds_read_b64 a[230:231], v253 offset:53248
    ds_read_b64 a[232:233], v252 offset:55296
    ds_read_b64 a[234:235], v253 offset:55296
    ds_read_b64 a[236:237], v252 offset:57344
    ds_read_b64 a[238:239], v253 offset:57344
    ds_read_b64 a[240:241], v254 offset:51200
    ds_read_b64 a[242:243], v255 offset:51200
    ds_read_b64 a[244:245], v254 offset:53248
    ds_read_b64 a[246:247], v255 offset:53248
    ds_read_b64 a[248:249], v254 offset:55296
    ds_read_b64 a[250:251], v255 offset:55296
    ds_read_b64 a[252:253], v254 offset:57344
    ds_read_b64 a[254:255], v255 offset:57344
    s_sub_u32 s101, s73, s101
    v_add_u32 v252, s101, v252
    v_add_u32 v253, s101, v253
    v_add_u32 v254, s101, v254
    v_add_u32 v255, s101, v255
    s_waitcnt vmcnt(2)
    s_mov_b32 s66, 0
    s_mov_b32 exec_hi, 15
    v_xor_b32 v161, s49, v161
    v_xor_b32 v163, s49, v163
    v_or_b32 v161, v161, v163
    v_cmp_ne_u32 vcc, 0, v161
    s_nop 3
    s_cbranch_vccnz L_F_A_rs
L_F_A_rs_go:
    ds_write_b32 v165, v160 offset:0
    ds_write_b32 v165, v162 offset:1024
    s_mov_b64 exec, -1
    v_lshlrev_b32 v151, 4, v1
    v_add_u32 v151, 135168, v151
    s_waitcnt lgkmcnt(0)
    s_barrier
    v_add_u32 v148, s61, v151
    v_add_u32 v149, s61, v147
    ds_read_b128 v[172:175], v148 offset:2048
    ds_read_b128 v[176:179], v148 offset:2112
    ds_read_b32 v171, v149 offset:2176
    ds_read_b32 v152, v147 offset:0
    ds_read_b32 v162, v147 offset:1024
    ds_read_b32 v153, v147 offset:64
    ds_read_b32 v163, v147 offset:1088
    ds_read_b32 v154, v147 offset:128
    ds_read_b32 v164, v147 offset:1152
    ds_read_b32 v155, v147 offset:192
    ds_read_b32 v165, v147 offset:1216
    ds_read_b32 v156, v147 offset:256
    ds_read_b32 v166, v147 offset:1280
    ds_read_b32 v157, v147 offset:320
    ds_read_b32 v167, v147 offset:1344
    ds_read_b32 v158, v147 offset:384
    ds_read_b32 v168, v147 offset:1408
    ds_read_b32 v159, v147 offset:448
    ds_read_b32 v169, v147 offset:1472
    ds_read_b32 v160, v147 offset:512
    ds_read_b32 v170, v147 offset:1536
    ds_read_b128 v[180:183], v148 offset:2240
    v_mov_b32 v184, 0xc0135761
    v_mov_b32 v185, 0xbdd2d3e8
    s_add_u32 s36, s24, 10485760
    s_addc_u32 s37, s25, 0
    s_mov_b32 s38, 3670016
    s_mov_b32 s39, 0x20000
    s_mul_i32 s62, s76, 224
    s_mul_i32 s63, s77, 14
    s_add_u32 s62, s62, s63
    s_and_b32 s63, s78, 1
    s_lshl_b32 s63, s63, 2
    s_add_u32 s62, s62, s63
    s_add_u32 s62, s62, s48
    s_lshl_b32 s62, s62, 10
    s_waitcnt lgkmcnt(0)
    v_pk_mul_f32 v[188:189], v[180:181], v[162:163] op_sel:[0,1]
    s_add_u32 m0, s73, 24832
    s_nop 0
    buffer_load_dwordx4 v23, s[28:31], s83 offen offset:768  lds
    v_pk_mul_f32 v[190:191], v[182:183], v[162:163] op_sel:[0,1]
    v_pk_mul_f32 v[192:193], v[180:181], v[164:165] op_sel_hi:[1,0]
    v_pk_mul_f32 v[194:195], v[182:183], v[164:165] op_sel_hi:[1,0]
    v_pk_fma_f32 v[220:221], v[220:221], v[152:153], v[188:189] op_sel:[0,1,0]
    v_pk_fma_f32 v[222:223], v[222:223], v[152:153], v[190:191] op_sel:[0,1,0]
    v_pk_fma_f32 v[224:225], v[224:225], v[154:155], v[192:193] op_sel_hi:[1,0,1]
    v_pk_fma_f32 v[226:227], v[226:227], v[154:155], v[194:195] op_sel_hi:[1,0,1]
    v_pk_mul_f32 v[188:189], v[220:221], v[220:221]
    v_pk_mul_f32 v[190:191], v[222:223], v[222:223]
    v_pk_mul_f32 v[192:193], v[224:225], v[224:225]
    v_pk_mul_f32 v[194:195], v[226:227], v[226:227]
    v_pk_fma_f32 v[188:189], v[188:189], v[184:185], v[184:185] op_sel:[0,1,0] op_sel_hi:[1,1,0]
    v_pk_fma_f32 v[190:191], v[190:191], v[184:185], v[184:185] op_sel:[0,1,0] op_sel_hi:[1,1,0]
    v_pk_fma_f32 v[192:193], v[192:193], v[184:185], v[184:185] op_sel:[0,1,0] op_sel_hi:[1,1,0]
    v_pk_fma_f32 v[194:195], v[194:195], v[184:185], v[184:185] op_sel:[0,1,0] op_sel_hi:[1,1,0]
    v_pk_mul_f32 v[188:189], v[188:189], v[220:221]
    v_pk_mul_f32 v[190:191], v[190:191], v[222:223]
    v_pk_mul_f32 v[192:193], v[192:193], v[224:225]
    v_pk_mul_f32 v[194:195], v[194:195], v[226:227]
    v_exp_f32 v188, v188
    v_exp_f32 v189, v189
    s_add_u32 m0, s73, 25856
    s_nop 0
    buffer_load_dwordx4 v31, s[28:31], s83 offen offset:768  lds
    v_exp_f32 v190, v190
    v_exp_f32 v191, v191
    v_exp_f32 v192, v192
    v_exp_f32 v193, v193
    v_exp_f32 v194, v194
    v_exp_f32 v195, v195
    v_pk_add_f32 v[188:189], v[188:189], 1.0 op_sel_hi:[1,0]
    v_pk_add_f32 v[190:191], v[190:191], 1.0 op_sel_hi:[1,0]
    v_pk_add_f32 v[192:193], v[192:193], 1.0 op_sel_hi:[1,0]
    v_pk_add_f32 v[194:195], v[194:195], 1.0 op_sel_hi:[1,0]
    v_rcp_f32 v188, v188
    v_rcp_f32 v189, v189
    v_rcp_f32 v190, v190
    v_rcp_f32 v191, v191
    s_add_u32 m0, s73, 26880
    s_nop 0
    buffer_load_dwordx4 v23, s[28:31], s27 offen offset:768  lds
    v_rcp_f32 v192, v192
    v_rcp_f32 v193, v193
    v_rcp_f32 v194, v194
    v_rcp_f32 v195, v195
    v_pk_mul_f32 v[220:221], v[220:221], v[188:189]
    v_pk_mul_f32 v[222:223], v[222:223], v[190:191]
    v_pk_mul_f32 v[224:225], v[224:225], v[192:193]
    v_pk_mul_f32 v[226:227], v[226:227], v[194:195]
    v_cvt_pk_bf16_f32 v220, v220, v221
    v_cvt_pk_bf16_f32 v221, v222, v223
    v_cvt_pk_bf16_f32 v222, v224, v225
    v_cvt_pk_bf16_f32 v223, v226, v227
    buffer_store_dwordx4 v[220:223], v20, s[36:39], s62 offen sc1
    s_add_u32 s62, s62, 57344
    v_pk_mul_f32 v[188:189], v[180:181], v[164:165] op_sel:[0,1]
    v_pk_mul_f32 v[190:191], v[182:183], v[164:165] op_sel:[0,1]
    v_pk_mul_f32 v[192:193], v[180:181], v[166:167] op_sel_hi:[1,0]
    v_pk_mul_f32 v[194:195], v[182:183], v[166:167] op_sel_hi:[1,0]
    v_pk_fma_f32 v[228:229], v[228:229], v[154:155], v[188:189] op_sel:[0,1,0]
    v_pk_fma_f32 v[230:231], v[230:231], v[154:155], v[190:191] op_sel:[0,1,0]
    v_pk_fma_f32 v[232:233], v[232:233], v[156:157], v[192:193] op_sel_hi:[1,0,1]
    s_add_u32 m0, s73, 27904
    s_nop 0
    buffer_load_dwordx4 v31, s[28:31], s27 offen offset:768  lds
    v_pk_fma_f32 v[234:235], v[234:235], v[156:157], v[194:195] op_sel_hi:[1,0,1]
    v_pk_mul_f32 v[188:189], v[228:229], v[228:229]
    v_pk_mul_f32 v[190:191], v[230:231], v[230:231]
    v_pk_mul_f32 v[192:193], v[232:233], v[232:233]
    v_pk_mul_f32 v[194:195], v[234:235], v[234:235]
    v_pk_fma_f32 v[188:189], v[188:189], v[184:185], v[184:185] op_sel:[0,1,0] op_sel_hi:[1,1,0]
    v_pk_fma_f32 v[190:191], v[190:191], v[184:185], v[184:185] op_sel:[0,1,0] op_sel_hi:[1,1,0]
    v_pk_fma_f32 v[192:193], v[192:193], v[184:185], v[184:185] op_sel:[0,1,0] op_sel_hi:[1,1,0]
    v_pk_fma_f32 v[194:195], v[194:195], v[184:185], v[184:185] op_sel:[0,1,0] op_sel_hi:[1,1,0]
    v_pk_mul_f32 v[188:189], v[188:189], v[228:229]
    v_pk_mul_f32 v[190:191], v[190:191], v[230:231]
    v_pk_mul_f32 v[192:193], v[192:193], v[232:233]
    v_pk_mul_f32 v[194:195], v[194:195], v[234:235]
    v_exp_f32 v188, v188
    v_exp_f32 v189, v189
    v_exp_f32 v190, v190
    v_exp_f32 v191, v191
    v_exp_f32 v192, v192
    s_add_u32 m0, s73, 28928
    s_nop 0
    buffer_load_dwordx4 v23, s[28:31], s58 offen offset:768  lds
    v_exp_f32 v193, v193
    v_exp_f32 v194, v194
    v_exp_f32 v195, v195
    v_pk_add_f32 v[188:189], v[188:189], 1.0 op_sel_hi:[1,0]
    v_pk_add_f32 v[190:191], v[190:191], 1.0 op_sel_hi:[1,0]
    v_pk_add_f32 v[192:193], v[192:193], 1.0 op_sel_hi:[1,0]
    v_pk_add_f32 v[194:195], v[194:195], 1.0 op_sel_hi:[1,0]
    v_rcp_f32 v188, v188
    v_rcp_f32 v189, v189
    v_rcp_f32 v190, v190
    v_rcp_f32 v191, v191
    v_rcp_f32 v192, v192
    v_rcp_f32 v193, v193
    v_rcp_f32 v194, v194
    s_add_u32 m0, s73, 29952
    s_nop 0
    buffer_load_dwordx4 v31, s[28:31], s58 offen offset:768  lds
    v_rcp_f32 v195, v195
    v_pk_mul_f32 v[228:229], v[228:229], v[188:189]
    v_pk_mul_f32 v[230:231], v[230:231], v[190:191]
    v_pk_mul_f32 v[232:233], v[232:233], v[192:193]
    v_pk_mul_f32 v[234:235], v[234:235], v[194:195]
    v_cvt_pk_bf16_f32 v228, v228, v229
    v_cvt_pk_bf16_f32 v229, v230, v231
    v_cvt_pk_bf16_f32 v230, v232, v233
    v_cvt_pk_bf16_f32 v231, v234, v235
    buffer_store_dwordx4 v[228:231], v20, s[36:39], s62 offen sc1
    s_add_u32 s62, s62, 57344
    v_pk_mul_f32 v[188:189], v[180:181], v[166:167] op_sel:[0,1]
    v_pk_mul_f32 v[190:191], v[182:183], v[166:167] op_sel:[0,1]
    v_pk_mul_f32 v[192:193], v[180:181], v[168:169] op_sel_hi:[1,0]
    v_pk_mul_f32 v[194:195], v[182:183], v[168:169] op_sel_hi:[1,0]
    v_pk_fma_f32 v[236:237], v[236:237], v[156:157], v[188:189] op_sel:[0,1,0]
    v_pk_fma_f32 v[238:239], v[238:239], v[156:157], v[190:191] op_sel:[0,1,0]
    v_pk_fma_f32 v[240:241], v[240:241], v[158:159], v[192:193] op_sel_hi:[1,0,1]
    v_pk_fma_f32 v[242:243], v[242:243], v[158:159], v[194:195] op_sel_hi:[1,0,1]
    v_pk_mul_f32 v[188:189], v[236:237], v[236:237]
    v_pk_mul_f32 v[190:191], v[238:239], v[238:239]
    v_pk_mul_f32 v[192:193], v[240:241], v[240:241]
    v_pk_mul_f32 v[194:195], v[242:243], v[242:243]
    v_pk_fma_f32 v[188:189], v[188:189], v[184:185], v[184:185] op_sel:[0,1,0] op_sel_hi:[1,1,0]
    s_add_u32 m0, s73, 30976
    s_nop 0
    buffer_load_dwordx4 v23, s[28:31], s72 offen offset:768  lds
    v_pk_fma_f32 v[190:191], v[190:191], v[184:185], v[184:185] op_sel:[0,1,0] op_sel_hi:[1,1,0]
    v_pk_fma_f32 v[192:193], v[192:193], v[184:185], v[184:185] op_sel:[0,1,0] op_sel_hi:[1,1,0]
    v_pk_fma_f32 v[194:195], v[194:195], v[184:185], v[184:185] op_sel:[0,1,0] op_sel_hi:[1,1,0]
    v_pk_mul_f32 v[188:189], v[188:189], v[236:237]
    v_pk_mul_f32 v[190:191], v[190:191], v[238:239]
    v_pk_mul_f32 v[192:193], v[192:193], v[240:241]
    v_pk_mul_f32 v[194:195], v[194:195], v[242:243]
    v_exp_f32 v188, v188
    v_exp_f32 v189, v189
    v_exp_f32 v190, v190
    v_exp_f32 v191, v191
    v_exp_f32 v192, v192
    v_exp_f32 v193, v193
    v_exp_f32 v194, v194
    v_exp_f32 v195, v195
    s_add_u32 m0, s73, 32000
    s_nop 0
    buffer_load_dwordx4 v31, s[28:31], s72 offen offset:768  lds
    v_pk_add_f32 v[188:189], v[188:189], 1.0 op_sel_hi:[1,0]
    v_pk_add_f32 v[190:191], v[190:191], 1.0 op_sel_hi:[1,0]
    v_pk_add_f32 v[192:193], v[192:193], 1.0 op_sel_hi:[1,0]
    v_pk_add_f32 v[194:195], v[194:195], 1.0 op_sel_hi:[1,0]
    v_rcp_f32 v188, v188
    v_rcp_f32 v189, v189
    v_rcp_f32 v190, v190
    v_rcp_f32 v191, v191
    v_rcp_f32 v192, v192
    v_rcp_f32 v193, v193
    v_rcp_f32 v194, v194
    v_rcp_f32 v195, v195
    v_pk_mul_f32 v[236:237], v[236:237], v[188:189]
    v_pk_mul_f32 v[238:239], v[238:239], v[190:191]
    v_pk_mul_f32 v[240:241], v[240:241], v[192:193]
    s_add_u32 m0, s73, 896
    s_nop 0
    buffer_load_dwordx4 v23, s[28:31], s83 offen offset:128  lds
    v_pk_mul_f32 v[242:243], v[242:243], v[194:195]
    v_cvt_pk_bf16_f32 v236, v236, v237
    v_cvt_pk_bf16_f32 v237, v238, v239
    v_cvt_pk_bf16_f32 v238, v240, v241
    v_cvt_pk_bf16_f32 v239, v242, v243
    buffer_store_dwordx4 v[236:239], v20, s[36:39], s62 offen sc1
    s_add_u32 s62, s62, 57344
    v_pk_mul_f32 v[188:189], v[180:181], v[168:169] op_sel:[0,1]
    v_pk_mul_f32 v[190:191], v[182:183], v[168:169] op_sel:[0,1]
    v_pk_mul_f32 v[192:193], v[180:181], v[170:171] op_sel_hi:[1,0]
    v_pk_mul_f32 v[194:195], v[182:183], v[170:171] op_sel_hi:[1,0]
    v_pk_fma_f32 v[244:245], v[244:245], v[158:159], v[188:189] op_sel:[0,1,0]
    v_pk_fma_f32 v[246:247], v[246:247], v[158:159], v[190:191] op_sel:[0,1,0]
    v_pk_fma_f32 v[248:249], v[248:249], v[160:161], v[192:193] op_sel_hi:[1,0,1]
    v_pk_fma_f32 v[250:251], v[250:251], v[160:161], v[194:195] op_sel_hi:[1,0,1]
    v_pk_mul_f32 v[188:189], v[244:245], v[244:245]
    v_pk_mul_f32 v[190:191], v[246:247], v[246:247]
    v_pk_mul_f32 v[192:193], v[248:249], v[248:249]
    v_pk_mul_f32 v[194:195], v[250:251], v[250:251]
    v_pk_fma_f32 v[188:189], v[188:189], v[184:185], v[184:185] op_sel:[0,1,0] op_sel_hi:[1,1,0]
    v_pk_fma_f32 v[190:191], v[190:191], v[184:185], v[184:185] op_sel:[0,1,0] op_sel_hi:[1,1,0]
    v_pk_fma_f32 v[192:193], v[192:193], v[184:185], v[184:185] op_sel:[0,1,0] op_sel_hi:[1,1,0]
    v_pk_fma_f32 v[194:195], v[194:195], v[184:185], v[184:185] op_sel:[0,1,0] op_sel_hi:[1,1,0]
    v_pk_mul_f32 v[188:189], v[188:189], v[244:245]
    v_pk_mul_f32 v[190:191], v[190:191], v[246:247]
    s_add_u32 m0, s73, 1920
    s_nop 0
    buffer_load_dwordx4 v31, s[28:31], s83 offen offset:128  lds
    v_pk_mul_f32 v[192:193], v[192:193], v[248:249]
    v_pk_mul_f32 v[194:195], v[194:195], v[250:251]
    v_exp_f32 v188, v188
    v_exp_f32 v189, v189
    v_exp_f32 v190, v190
    v_exp_f32 v191, v191
    v_exp_f32 v192, v192
    v_exp_f32 v193, v193
    v_exp_f32 v194, v194
    v_exp_f32 v195, v195
    v_pk_add_f32 v[188:189], v[188:189], 1.0 op_sel_hi:[1,0]
    v_pk_add_f32 v[190:191], v[190:191], 1.0 op_sel_hi:[1,0]
    v_pk_add_f32 v[192:193], v[192:193], 1.0 op_sel_hi:[1,0]
    v_pk_add_f32 v[194:195], v[194:195], 1.0 op_sel_hi:[1,0]
    v_rcp_f32 v188, v188
    s_add_u32 m0, s73, 2944
    s_nop 0
    buffer_load_dwordx4 v23, s[28:31], s27 offen offset:128  lds
    v_rcp_f32 v189, v189
    v_rcp_f32 v190, v190
    v_rcp_f32 v191, v191
    v_rcp_f32 v192, v192
    v_rcp_f32 v193, v193
    v_rcp_f32 v194, v194
    v_rcp_f32 v195, v195
    v_pk_mul_f32 v[244:245], v[244:245], v[188:189]
    v_pk_mul_f32 v[246:247], v[246:247], v[190:191]
    v_pk_mul_f32 v[248:249], v[248:249], v[192:193]
    v_pk_mul_f32 v[250:251], v[250:251], v[194:195]
    v_cvt_pk_bf16_f32 v244, v244, v245
    v_cvt_pk_bf16_f32 v245, v246, v247
    v_cvt_pk_bf16_f32 v246, v248, v249
    v_cvt_pk_bf16_f32 v247, v250, v251
    buffer_store_dwordx4 v[244:247], v20, s[36:39], s62 offen sc1
    s_add_u32 s62, s62, 57344
    v_and_b32 v232, 1, v2
    s_add_u32 m0, s73, 3968
    s_nop 0
    buffer_load_dwordx4 v31, s[28:31], s27 offen offset:128  lds
    v_lshl_add_u32 v233, v1, 2, v232
    v_cmp_le_u32 s[52:53], v233, v2
    v_add_u32 v233, 2, v233
    v_cmp_le_u32 s[54:55], v233, v2
    v_lshlrev_b32 v232, 4, v232
    v_mov_b32 v233, 0xffff
    v_lshlrev_b32 v232, v232, v233
    v_cndmask_b32 v240, 0, v232, s[52:53]
    v_cndmask_b32 v242, v232, 0, s[52:53]
    v_cndmask_b32 v241, 0, v232, s[54:55]
    v_cndmask_b32 v243, v232, 0, s[54:55]
    v_mov_b32 v144, 0x3eb8aa3b
    v_mov_b32 v145, 0xf149f2ca
    s_cmp_eq_u32 s76, 0
    s_cselect_b64 s[56:57], -1, 0
    v_pk_mul_f32 v[232:233], v[176:177], v[162:163] op_sel_hi:[1,0]
    v_pk_mul_f32 v[234:235], v[178:179], v[162:163] op_sel_hi:[1,0]
    v_pk_fma_f32 v[64:65], v[64:65], v[152:153], v[232:233] op_sel_hi:[1,0,1]
    v_pk_fma_f32 v[66:67], v[66:67], v[152:153], v[234:235] op_sel_hi:[1,0,1]
    v_cvt_pk_bf16_f32 v196, v64, v65
    v_cvt_pk_bf16_f32 v197, v66, v67
    v_pk_mul_f32 v[232:233], v[176:177], v[162:163] op_sel:[0,1]
    v_pk_mul_f32 v[234:235], v[178:179], v[162:163] op_sel:[0,1]
    v_pk_mul_f32 v[236:237], v[172:173], v[162:163] op_sel:[0,1]
    v_pk_mul_f32 v[238:239], v[174:175], v[162:163] op_sel:[0,1]
    s_add_u32 m0, s73, 4992
    s_nop 0
    buffer_load_dwordx4 v23, s[28:31], s58 offen offset:128  lds
    v_pk_fma_f32 v[68:69], v[68:69], v[152:153], v[232:233] op_sel:[0,1,0]
    v_pk_fma_f32 v[70:71], v[70:71], v[152:153], v[234:235] op_sel:[0,1,0]
    v_pk_fma_f32 v[32:33], v[32:33], v[152:153], v[236:237] op_sel:[0,1,0]
    v_pk_fma_f32 v[34:35], v[34:35], v[152:153], v[238:239] op_sel:[0,1,0]
    v_cvt_pk_bf16_f32 v198, v68, v69
    v_cvt_pk_bf16_f32 v199, v70, v71
    v_cvt_pk_bf16_f32 v180, v32, v33
    v_cvt_pk_bf16_f32 v181, v34, v35
    v_pk_mul_f32 v[232:233], v[176:177], v[164:165] op_sel_hi:[1,0]
    v_pk_mul_f32 v[234:235], v[178:179], v[164:165] op_sel_hi:[1,0]
    v_pk_mul_f32 v[236:237], v[172:173], v[164:165] op_sel_hi:[1,0]
    v_pk_mul_f32 v[238:239], v[174:175], v[164:165] op_sel_hi:[1,0]
    v_pk_fma_f32 v[72:73], v[72:73], v[154:155], v[232:233] op_sel_hi:[1,0,1]
    v_pk_fma_f32 v[74:75], v[74:75], v[154:155], v[234:235] op_sel_hi:[1,0,1]
    v_pk_fma_f32 v[36:37], v[36:37], v[154:155], v[236:237] op_sel_hi:[1,0,1]
    v_pk_fma_f32 v[38:39], v[38:39], v[154:155], v[238:239] op_sel_hi:[1,0,1]
    v_cvt_pk_bf16_f32 v200, v72, v73
    v_cvt_pk_bf16_f32 v201, v74, v75
    v_cvt_pk_bf16_f32 v182, v36, v37
    v_cvt_pk_bf16_f32 v183, v38, v39
    v_pk_mul_f32 v[232:233], v[176:177], v[164:165] op_sel:[0,1]
    v_pk_mul_f32 v[234:235], v[178:179], v[164:165] op_sel:[0,1]
    v_pk_mul_f32 v[236:237], v[172:173], v[164:165] op_sel:[0,1]
    s_add_u32 m0, s73, 6016
    s_nop 0
    buffer_load_dwordx4 v31, s[28:31], s58 offen offset:128  lds
    v_pk_mul_f32 v[238:239], v[174:175], v[164:165] op_sel:[0,1]
    v_pk_fma_f32 v[76:77], v[76:77], v[154:155], v[232:233] op_sel:[0,1,0]
    v_pk_fma_f32 v[78:79], v[78:79], v[154:155], v[234:235] op_sel:[0,1,0]
    v_pk_fma_f32 v[40:41], v[40:41], v[154:155], v[236:237] op_sel:[0,1,0]
    v_pk_fma_f32 v[42:43], v[42:43], v[154:155], v[238:239] op_sel:[0,1,0]
    v_cvt_pk_bf16_f32 v202, v76, v77
    v_cvt_pk_bf16_f32 v203, v78, v79
    v_cvt_pk_bf16_f32 v184, v40, v41
    v_cvt_pk_bf16_f32 v185, v42, v43
    v_pk_mul_f32 v[232:233], v[176:177], v[166:167] op_sel_hi:[1,0]
    v_pk_mul_f32 v[234:235], v[178:179], v[166:167] op_sel_hi:[1,0]
    v_pk_mul_f32 v[236:237], v[172:173], v[166:167] op_sel_hi:[1,0]
    v_pk_mul_f32 v[238:239], v[174:175], v[166:167] op_sel_hi:[1,0]
    v_pk_fma_f32 v[80:81], v[80:81], v[156:157], v[232:233] op_sel_hi:[1,0,1]
    v_pk_fma_f32 v[82:83], v[82:83], v[156:157], v[234:235] op_sel_hi:[1,0,1]
    v_pk_fma_f32 v[44:45], v[44:45], v[156:157], v[236:237] op_sel_hi:[1,0,1]
    v_pk_fma_f32 v[46:47], v[46:47], v[156:157], v[238:239] op_sel_hi:[1,0,1]
    v_cvt_pk_bf16_f32 v204, v80, v81
    v_cvt_pk_bf16_f32 v205, v82, v83
    v_cvt_pk_bf16_f32 v186, v44, v45
    v_cvt_pk_bf16_f32 v187, v46, v47
    v_pk_mul_f32 v[232:233], v[176:177], v[166:167] op_sel:[0,1]
    v_pk_mul_f32 v[234:235], v[178:179], v[166:167] op_sel:[0,1]
    s_add_u32 m0, s73, 7040
    s_nop 0
    buffer_load_dwordx4 v23, s[28:31], s72 offen offset:128  lds
    v_pk_mul_f32 v[236:237], v[172:173], v[166:167] op_sel:[0,1]
    v_pk_mul_f32 v[238:239], v[174:175], v[166:167] op_sel:[0,1]
    v_pk_fma_f32 v[84:85], v[84:85], v[156:157], v[232:233] op_sel:[0,1,0]
    v_pk_fma_f32 v[86:87], v[86:87], v[156:157], v[234:235] op_sel:[0,1,0]
    v_pk_fma_f32 v[48:49], v[48:49], v[156:157], v[236:237] op_sel:[0,1,0]
    v_pk_fma_f32 v[50:51], v[50:51], v[156:157], v[238:239] op_sel:[0,1,0]
    v_cvt_pk_bf16_f32 v206, v84, v85
    v_cvt_pk_bf16_f32 v207, v86, v87
    v_cvt_pk_bf16_f32 v188, v48, v49
    v_cvt_pk_bf16_f32 v189, v50, v51
    v_pk_mul_f32 v[232:233], v[176:177], v[168:169] op_sel_hi:[1,0]
    v_pk_mul_f32 v[234:235], v[178:179], v[168:169] op_sel_hi:[1,0]
    v_pk_mul_f32 v[236:237], v[172:173], v[168:169] op_sel_hi:[1,0]
    v_pk_mul_f32 v[238:239], v[174:175], v[168:169] op_sel_hi:[1,0]
    v_pk_fma_f32 v[88:89], v[88:89], v[158:159], v[232:233] op_sel_hi:[1,0,1]
    v_pk_fma_f32 v[90:91], v[90:91], v[158:159], v[234:235] op_sel_hi:[1,0,1]
    v_pk_fma_f32 v[52:53], v[52:53], v[158:159], v[236:237] op_sel_hi:[1,0,1]
    v_pk_fma_f32 v[54:55], v[54:55], v[158:159], v[238:239] op_sel_hi:[1,0,1]
    v_cvt_pk_bf16_f32 v208, v88, v89
    v_cvt_pk_bf16_f32 v209, v90, v91
    v_cvt_pk_bf16_f32 v190, v52, v53
    v_cvt_pk_bf16_f32 v191, v54, v55
    v_pk_mul_f32 v[232:233], v[176:177], v[168:169] op_sel:[0,1]
    s_add_u32 m0, s73, 8064
    s_nop 0
    buffer_load_dwordx4 v31, s[28:31], s72 offen offset:128  lds
    v_pk_mul_f32 v[234:235], v[178:179], v[168:169] op_sel:[0,1]
    v_pk_mul_f32 v[236:237], v[172:173], v[168:169] op_sel:[0,1]
    v_pk_mul_f32 v[238:239], v[174:175], v[168:169] op_sel:[0,1]
    v_pk_fma_f32 v[92:93], v[92:93], v[158:159], v[232:233] op_sel:[0,1,0]
    v_pk_fma_f32 v[94:95], v[94:95], v[158:159], v[234:235] op_sel:[0,1,0]
    v_pk_fma_f32 v[56:57], v[56:57], v[158:159], v[236:237] op_sel:[0,1,0]
    v_pk_fma_f32 v[58:59], v[58:59], v[158:159], v[238:239] op_sel:[0,1,0]
    v_cvt_pk_bf16_f32 v210, v92, v93
    v_cvt_pk_bf16_f32 v211, v94, v95
    v_cvt_pk_bf16_f32 v192, v56, v57
    v_cvt_pk_bf16_f32 v193, v58, v59
    v_pk_mul_f32 v[232:233], v[176:177], v[170:171] op_sel_hi:[1,0]
    v_pk_mul_f32 v[234:235], v[178:179], v[170:171] op_sel_hi:[1,0]
    v_pk_mul_f32 v[236:237], v[172:173], v[170:171] op_sel_hi:[1,0]
    v_pk_mul_f32 v[238:239], v[174:175], v[170:171] op_sel_hi:[1,0]
    v_pk_fma_f32 v[96:97], v[96:97], v[160:161], v[232:233] op_sel_hi:[1,0,1]
    v_pk_fma_f32 v[98:99], v[98:99], v[160:161], v[234:235] op_sel_hi:[1,0,1]
    v_pk_fma_f32 v[60:61], v[60:61], v[160:161], v[236:237] op_sel_hi:[1,0,1]
    v_pk_fma_f32 v[62:63], v[62:63], v[160:161], v[238:239] op_sel_hi:[1,0,1]
    v_cvt_pk_bf16_f32 v212, v96, v97
    v_cvt_pk_bf16_f32 v213, v98, v99
    v_cvt_pk_bf16_f32 v194, v60, v61
    v_cvt_pk_bf16_f32 v195, v62, v63
    s_add_u32 m0, s73, 8832
    s_nop 0
    buffer_load_dwordx4 v23, s[28:31], s83 offen offset:384  lds
    ds_read_b128 v[152:155], v151 offset:0
    ds_read_b128 v[156:159], v151 offset:1024
    ds_read_b128 v[160:163], v151 offset:64
    ds_read_b128 v[164:167], v151 offset:1088
    v_mfma_f32_16x16x16_bf16 v[32:35], v[198:199], v[180:181], 0
    v_mfma_f32_16x16x16_bf16 v[68:71], v[196:197], v[180:181], 0
    v_mfma_f32_16x16x16_bf16 v[36:39], v[200:201], v[182:183], 0
    v_mfma_f32_16x16x16_bf16 v[72:75], v[198:199], v[182:183], 0
    v_mfma_f32_16x16x16_bf16 v[40:43], v[202:203], v[184:185], 0
    v_mfma_f32_16x16x16_bf16 v[76:79], v[200:201], v[184:185], 0
    s_add_u32 m0, s73, 9856
    s_nop 0
    buffer_load_dwordx4 v31, s[28:31], s83 offen offset:384  lds
    v_mfma_f32_16x16x16_bf16 v[44:47], v[204:205], v[186:187], 0
    v_mfma_f32_16x16x16_bf16 v[80:83], v[202:203], v[186:187], 0
    v_mfma_f32_16x16x16_bf16 v[48:51], v[206:207], v[188:189], 0
    v_mfma_f32_16x16x16_bf16 v[84:87], v[204:205], v[188:189], 0
    v_mfma_f32_16x16x16_bf16 v[52:55], v[208:209], v[190:191], 0
    v_mfma_f32_16x16x16_bf16 v[88:91], v[206:207], v[190:191], 0
    s_add_u32 m0, s73, 10880
    s_nop 0
    buffer_load_dwordx4 v23, s[28:31], s27 offen offset:384  lds
    v_mfma_f32_16x16x16_bf16 v[56:59], v[210:211], v[192:193], 0
    v_mfma_f32_16x16x16_bf16 v[92:95], v[208:209], v[192:193], 0
    v_mfma_f32_16x16x16_bf16 v[60:63], v[212:213], v[194:195], 0
    v_mfma_f32_16x16x16_bf16 v[96:99], v[210:211], v[194:195], 0
    ds_read_b128 v[244:247], v151 offset:128
    ds_read_b128 v[248:251], v151 offset:1152
    s_waitcnt lgkmcnt(4)
    v_pk_mul_f32 v[232:233], v[156:157], v[170:171] op_sel:[0,1]
    v_pk_mul_f32 v[234:235], v[158:159], v[170:171] op_sel:[0,1]
    v_pk_fma_f32 v[100:101], v[152:153], v[100:101], v[232:233]
    v_pk_fma_f32 v[102:103], v[154:155], v[102:103], v[234:235]
    v_cvt_pk_bf16_f32 v214, v100, v101
    v_cvt_pk_bf16_f32 v215, v102, v103
    ds_read_b128 v[152:155], v151 offset:192
    ds_read_b128 v[156:159], v151 offset:1216
    s_waitcnt lgkmcnt(4)
    v_pk_mul_f32 v[232:233], v[164:165], v[170:171] op_sel:[0,1]
    s_add_u32 m0, s73, 11904
    s_nop 0
    buffer_load_dwordx4 v31, s[28:31], s27 offen offset:384  lds
    v_pk_mul_f32 v[234:235], v[166:167], v[170:171] op_sel:[0,1]
    v_pk_fma_f32 v[104:105], v[160:161], v[104:105], v[232:233]
    v_pk_fma_f32 v[106:107], v[162:163], v[106:107], v[234:235]
    v_cvt_pk_bf16_f32 v216, v104, v105
    v_cvt_pk_bf16_f32 v217, v106, v107
    ds_read_b128 v[160:163], v151 offset:256
    ds_read_b128 v[164:167], v151 offset:1280
    s_waitcnt lgkmcnt(4)
    v_pk_mul_f32 v[232:233], v[248:249], v[170:171] op_sel:[0,1]
    v_pk_mul_f32 v[234:235], v[250:251], v[170:171] op_sel:[0,1]
    v_pk_fma_f32 v[108:109], v[244:245], v[108:109], v[232:233]
    v_pk_fma_f32 v[110:111], v[246:247], v[110:111], v[234:235]
    v_cvt_pk_bf16_f32 v218, v108, v109
    v_cvt_pk_bf16_f32 v219, v110, v111
    ds_read_b128 v[244:247], v151 offset:320
    ds_read_b128 v[248:251], v151 offset:1344
    s_waitcnt lgkmcnt(4)
    v_pk_mul_f32 v[232:233], v[156:157], v[170:171] op_sel:[0,1]
    v_pk_mul_f32 v[234:235], v[158:159], v[170:171] op_sel:[0,1]
    v_pk_fma_f32 v[112:113], v[152:153], v[112:113], v[232:233]
    v_pk_fma_f32 v[114:115], v[154:155], v[114:115], v[234:235]
    v_cvt_pk_bf16_f32 v220, v112, v113
    v_cvt_pk_bf16_f32 v221, v114, v115
    ds_read_b128 v[152:155], v151 offset:384
    ds_read_b128 v[156:159], v151 offset:1408
    s_waitcnt lgkmcnt(4)
    v_pk_mul_f32 v[232:233], v[164:165], v[170:171] op_sel:[0,1]
    v_pk_mul_f32 v[234:235], v[166:167], v[170:171] op_sel:[0,1]
    v_pk_fma_f32 v[116:117], v[160:161], v[116:117], v[232:233]
    v_pk_fma_f32 v[118:119], v[162:163], v[118:119], v[234:235]
    v_cvt_pk_bf16_f32 v222, v116, v117
    v_cvt_pk_bf16_f32 v223, v118, v119
    s_waitcnt vmcnt(14)
    ds_read_b64 a[128:129], v252 offset:25600
    ds_read_b64 a[130:131], v253 offset:25600
    ds_read_b64 a[132:133], v252 offset:27648
    ds_read_b64 a[134:135], v253 offset:27648
    ds_read_b64 a[136:137], v252 offset:29696
    ds_read_b64 a[138:139], v253 offset:29696
    ds_read_b64 a[140:141], v252 offset:31744
    ds_read_b64 a[142:143], v253 offset:31744
    ds_read_b128 v[160:163], v151 offset:448
    ds_read_b128 v[164:167], v151 offset:1472
    s_waitcnt lgkmcnt(12)
    v_pk_mul_f32 v[232:233], v[248:249], v[170:171] op_sel:[0,1]
    v_pk_mul_f32 v[234:235], v[250:251], v[170:171] op_sel:[0,1]
    v_pk_fma_f32 v[120:121], v[244:245], v[120:121], v[232:233]
    v_pk_fma_f32 v[122:123], v[246:247], v[122:123], v[234:235]
    v_cvt_pk_bf16_f32 v224, v120, v121
    v_cvt_pk_bf16_f32 v225, v122, v123
    ds_read_b128 v[244:247], v151 offset:512
    ds_read_b128 v[248:251], v151 offset:1536
    s_waitcnt lgkmcnt(12)
    v_pk_mul_f32 v[232:233], v[156:157], v[170:171] op_sel:[0,1]
    v_pk_mul_f32 v[234:235], v[158:159], v[170:171] op_sel:[0,1]
    v_pk_fma_f32 v[124:125], v[152:153], v[124:125], v[232:233]
    v_pk_fma_f32 v[126:127], v[154:155], v[126:127], v[234:235]
    v_cvt_pk_bf16_f32 v226, v124, v125
    v_cvt_pk_bf16_f32 v227, v126, v127
    s_waitcnt lgkmcnt(2)
    v_pk_mul_f32 v[232:233], v[164:165], v[170:171] op_sel:[0,1]
    v_pk_mul_f32 v[234:235], v[166:167], v[170:171] op_sel:[0,1]
    v_pk_fma_f32 v[128:129], v[160:161], v[128:129], v[232:233]
    v_pk_fma_f32 v[130:131], v[162:163], v[130:131], v[234:235]
    v_cvt_pk_bf16_f32 v228, v128, v129
    v_cvt_pk_bf16_f32 v229, v130, v131
    s_waitcnt lgkmcnt(0)
    v_pk_mul_f32 v[232:233], v[248:249], v[170:171] op_sel:[0,1]
    v_pk_mul_f32 v[234:235], v[250:251], v[170:171] op_sel:[0,1]
    v_pk_fma_f32 v[132:133], v[244:245], v[132:133], v[232:233]
    v_pk_fma_f32 v[134:135], v[246:247], v[134:135], v[234:235]
    v_cvt_pk_bf16_f32 v230, v132, v133
    ds_read_b64 a[144:145], v254 offset:25600
    ds_read_b64 a[146:147], v255 offset:25600
    ds_read_b64 a[148:149], v254 offset:27648
    ds_read_b64 a[150:151], v255 offset:27648
    ds_read_b64 a[152:153], v254 offset:29696
    ds_read_b64 a[154:155], v255 offset:29696
    ds_read_b64 a[156:157], v254 offset:31744
    ds_read_b64 a[158:159], v255 offset:31744
    v_cvt_pk_bf16_f32 v231, v134, v135
    v_cndmask_b32 v104, v32, v33, s[50:51]
    v_cndmask_b32 v106, v68, v69, s[50:51]
    v_cndmask_b32 v105, v34, v35, s[50:51]
    v_cndmask_b32 v107, v70, v71, s[50:51]
    v_cndmask_b32 v108, v36, v37, s[50:51]
    v_cndmask_b32 v110, v72, v73, s[50:51]
    v_cndmask_b32 v109, v38, v39, s[50:51]
    v_cndmask_b32 v111, v74, v75, s[50:51]
    v_cndmask_b32 v112, v40, v41, s[50:51]
    v_cndmask_b32 v114, v76, v77, s[50:51]
    v_cndmask_b32 v113, v42, v43, s[50:51]
    v_cndmask_b32 v115, v78, v79, s[50:51]
    v_cndmask_b32 v116, v44, v45, s[50:51]
    v_cndmask_b32 v118, v80, v81, s[50:51]
    v_cndmask_b32 v117, v46, v47, s[50:51]
    v_cndmask_b32 v119, v82, v83, s[50:51]
    v_cndmask_b32 v120, v48, v49, s[50:51]
    v_cndmask_b32 v122, v84, v85, s[50:51]
    v_cndmask_b32 v121, v50, v51, s[50:51]
    v_cndmask_b32 v123, v86, v87, s[50:51]
    v_cndmask_b32 v124, v52, v53, s[50:51]
    v_cndmask_b32 v126, v88, v89, s[50:51]
    s_add_u32 m0, s73, 12928
    s_nop 0
    buffer_load_dwordx4 v23, s[28:31], s58 offen offset:384  lds
    v_cndmask_b32 v125, v54, v55, s[50:51]
    v_cndmask_b32 v127, v90, v91, s[50:51]
    v_cndmask_b32 v128, v56, v57, s[50:51]
    v_cndmask_b32 v130, v92, v93, s[50:51]
    v_cndmask_b32 v129, v58, v59, s[50:51]
    v_cndmask_b32 v131, v94, v95, s[50:51]
    v_cndmask_b32 v132, v60, v61, s[50:51]
    v_cndmask_b32 v134, v96, v97, s[50:51]
    v_cndmask_b32 v133, v62, v63, s[50:51]
    v_cndmask_b32 v135, v98, v99, s[50:51]
    v_cndmask_b32 v106, v106, v145, s[56:57]
    v_cndmask_b32 v107, v107, v145, s[56:57]
    v_cndmask_b32 v104, v106, v104, s[52:53]
    v_cndmask_b32 v105, v107, v105, s[54:55]
    v_cndmask_b32 v108, v110, v108, s[52:53]
    v_cndmask_b32 v109, v111, v109, s[54:55]
    v_cndmask_b32 v112, v114, v112, s[52:53]
    v_cndmask_b32 v113, v115, v113, s[54:55]
    v_cndmask_b32 v116, v118, v116, s[52:53]
    v_cndmask_b32 v117, v119, v117, s[54:55]
    v_cndmask_b32 v120, v122, v120, s[52:53]
    v_cndmask_b32 v121, v123, v121, s[54:55]
    v_cndmask_b32 v124, v126, v124, s[52:53]
    s_add_u32 m0, s73, 13952
    s_nop 0
    buffer_load_dwordx4 v31, s[28:31], s58 offen offset:384  lds
    v_cndmask_b32 v125, v127, v125, s[54:55]
    v_cndmask_b32 v128, v130, v128, s[52:53]
    v_cndmask_b32 v129, v131, v129, s[54:55]
    v_cndmask_b32 v132, v134, v132, s[52:53]
    v_cndmask_b32 v133, v135, v133, s[54:55]
    v_max_f32 v106, v104, v105
    v_max_f32 v110, v108, v109
    v_max_f32 v114, v112, v113
    v_max_f32 v118, v116, v117
    v_max_f32 v122, v120, v121
    v_max_f32 v126, v124, v125
    v_max_f32 v130, v128, v129
    v_max_f32 v134, v132, v133
    v_mov_b32 v107, v106
    v_mov_b32 v111, v110
    v_mov_b32 v115, v114
    v_mov_b32 v119, v118
    v_mov_b32 v123, v122
    v_mov_b32 v127, v126
    v_mov_b32 v131, v130
    v_mov_b32 v135, v134
    v_permlane16_swap_b32 v106, v107
    s_add_u32 m0, s73, 14976
    s_nop 0
    buffer_load_dwordx4 v23, s[28:31], s72 offen offset:384  lds
    v_permlane16_swap_b32 v110, v111
    v_permlane16_swap_b32 v114, v115
    v_permlane16_swap_b32 v118, v119
    v_permlane16_swap_b32 v122, v123
    v_permlane16_swap_b32 v126, v127
    v_permlane16_swap_b32 v130, v131
    v_permlane16_swap_b32 v134, v135
    v_max_f32 v106, v106, v107
    v_max_f32 v110, v110, v111
    v_max_f32 v114, v114, v115
    v_max_f32 v118, v118, v119
    v_max_f32 v122, v122, v123
    v_max_f32 v126, v126, v127
    v_max_f32 v130, v130, v131
    v_max_f32 v134, v134, v135
    v_mov_b32 v107, v106
    s_add_u32 m0, s73, 16000
    s_nop 0
    buffer_load_dwordx4 v31, s[28:31], s72 offen offset:384  lds
    v_mov_b32 v111, v110
    v_mov_b32 v115, v114
    v_mov_b32 v119, v118
    v_mov_b32 v123, v122
    v_mov_b32 v127, v126
    v_mov_b32 v131, v130
    v_mov_b32 v135, v134
    v_permlane32_swap_b32 v106, v107
    v_permlane32_swap_b32 v110, v111
    v_permlane32_swap_b32 v114, v115
    v_permlane32_swap_b32 v118, v119
    v_permlane32_swap_b32 v122, v123
    v_permlane32_swap_b32 v126, v127
    v_permlane32_swap_b32 v130, v131
    v_permlane32_swap_b32 v134, v135
    s_add_u32 m0, s73, 16768
    s_nop 0
    buffer_load_dwordx4 v23, s[28:31], s83 offen offset:640  lds
    v_max_f32 v106, v106, v107
    v_max_f32 v110, v110, v111
    v_max_f32 v114, v114, v115
    v_max_f32 v118, v118, v119
    v_max_f32 v122, v122, v123
    v_max_f32 v126, v126, v127
    v_max_f32 v130, v130, v131
    v_max_f32 v134, v134, v135
    v_pk_add_f32 v[104:105], v[104:105], v[106:107] op_sel_hi:[1,0] neg_lo:[0,1] neg_hi:[0,1]
    v_pk_add_f32 v[108:109], v[108:109], v[110:111] op_sel_hi:[1,0] neg_lo:[0,1] neg_hi:[0,1]
    v_pk_add_f32 v[112:113], v[112:113], v[114:115] op_sel_hi:[1,0] neg_lo:[0,1] neg_hi:[0,1]
    v_pk_add_f32 v[116:117], v[116:117], v[118:119] op_sel_hi:[1,0] neg_lo:[0,1] neg_hi:[0,1]
    v_pk_add_f32 v[120:121], v[120:121], v[122:123] op_sel_hi:[1,0] neg_lo:[0,1] neg_hi:[0,1]
    v_pk_add_f32 v[124:125], v[124:125], v[126:127] op_sel_hi:[1,0] neg_lo:[0,1] neg_hi:[0,1]
    v_pk_add_f32 v[128:129], v[128:129], v[130:131] op_sel_hi:[1,0] neg_lo:[0,1] neg_hi:[0,1]
    v_pk_add_f32 v[132:133], v[132:133], v[134:135] op_sel_hi:[1,0] neg_lo:[0,1] neg_hi:[0,1]
    v_pk_mul_f32 v[104:105], v[104:105], v[144:145] op_sel_hi:[1,0]
    v_pk_mul_f32 v[108:109], v[108:109], v[144:145] op_sel_hi:[1,0]
    v_pk_mul_f32 v[112:113], v[112:113], v[144:145] op_sel_hi:[1,0]
    v_pk_mul_f32 v[116:117], v[116:117], v[144:145] op_sel_hi:[1,0]
    v_pk_mul_f32 v[120:121], v[120:121], v[144:145] op_sel_hi:[1,0]
    v_pk_mul_f32 v[124:125], v[124:125], v[144:145] op_sel_hi:[1,0]
    v_pk_mul_f32 v[128:129], v[128:129], v[144:145] op_sel_hi:[1,0]
    s_add_u32 m0, s73, 17792
    s_nop 0
    buffer_load_dwordx4 v31, s[28:31], s83 offen offset:640  lds
    v_pk_mul_f32 v[132:133], v[132:133], v[144:145] op_sel_hi:[1,0]
    v_exp_f32 v104, v104
    v_exp_f32 v105, v105
    v_exp_f32 v108, v108
    v_exp_f32 v109, v109
    v_exp_f32 v112, v112
    v_exp_f32 v113, v113
    v_exp_f32 v116, v116
    v_exp_f32 v117, v117
    v_exp_f32 v120, v120
    v_exp_f32 v121, v121
    v_exp_f32 v124, v124
    s_add_u32 m0, s73, 18816
    s_nop 0
    buffer_load_dwordx4 v23, s[28:31], s27 offen offset:640  lds
    v_exp_f32 v125, v125
    v_exp_f32 v128, v128
    v_exp_f32 v129, v129
    v_exp_f32 v132, v132
    v_exp_f32 v133, v133
    v_add_f32 v106, v104, v105
    v_add_f32 v110, v108, v109
    v_add_f32 v114, v112, v113
    v_add_f32 v118, v116, v117
    v_add_f32 v122, v120, v121
    v_add_f32 v126, v124, v125
    v_add_f32 v130, v128, v129
    v_add_f32 v134, v132, v133
    v_mov_b32 v107, v106
    v_mov_b32 v111, v110
    v_mov_b32 v115, v114
    v_mov_b32 v119, v118
    v_mov_b32 v123, v122
    s_add_u32 m0, s73, 19840
    s_nop 0
    buffer_load_dwordx4 v31, s[28:31], s27 offen offset:640  lds
    v_mov_b32 v127, v126
    v_mov_b32 v131, v130
    v_mov_b32 v135, v134
    v_permlane16_swap_b32 v106, v107
    v_permlane16_swap_b32 v110, v111
    v_permlane16_swap_b32 v114, v115
    v_permlane16_swap_b32 v118, v119
    v_permlane16_swap_b32 v122, v123
    v_permlane16_swap_b32 v126, v127
    v_permlane16_swap_b32 v130, v131
    v_permlane16_swap_b32 v134, v135
    v_add_f32 v106, v106, v107
    v_add_f32 v110, v110, v111
    v_add_f32 v114, v114, v115
    v_add_f32 v118, v118, v119
    s_add_u32 m0, s73, 20864
    s_nop 0
    buffer_load_dwordx4 v23, s[28:31], s58 offen offset:640  lds
    v_add_f32 v122, v122, v123
    v_add_f32 v126, v126, v127
    v_add_f32 v130, v130, v131
    v_add_f32 v134, v134, v135
    v_mov_b32 v107, v106
    v_mov_b32 v111, v110
    v_mov_b32 v115, v114
    v_mov_b32 v119, v118
    v_mov_b32 v123, v122
    v_mov_b32 v127, v126
    v_mov_b32 v131, v130
    v_mov_b32 v135, v134
    v_permlane32_swap_b32 v106, v107
    v_permlane32_swap_b32 v110, v111
    v_permlane32_swap_b32 v114, v115
    v_permlane32_swap_b32 v118, v119
    v_permlane32_swap_b32 v122, v123
    v_permlane32_swap_b32 v126, v127
    s_add_u32 m0, s73, 21888
    s_nop 0
    buffer_load_dwordx4 v31, s[28:31], s58 offen offset:640  lds
    v_permlane32_swap_b32 v130, v131
    v_permlane32_swap_b32 v134, v135
    v_add_f32 v106, v106, v107
    v_add_f32 v110, v110, v111
    v_add_f32 v114, v114, v115
    v_add_f32 v118, v118, v119
    v_add_f32 v122, v122, v123
    v_add_f32 v126, v126, v127
    v_add_f32 v130, v130, v131
    v_add_f32 v134, v134, v135
    v_rcp_f32 v106, v106
    v_rcp_f32 v110, v110
    v_rcp_f32 v114, v114
    v_rcp_f32 v118, v118
    v_rcp_f32 v122, v122
    v_rcp_f32 v126, v126
    s_add_u32 m0, s73, 22912
    s_nop 0
    buffer_load_dwordx4 v23, s[28:31], s72 offen offset:640  lds
    v_rcp_f32 v130, v130
    v_rcp_f32 v134, v134
    v_pk_mul_f32 v[104:105], v[104:105], v[106:107] op_sel_hi:[1,0]
    v_pk_mul_f32 v[108:109], v[108:109], v[110:111] op_sel_hi:[1,0]
    v_pk_mul_f32 v[112:113], v[112:113], v[114:115] op_sel_hi:[1,0]
    v_pk_mul_f32 v[116:117], v[116:117], v[118:119] op_sel_hi:[1,0]
    v_pk_mul_f32 v[120:121], v[120:121], v[122:123] op_sel_hi:[1,0]
    v_pk_mul_f32 v[124:125], v[124:125], v[126:127] op_sel_hi:[1,0]
    v_pk_mul_f32 v[128:129], v[128:129], v[130:131] op_sel_hi:[1,0]
    v_pk_mul_f32 v[132:133], v[132:133], v[134:135] op_sel_hi:[1,0]
    v_cvt_pk_bf16_f32 v104, v104, v104
    v_cvt_pk_bf16_f32 v105, v105, v105
    v_cvt_pk_bf16_f32 v108, v108, v108
    v_cvt_pk_bf16_f32 v109, v109, v109
    v_cvt_pk_bf16_f32 v112, v112, v112
    v_cvt_pk_bf16_f32 v113, v113, v113
    v_cvt_pk_bf16_f32 v116, v116, v116
    v_cvt_pk_bf16_f32 v117, v117, v117
    v_cvt_pk_bf16_f32 v120, v120, v120
    v_cvt_pk_bf16_f32 v121, v121, v121
    v_cvt_pk_bf16_f32 v124, v124, v124
    s_add_u32 m0, s73, 23936
    s_nop 0
    buffer_load_dwordx4 v31, s[28:31], s72 offen offset:640  lds
    v_cvt_pk_bf16_f32 v125, v125, v125
    v_cvt_pk_bf16_f32 v128, v128, v128
    v_cvt_pk_bf16_f32 v129, v129, v129
    v_cvt_pk_bf16_f32 v132, v132, v132
    v_cvt_pk_bf16_f32 v133, v133, v133
    v_and_b32 v32, v104, v242
    v_and_b32 v34, v104, v240
    v_and_b32 v33, v105, v243
    v_and_b32 v35, v105, v241
    v_and_b32 v36, v108, v242
    v_and_b32 v38, v108, v240
    v_and_b32 v37, v109, v243
    v_and_b32 v39, v109, v241
    v_and_b32 v40, v112, v242
    v_and_b32 v42, v112, v240
    v_and_b32 v41, v113, v243
    v_and_b32 v43, v113, v241
    v_and_b32 v44, v116, v242
    v_and_b32 v46, v116, v240
    v_and_b32 v45, v117, v243
    v_and_b32 v47, v117, v241
    v_and_b32 v48, v120, v242
    v_and_b32 v50, v120, v240
    s_waitcnt lgkmcnt(0)
    s_add_u32 m0, s73, 24704
    s_nop 0
    buffer_load_dwordx4 v23, s[28:31], s83 offen offset:896  lds
    v_and_b32 v49, v121, v243
    v_and_b32 v51, v121, v241
    v_and_b32 v52, v124, v242
    v_and_b32 v54, v124, v240
    v_and_b32 v53, v125, v243
    v_and_b32 v55, v125, v241
    v_and_b32 v56, v128, v242
    v_and_b32 v58, v128, v240
    v_and_b32 v57, v129, v243
    v_and_b32 v59, v129, v241
    v_and_b32 v60, v132, v242
    v_and_b32 v62, v132, v240
    v_and_b32 v61, v133, v243
    v_and_b32 v63, v133, v241
    v_mfma_f32_16x16x32_bf16 v[68:71], v[214:217], v[32:35], 0
    v_mfma_f32_16x16x32_bf16 v[72:75], v[216:219], v[36:39], 0
    v_mfma_f32_16x16x32_bf16 v[76:79], v[218:221], v[40:43], 0
    s_add_u32 m0, s73, 25728
    s_nop 0
    buffer_load_dwordx4 v31, s[28:31], s83 offen offset:896  lds
    v_mfma_f32_16x16x32_bf16 v[80:83], v[220:223], v[44:47], 0
    v_mfma_f32_16x16x32_bf16 v[84:87], v[222:225], v[48:51], 0
    v_mfma_f32_16x16x32_bf16 v[88:91], v[224:227], v[52:55], 0
    v_mfma_f32_16x16x32_bf16 v[92:95], v[226:229], v[56:59], 0
    v_mfma_f32_16x16x32_bf16 v[96:99], v[228:231], v[60:63], 0
    s_lshl_b32 s60, s48, 12
    s_add_u32 s60, s60, 135168
    v_add_u32 v232, s60, v20
    s_and_b32 s61, s48, 2
    s_lshl_b32 s61, s61, 12
    s_and_b32 s62, s48, 1
    s_lshl_b32 s63, s62, 11
    s_add_u32 s61, s61, s63
    s_add_u32 s61, s61, 135168
    v_add_u32 v233, s61, v20
    s_add_u32 s36, s24, 4194304
    s_addc_u32 s37, s25, 0
    s_mov_b32 s38, 5767168
    s_mov_b32 s39, 0x20000
    s_lshl_b32 s60, s76, 1
    s_add_u32 s60, s60, s62
    s_mul_i32 s60, s60, 176
    s_lshl_b32 s61, s78, 1
    s_add_u32 s60, s60, s61
    s_lshr_b32 s61, s48, 1
    s_add_u32 s60, s60, s61
    s_lshl_b32 s60, s60, 10
    s_add_u32 s61, s60, 45056
    s_add_u32 s62, s60, 90112
    s_add_u32 s63, s60, 135168
    v_cvt_pk_bf16_f32 v152, v68, v69
    s_add_u32 m0, s73, 26752
    s_nop 0
    buffer_load_dwordx4 v23, s[28:31], s27 offen offset:896  lds
    v_cvt_pk_bf16_f32 v153, v70, v71
    v_cvt_pk_bf16_f32 v154, v72, v73
    v_cvt_pk_bf16_f32 v155, v74, v75
    v_cvt_pk_bf16_f32 v156, v76, v77
    v_cvt_pk_bf16_f32 v157, v78, v79
    v_cvt_pk_bf16_f32 v158, v80, v81
    v_cvt_pk_bf16_f32 v159, v82, v83
    v_cvt_pk_bf16_f32 v160, v84, v85
    v_cvt_pk_bf16_f32 v161, v86, v87
    v_cvt_pk_bf16_f32 v162, v88, v89
    v_cvt_pk_bf16_f32 v163, v90, v91
    v_cvt_pk_bf16_f32 v164, v92, v93
    v_cvt_pk_bf16_f32 v165, v94, v95
    v_cvt_pk_bf16_f32 v166, v96, v97
    v_cvt_pk_bf16_f32 v167, v98, v99
    s_add_u32 s44, s24, 15466496
    s_addc_u32 s45, s25, 0
    s_mov_b32 s46, 196608
    s_mov_b32 s47, 0x20000
    s_lshl_b32 s100, s48, 13
    s_and_b32 s10, s2, 1
    s_lshl_b32 s10, s10, 10
    s_add_u32 s100, s100, s10
    s_mov_b32 s10, 0
    v_lshlrev_b32 v26, 11, v1
    v_lshl_add_u32 v26, v2, 6, v26
    buffer_load_dword v27, v26, s[44:47], s100 offen offset:0 sc1
    ds_write_b128 v232, v[152:155] offset:8192
    ds_write_b128 v232, v[156:159] offset:9216
    ds_write_b128 v232, v[160:163] offset:10240
    ds_write_b128 v232, v[164:167] offset:11264
    s_waitcnt lgkmcnt(0)
    s_barrier
    ds_read_b64 v[168:169], v233 offset:8192
    ds_read_b64 v[170:171], v233 offset:12288
    ds_read_b64 v[172:173], v233 offset:8200
    ds_read_b64 v[174:175], v233 offset:12296
    ds_read_b64 v[176:177], v233 offset:9216
    ds_read_b64 v[178:179], v233 offset:13312
    ds_read_b64 v[180:181], v233 offset:9224
    ds_read_b64 v[182:183], v233 offset:13320
    s_waitcnt lgkmcnt(6)
    buffer_store_dwordx4 v[168:171], v20, s[36:39], s60 offen sc1
    s_waitcnt lgkmcnt(4)
    buffer_store_dwordx4 v[172:175], v20, s[36:39], s61 offen sc1
    s_waitcnt lgkmcnt(2)
    buffer_store_dwordx4 v[176:179], v20, s[36:39], s62 offen sc1
    s_waitcnt lgkmcnt(0)
    buffer_store_dwordx4 v[180:183], v20, s[36:39], s63 offen sc1
    s_waitcnt vmcnt(4)
    v_cmp_ne_u32 vcc, s49, v27
    s_nop 3
    s_cbranch_vccnz L_F_ehA
L_F_ehA_go:
    v_add_u32 v6, 4096, v20
    s_bfe_u32 s75, s2, 0x20003
    s_and_b32 s11, s2, 1
    s_lshl_b32 s11, s11, 2
    s_add_u32 s75, s75, s11
    s_mul_i32 s75, s75, 7
    s_mul_i32 s11, s48, 896
    s_add_u32 s11, s11, s75
    s_lshl_b32 s11, s11, 10
    s_mov_b32 s32, s24
    s_mov_b32 s33, s25
    s_mov_b32 s34, 3670016
    s_mov_b32 s35, 0x20000
    s_add_u32 s75, s11, 0
    buffer_load_dwordx4 a[0:3], v20, s[32:35], s75 offen offset:0 sc1
    buffer_load_dwordx4 a[4:7], v20, s[32:35], s75 offen offset:1024 sc1
    buffer_load_dwordx4 a[8:11], v20, s[32:35], s75 offen offset:2048 sc1
    buffer_load_dwordx4 a[12:15], v20, s[32:35], s75 offen offset:3072 sc1
    buffer_load_dwordx4 a[16:19], v6, s[32:35], s75 offen offset:0 sc1
    buffer_load_dwordx4 a[20:23], v6, s[32:35], s75 offen offset:1024 sc1
    buffer_load_dwordx4 a[24:27], v6, s[32:35], s75 offen offset:2048 sc1
    s_add_u32 s75, s11, 57344
    buffer_load_dwordx4 a[28:31], v20, s[32:35], s75 offen offset:0 sc1
    buffer_load_dwordx4 a[32:35], v20, s[32:35], s75 offen offset:1024 sc1
    buffer_load_dwordx4 a[36:39], v20, s[32:35], s75 offen offset:2048 sc1
    buffer_load_dwordx4 a[40:43], v20, s[32:35], s75 offen offset:3072 sc1
    buffer_load_dwordx4 a[44:47], v6, s[32:35], s75 offen offset:0 sc1
    buffer_load_dwordx4 a[48:51], v6, s[32:35], s75 offen offset:1024 sc1
    buffer_load_dwordx4 a[52:55], v6, s[32:35], s75 offen offset:2048 sc1
    s_add_u32 s75, s11, 229376
    buffer_load_dwordx4 a[56:59], v20, s[32:35], s75 offen offset:0 sc1
    buffer_load_dwordx4 a[60:63], v20, s[32:35], s75 offen offset:1024 sc1
    buffer_load_dwordx4 a[64:67], v20, s[32:35], s75 offen offset:2048 sc1
    buffer_load_dwordx4 a[68:71], v20, s[32:35], s75 offen offset:3072 sc1
    buffer_load_dwordx4 a[72:75], v6, s[32:35], s75 offen offset:0 sc1
    buffer_load_dwordx4 a[76:79], v6, s[32:35], s75 offen offset:1024 sc1
    buffer_load_dwordx4 a[80:83], v6, s[32:35], s75 offen offset:2048 sc1
    s_add_u32 m0, s73, 27776
    s_nop 0
    buffer_load_dwordx4 v31, s[28:31], s27 offen offset:896  lds
    s_add_u32 m0, s73, 28800
    s_nop 0
    buffer_load_dwordx4 v23, s[28:31], s58 offen offset:896  lds
    s_add_u32 m0, s73, 29824
    s_nop 0
    buffer_load_dwordx4 v31, s[28:31], s58 offen offset:896  lds
    s_add_u32 m0, s73, 30848
    s_nop 0
    buffer_load_dwordx4 v23, s[28:31], s72 offen offset:896  lds
    s_add_u32 m0, s73, 31872
    s_nop 0
    buffer_load_dwordx4 v31, s[28:31], s72 offen offset:896  lds
    s_lshl_b32 s59, s76, 4
    s_add_u32 s59, s59, s78
    s_lshl_b32 s59, s59, 4
    s_lshl_b32 s60, s48, 2
    s_add_u32 s59, s59, s60
    s_add_u32 s59, s59, 65536
L_F_p2A:
    s_waitcnt lgkmcnt(0)
    s_barrier
    s_and_b32 s66, s2, 7
    s_lshr_b32 s67, s2, 3
    s_lshr_b32 s81, s66, 1
    s_lshl_b32 s81, s81, 3
    s_lshr_b32 s68, s67, 2
    s_add_u32 s81, s81, s68
    s_and_b32 s82, s66, 1
    s_lshl_b32 s82, s82, 2
    s_and_b32 s68, s67, 3
    s_add_u32 s82, s82, s68
    v_add_u32 v6, 4096, v20
    s_and_b32 s60, s82, 3
    s_mul_i32 s74, s60, 7
    s_cmp_eq_u32 s60, 3
    s_cselect_b32 s74, 21, s74
    s_lshr_b32 s60, s82, 2
    s_mul_i32 s60, s60, 28
    s_add_u32 s74, s74, s60
    s_mul_i32 s11, s48, 896
    s_add_u32 s11, s11, s74
    s_lshl_b32 s11, s11, 10
    s_mov_b32 s32, s24
    s_mov_b32 s33, s25
    s_mov_b32 s34, 3670016
    s_mov_b32 s35, 0x20000
    s_add_u32 s36, s24, 10485760
    s_addc_u32 s37, s25, 0
    s_mov_b32 s38, 3670016
    s_mov_b32 s39, 0x20000
    s_add_u32 s40, s24, 4194304
    s_addc_u32 s41, s25, 0
    s_mov_b32 s42, 5767168
    s_mov_b32 s43, 0x20000
    v_add_u32 v12, s73, v20
    s_mov_b32 s44, s16
    s_mov_b32 s45, s17
    s_mov_b32 s46, 4096
    s_mov_b32 s47, 0x20000
    s_xor_b32 s61, s48, 1
    s_mul_i32 s61, s61, 33792
    s_add_u32 s61, s61, 0
    v_add_u32 v13, s61, v20
    s_xor_b32 s61, s48, 2
    s_mul_i32 s61, s61, 33792
    s_add_u32 s61, s61, 8192
    v_add_u32 v14, s61, v20
    s_xor_b32 s61, s48, 3
    s_mul_i32 s61, s61, 33792
    s_add_u32 s61, s61, 16384
    v_add_u32 v15, s61, v20
    s_lshl_b32 s64, s81, 1
    s_lshr_b32 s61, s48, 1
    s_add_u32 s64, s64, s61
    s_mul_i32 s64, s64, 56
    s_add_u32 s64, s64, s74
    s_lshl_b32 s64, s64, 10
    s_and_b32 s61, s48, 1
    s_lshl_b32 s61, s61, 3
    s_add_u32 s62, s64, s61
    s_lshl_b32 s63, s81, 2
    s_add_u32 s63, s63, s48
    s_mul_i32 s64, s63, 44
    s_lshl_b32 s63, s63, 5
    s_lshr_b32 s61, s74, 1
    s_add_u32 s64, s64, s61
    s_add_u32 s64, s64, 16
    s_lshl_b32 s64, s64, 10
    v_lshlrev_b32 v19, 1, v2
    buffer_load_ushort v18, v19, s[44:47], s63 offen
    s_mov_b32 s77, s82
    s_mov_b32 s76, s81
    s_lshl_b32 s101, s48, 5
    s_add_u32 s101, s101, s77
    s_lshl_b32 s101, s101, 12
    s_mul_i32 s3, s76, 176
    s_lshl_b32 s10, s48, 2
    s_add_u32 s3, s3, s10
    s_lshl_b32 s3, s3, 10
    s_add_u32 s10, s3, 45056
    s_add_u32 s100, s3, 90112
    s_add_u32 s78, s3, 135168
    s_add_u32 s44, s24, 15466496
    s_addc_u32 s45, s25, 0
    s_mov_b32 s46, 196608
    s_mov_b32 s47, 0x20000
    s_lshl_b32 s68, s48, 13
    s_lshr_b32 s69, s82, 2
    s_lshl_b32 s69, s69, 10
    s_add_u32 s68, s68, s69
    v_lshlrev_b32 v26, 11, v1
    v_and_b32 v27, 15, v0
    v_lshl_add_u32 v26, v27, 6, v26
    s_lshr_b32 s68, s68, 4
    v_lshrrev_b32 v26, 4, v26
    s_add_u32 s68, s68, 32768
    s_mov_b32 s70, 0
    s_lshr_b32 s65, s81, 1
    s_lshl_b32 s65, s65, 8
    s_add_u32 s65, s65, 65536
    v_lshlrev_b32 v25, 2, v0
    v_mov_b32 v29, s49
    v_mov_b32 v30, 0
    s_lshl_b32 s66, s81, 11
    s_add_u32 s66, s66, 131072
    s_lshr_b32 s69, s48, 1
    s_lshl_b32 s69, s69, 10
    s_add_u32 s69, s69, s66
    s_lshl_b32 s67, s82, 2
    s_add_u32 s67, s67, s48
    s_lshl_b32 s67, s67, 6
    s_add_u32 s66, s66, s67
    v_lshlrev_b32 v27, 6, v0
    s_lshl_b32 s77, s77, 7
    v_mul_u32_u24 v16, 272, v2
    v_lshl_add_u32 v16, v1, 4, v16
    v_add_u32 v8, s73, v16
    v_lshrrev_b32 v16, 3, v0
    v_and_b32 v17, 7, v0
    v_mul_u32_u24 v7, 272, v16
    v_lshl_add_u32 v7, v17, 5, v7
    s_mul_i32 s67, s48, 4352
    v_add_u32 v9, s67, v7
    v_add_u32 v10, 67584, v9
    v_lshlrev_b32 v17, 4, v17
    v_lshl_add_u32 v11, v16, 10, v17
    s_lshl_b32 s61, s76, 2
    s_add_u32 s61, s61, s48
    s_lshl_b32 s61, s61, 14
    s_add_u32 s79, s61, s77
    s_add_u32 s80, s79, 8192
    s_mul_i32 s71, s48, 3
    s_add_u32 s71, s71, 16
    s_lshl_b32 s71, s71, 10
    s_waitcnt vmcnt(15)
    v_mfma_f32_16x16x32_bf16 v[32:35], a[0:3], a[160:163], 0
    s_add_u32 s60, s11, 286720
    buffer_load_dwordx4 a[84:87], v20, s[32:35], s60 offen offset:0 sc1
    v_mfma_f32_16x16x32_bf16 v[60:63], a[0:3], a[164:167], 0
    v_mfma_f32_16x16x32_bf16 v[88:91], a[0:3], a[168:171], 0
    v_mfma_f32_16x16x32_bf16 v[116:119], a[0:3], a[172:175], 0
    buffer_load_dwordx4 a[88:91], v20, s[32:35], s60 offen offset:1024 sc1
    v_mfma_f32_16x16x32_bf16 v[36:39], a[4:7], a[160:163], 0
    v_mfma_f32_16x16x32_bf16 v[64:67], a[4:7], a[164:167], 0
    v_mfma_f32_16x16x32_bf16 v[92:95], a[4:7], a[168:171], 0
    v_mfma_f32_16x16x32_bf16 v[120:123], a[4:7], a[172:175], 0
    buffer_load_dwordx4 a[92:95], v20, s[32:35], s60 offen offset:2048 sc1
    v_mfma_f32_16x16x32_bf16 v[40:43], a[8:11], a[160:163], 0
    v_mfma_f32_16x16x32_bf16 v[68:71], a[8:11], a[164:167], 0
    v_mfma_f32_16x16x32_bf16 v[96:99], a[8:11], a[168:171], 0
    v_mfma_f32_16x16x32_bf16 v[124:127], a[8:11], a[172:175], 0
    buffer_load_dwordx4 a[96:99], v20, s[32:35], s60 offen offset:3072 sc1
    v_mfma_f32_16x16x32_bf16 v[44:47], a[12:15], a[160:163], 0
    v_mfma_f32_16x16x32_bf16 v[72:75], a[12:15], a[164:167], 0
    v_mfma_f32_16x16x32_bf16 v[100:103], a[12:15], a[168:171], 0
    v_mfma_f32_16x16x32_bf16 v[128:131], a[12:15], a[172:175], 0
    buffer_load_dwordx4 a[100:103], v6, s[32:35], s60 offen offset:0 sc1
    v_mfma_f32_16x16x32_bf16 v[48:51], a[16:19], a[160:163], 0
    v_mfma_f32_16x16x32_bf16 v[76:79], a[16:19], a[164:167], 0
    v_mfma_f32_16x16x32_bf16 v[104:107], a[16:19], a[168:171], 0
    v_mfma_f32_16x16x32_bf16 v[132:135], a[16:19], a[172:175], 0
    buffer_load_dwordx4 a[104:107], v6, s[32:35], s60 offen offset:1024 sc1
    v_mfma_f32_16x16x32_bf16 v[52:55], a[20:23], a[160:163], 0
    v_mfma_f32_16x16x32_bf16 v[80:83], a[20:23], a[164:167], 0
    v_mfma_f32_16x16x32_bf16 v[108:111], a[20:23], a[168:171], 0
    v_mfma_f32_16x16x32_bf16 v[136:139], a[20:23], a[172:175], 0
    buffer_load_dwordx4 a[108:111], v6, s[32:35], s60 offen offset:2048 sc1
    v_mfma_f32_16x16x32_bf16 v[56:59], a[24:27], a[160:163], 0
    v_mfma_f32_16x16x32_bf16 v[84:87], a[24:27], a[164:167], 0
    v_mfma_f32_16x16x32_bf16 v[112:115], a[24:27], a[168:171], 0
    v_mfma_f32_16x16x32_bf16 v[140:143], a[24:27], a[172:175], 0
    s_waitcnt vmcnt(15)
    v_mfma_f32_16x16x32_bf16 v[32:35], a[28:31], a[176:179], v[32:35]
    s_add_u32 s60, s11, 458752
    buffer_load_dwordx4 a[0:3], v20, s[32:35], s60 offen offset:0 sc1
    v_mfma_f32_16x16x32_bf16 v[60:63], a[28:31], a[180:183], v[60:63]
    v_mfma_f32_16x16x32_bf16 v[88:91], a[28:31], a[184:187], v[88:91]
    v_mfma_f32_16x16x32_bf16 v[116:119], a[28:31], a[188:191], v[116:119]
    buffer_load_dwordx4 a[4:7], v20, s[32:35], s60 offen offset:1024 sc1
    v_mfma_f32_16x16x32_bf16 v[36:39], a[32:35], a[176:179], v[36:39]
    v_mfma_f32_16x16x32_bf16 v[64:67], a[32:35], a[180:183], v[64:67]
    v_mfma_f32_16x16x32_bf16 v[92:95], a[32:35], a[184:187], v[92:95]
    v_mfma_f32_16x16x32_bf16 v[120:123], a[32:35], a[188:191], v[120:123]
    buffer_load_dwordx4 a[8:11], v20, s[32:35], s60 offen offset:2048 sc1
    v_mfma_f32_16x16x32_bf16 v[40:43], a[36:39], a[176:179], v[40:43]
    v_mfma_f32_16x16x32_bf16 v[68:71], a[36:39], a[180:183], v[68:71]
    v_mfma_f32_16x16x32_bf16 v[96:99], a[36:39], a[184:187], v[96:99]
    v_mfma_f32_16x16x32_bf16 v[124:127], a[36:39], a[188:191], v[124:127]
    buffer_load_dwordx4 a[12:15], v20, s[32:35], s60 offen offset:3072 sc1
    v_mfma_f32_16x16x32_bf16 v[44:47], a[40:43], a[176:179], v[44:47]
    v_mfma_f32_16x16x32_bf16 v[72:75], a[40:43], a[180:183], v[72:75]
    v_mfma_f32_16x16x32_bf16 v[100:103], a[40:43], a[184:187], v[100:103]
    v_mfma_f32_16x16x32_bf16 v[128:131], a[40:43], a[188:191], v[128:131]
    buffer_load_dwordx4 a[16:19], v6, s[32:35], s60 offen offset:0 sc1
    v_mfma_f32_16x16x32_bf16 v[48:51], a[44:47], a[176:179], v[48:51]
    v_mfma_f32_16x16x32_bf16 v[76:79], a[44:47], a[180:183], v[76:79]
    v_mfma_f32_16x16x32_bf16 v[104:107], a[44:47], a[184:187], v[104:107]
    v_mfma_f32_16x16x32_bf16 v[132:135], a[44:47], a[188:191], v[132:135]
    buffer_load_dwordx4 a[20:23], v6, s[32:35], s60 offen offset:1024 sc1
    v_mfma_f32_16x16x32_bf16 v[52:55], a[48:51], a[176:179], v[52:55]
    v_mfma_f32_16x16x32_bf16 v[80:83], a[48:51], a[180:183], v[80:83]
    v_mfma_f32_16x16x32_bf16 v[108:111], a[48:51], a[184:187], v[108:111]
    v_mfma_f32_16x16x32_bf16 v[136:139], a[48:51], a[188:191], v[136:139]
    buffer_load_dwordx4 a[24:27], v6, s[32:35], s60 offen offset:2048 sc1
    v_mfma_f32_16x16x32_bf16 v[56:59], a[52:55], a[176:179], v[56:59]
    v_mfma_f32_16x16x32_bf16 v[84:87], a[52:55], a[180:183], v[84:87]
    v_mfma_f32_16x16x32_bf16 v[112:115], a[52:55], a[184:187], v[112:115]
    v_mfma_f32_16x16x32_bf16 v[140:143], a[52:55], a[188:191], v[140:143]
    s_waitcnt vmcnt(15)
    v_mfma_f32_16x16x32_bf16 v[32:35], a[56:59], a[192:195], v[32:35]
    buffer_load_dword v28, v26, s[44:47], s68 offen sc1
    v_mfma_f32_16x16x32_bf16 v[60:63], a[56:59], a[196:199], v[60:63]
    v_mfma_f32_16x16x32_bf16 v[88:91], a[56:59], a[200:203], v[88:91]
    v_mfma_f32_16x16x32_bf16 v[116:119], a[56:59], a[204:207], v[116:119]
    s_add_u32 s60, s11, 516096
    buffer_load_dwordx4 a[28:31], v20, s[32:35], s60 offen offset:0 sc1
    v_mfma_f32_16x16x32_bf16 v[36:39], a[60:63], a[192:195], v[36:39]
    v_mfma_f32_16x16x32_bf16 v[64:67], a[60:63], a[196:199], v[64:67]
    v_mfma_f32_16x16x32_bf16 v[92:95], a[60:63], a[200:203], v[92:95]
    buffer_load_dwordx4 a[32:35], v20, s[32:35], s60 offen offset:1024 sc1
    v_mfma_f32_16x16x32_bf16 v[120:123], a[60:63], a[204:207], v[120:123]
    v_mfma_f32_16x16x32_bf16 v[40:43], a[64:67], a[192:195], v[40:43]
    v_mfma_f32_16x16x32_bf16 v[68:71], a[64:67], a[196:199], v[68:71]
    v_mfma_f32_16x16x32_bf16 v[96:99], a[64:67], a[200:203], v[96:99]
    buffer_load_dwordx4 a[36:39], v20, s[32:35], s60 offen offset:2048 sc1
    v_mfma_f32_16x16x32_bf16 v[124:127], a[64:67], a[204:207], v[124:127]
    v_mfma_f32_16x16x32_bf16 v[44:47], a[68:71], a[192:195], v[44:47]
    v_mfma_f32_16x16x32_bf16 v[72:75], a[68:71], a[196:199], v[72:75]
    buffer_load_dwordx4 a[40:43], v20, s[32:35], s60 offen offset:3072 sc1
    v_mfma_f32_16x16x32_bf16 v[100:103], a[68:71], a[200:203], v[100:103]
    v_mfma_f32_16x16x32_bf16 v[128:131], a[68:71], a[204:207], v[128:131]
    v_mfma_f32_16x16x32_bf16 v[48:51], a[72:75], a[192:195], v[48:51]
    buffer_load_dwordx4 a[44:47], v6, s[32:35], s60 offen offset:0 sc1
    v_mfma_f32_16x16x32_bf16 v[76:79], a[72:75], a[196:199], v[76:79]
    v_mfma_f32_16x16x32_bf16 v[104:107], a[72:75], a[200:203], v[104:107]
    v_mfma_f32_16x16x32_bf16 v[132:135], a[72:75], a[204:207], v[132:135]
    v_mfma_f32_16x16x32_bf16 v[52:55], a[76:79], a[192:195], v[52:55]
    buffer_load_dwordx4 a[48:51], v6, s[32:35], s60 offen offset:1024 sc1
    v_mfma_f32_16x16x32_bf16 v[80:83], a[76:79], a[196:199], v[80:83]
    v_mfma_f32_16x16x32_bf16 v[108:111], a[76:79], a[200:203], v[108:111]
    v_mfma_f32_16x16x32_bf16 v[136:139], a[76:79], a[204:207], v[136:139]
    buffer_load_dwordx4 a[52:55], v6, s[32:35], s60 offen offset:2048 sc1
    v_mfma_f32_16x16x32_bf16 v[56:59], a[80:83], a[192:195], v[56:59]
    v_mfma_f32_16x16x32_bf16 v[84:87], a[80:83], a[196:199], v[84:87]
    v_mfma_f32_16x16x32_bf16 v[112:115], a[80:83], a[200:203], v[112:115]
    v_mfma_f32_16x16x32_bf16 v[140:143], a[80:83], a[204:207], v[140:143]
    s_waitcnt vmcnt(15)
    v_mfma_f32_16x16x32_bf16 v[32:35], a[84:87], a[208:211], v[32:35]
    s_add_u32 s60, s11, 688128
    buffer_load_dwordx4 a[56:59], v20, s[32:35], s60 offen offset:0 sc1
    v_mfma_f32_16x16x32_bf16 v[60:63], a[84:87], a[212:215], v[60:63]
    v_mfma_f32_16x16x32_bf16 v[88:91], a[84:87], a[216:219], v[88:91]
    v_mfma_f32_16x16x32_bf16 v[116:119], a[84:87], a[220:223], v[116:119]
    buffer_load_dwordx4 a[60:63], v20, s[32:35], s60 offen offset:1024 sc1
    v_mfma_f32_16x16x32_bf16 v[36:39], a[88:91], a[208:211], v[36:39]
    v_mfma_f32_16x16x32_bf16 v[64:67], a[88:91], a[212:215], v[64:67]
    v_mfma_f32_16x16x32_bf16 v[92:95], a[88:91], a[216:219], v[92:95]
    buffer_load_dwordx4 a[64:67], v20, s[32:35], s60 offen offset:2048 sc1
    v_mfma_f32_16x16x32_bf16 v[120:123], a[88:91], a[220:223], v[120:123]
    v_mfma_f32_16x16x32_bf16 v[40:43], a[92:95], a[208:211], v[40:43]
    v_mfma_f32_16x16x32_bf16 v[68:71], a[92:95], a[212:215], v[68:71]
    v_mfma_f32_16x16x32_bf16 v[96:99], a[92:95], a[216:219], v[96:99]
    buffer_load_dwordx4 a[68:71], v20, s[32:35], s60 offen offset:3072 sc1
    v_mfma_f32_16x16x32_bf16 v[124:127], a[92:95], a[220:223], v[124:127]
    v_mfma_f32_16x16x32_bf16 v[44:47], a[96:99], a[208:211], v[44:47]
    v_mfma_f32_16x16x32_bf16 v[72:75], a[96:99], a[212:215], v[72:75]
    buffer_load_dwordx4 a[72:75], v6, s[32:35], s60 offen offset:0 sc1
    v_mfma_f32_16x16x32_bf16 v[100:103], a[96:99], a[216:219], v[100:103]
    v_mfma_f32_16x16x32_bf16 v[128:131], a[96:99], a[220:223], v[128:131]
    v_mfma_f32_16x16x32_bf16 v[48:51], a[100:103], a[208:211], v[48:51]
    buffer_load_dwordx4 a[76:79], v6, s[32:35], s60 offen offset:1024 sc1
    v_mfma_f32_16x16x32_bf16 v[76:79], a[100:103], a[212:215], v[76:79]
    v_mfma_f32_16x16x32_bf16 v[104:107], a[100:103], a[216:219], v[104:107]
    v_mfma_f32_16x16x32_bf16 v[132:135], a[100:103], a[220:223], v[132:135]
    v_mfma_f32_16x16x32_bf16 v[52:55], a[104:107], a[208:211], v[52:55]
    buffer_load_dwordx4 a[80:83], v6, s[32:35], s60 offen offset:2048 sc1
    v_mfma_f32_16x16x32_bf16 v[80:83], a[104:107], a[212:215], v[80:83]
    v_mfma_f32_16x16x32_bf16 v[108:111], a[104:107], a[216:219], v[108:111]
    v_mfma_f32_16x16x32_bf16 v[136:139], a[104:107], a[220:223], v[136:139]
    s_mov_b64 exec, 1
    buffer_store_dword v29, v30, s[44:47], s59 offen sc1
    s_mov_b64 exec, -1
    v_mfma_f32_16x16x32_bf16 v[56:59], a[108:111], a[208:211], v[56:59]
    v_mfma_f32_16x16x32_bf16 v[84:87], a[108:111], a[212:215], v[84:87]
    v_mfma_f32_16x16x32_bf16 v[112:115], a[108:111], a[216:219], v[112:115]
    v_mfma_f32_16x16x32_bf16 v[140:143], a[108:111], a[220:223], v[140:143]
    s_waitcnt vmcnt(16)
    v_mfma_f32_16x16x32_bf16 v[32:35], a[0:3], a[224:227], v[32:35]
    s_add_u32 s60, s11, 745472
    buffer_load_dwordx4 a[84:87], v20, s[32:35], s60 offen offset:0 sc1
    v_mfma_f32_16x16x32_bf16 v[60:63], a[0:3], a[228:231], v[60:63]
    v_mfma_f32_16x16x32_bf16 v[88:91], a[0:3], a[232:235], v[88:91]
    v_mfma_f32_16x16x32_bf16 v[116:119], a[0:3], a[236:239], v[116:119]
    buffer_load_dwordx4 a[88:91], v20, s[32:35], s60 offen offset:1024 sc1
    v_mfma_f32_16x16x32_bf16 v[36:39], a[4:7], a[224:227], v[36:39]
    v_mfma_f32_16x16x32_bf16 v[64:67], a[4:7], a[228:231], v[64:67]
    v_mfma_f32_16x16x32_bf16 v[92:95], a[4:7], a[232:235], v[92:95]
    v_mfma_f32_16x16x32_bf16 v[120:123], a[4:7], a[236:239], v[120:123]
    buffer_load_dwordx4 a[92:95], v20, s[32:35], s60 offen offset:2048 sc1
    v_mfma_f32_16x16x32_bf16 v[40:43], a[8:11], a[224:227], v[40:43]
    v_mfma_f32_16x16x32_bf16 v[68:71], a[8:11], a[228:231], v[68:71]
    v_mfma_f32_16x16x32_bf16 v[96:99], a[8:11], a[232:235], v[96:99]
    v_mfma_f32_16x16x32_bf16 v[124:127], a[8:11], a[236:239], v[124:127]
    buffer_load_dwordx4 a[96:99], v20, s[32:35], s60 offen offset:3072 sc1
    v_mfma_f32_16x16x32_bf16 v[44:47], a[12:15], a[224:227], v[44:47]
    v_mfma_f32_16x16x32_bf16 v[72:75], a[12:15], a[228:231], v[72:75]
    v_mfma_f32_16x16x32_bf16 v[100:103], a[12:15], a[232:235], v[100:103]
    v_mfma_f32_16x16x32_bf16 v[128:131], a[12:15], a[236:239], v[128:131]
    buffer_load_dwordx4 a[100:103], v6, s[32:35], s60 offen offset:0 sc1
    v_mfma_f32_16x16x32_bf16 v[48:51], a[16:19], a[224:227], v[48:51]
    v_mfma_f32_16x16x32_bf16 v[76:79], a[16:19], a[228:231], v[76:79]
    v_mfma_f32_16x16x32_bf16 v[104:107], a[16:19], a[232:235], v[104:107]
    v_mfma_f32_16x16x32_bf16 v[132:135], a[16:19], a[236:239], v[132:135]
    buffer_load_dwordx4 a[104:107], v6, s[32:35], s60 offen offset:1024 sc1
    v_mfma_f32_16x16x32_bf16 v[52:55], a[20:23], a[224:227], v[52:55]
    v_mfma_f32_16x16x32_bf16 v[80:83], a[20:23], a[228:231], v[80:83]
    v_mfma_f32_16x16x32_bf16 v[108:111], a[20:23], a[232:235], v[108:111]
    v_mfma_f32_16x16x32_bf16 v[136:139], a[20:23], a[236:239], v[136:139]
    buffer_load_dwordx4 a[108:111], v6, s[32:35], s60 offen offset:2048 sc1
    v_mfma_f32_16x16x32_bf16 v[56:59], a[24:27], a[224:227], v[56:59]
    v_mfma_f32_16x16x32_bf16 v[84:87], a[24:27], a[228:231], v[84:87]
    v_mfma_f32_16x16x32_bf16 v[112:115], a[24:27], a[232:235], v[112:115]
    v_mfma_f32_16x16x32_bf16 v[140:143], a[24:27], a[236:239], v[140:143]
    s_waitcnt vmcnt(22)
    s_waitcnt vmcnt(15)
    v_cmp_ne_u32 vcc, s49, v28
    s_nop 3
    s_cbranch_vccnz L_FA_h2
L_FA_h2_go:
    v_mfma_f32_16x16x32_bf16 v[32:35], a[28:31], a[240:243], v[32:35]
    s_add_u32 s60, s11, 114688
    buffer_load_dwordx4 a[0:3], v20, s[32:35], s60 offen offset:0 sc1
    v_mfma_f32_16x16x32_bf16 v[60:63], a[28:31], a[244:247], v[60:63]
    v_mfma_f32_16x16x32_bf16 v[88:91], a[28:31], a[248:251], v[88:91]
    v_mfma_f32_16x16x32_bf16 v[116:119], a[28:31], a[252:255], v[116:119]
    buffer_load_dwordx4 a[4:7], v20, s[32:35], s60 offen offset:1024 sc1
    v_mfma_f32_16x16x32_bf16 v[36:39], a[32:35], a[240:243], v[36:39]
    v_mfma_f32_16x16x32_bf16 v[64:67], a[32:35], a[244:247], v[64:67]
    v_mfma_f32_16x16x32_bf16 v[92:95], a[32:35], a[248:251], v[92:95]
    v_mfma_f32_16x16x32_bf16 v[120:123], a[32:35], a[252:255], v[120:123]
    buffer_load_dwordx4 a[8:11], v20, s[32:35], s60 offen offset:2048 sc1
    v_mfma_f32_16x16x32_bf16 v[40:43], a[36:39], a[240:243], v[40:43]
    v_mfma_f32_16x16x32_bf16 v[68:71], a[36:39], a[244:247], v[68:71]
    v_mfma_f32_16x16x32_bf16 v[96:99], a[36:39], a[248:251], v[96:99]
    v_mfma_f32_16x16x32_bf16 v[124:127], a[36:39], a[252:255], v[124:127]
    buffer_load_dwordx4 a[12:15], v20, s[32:35], s60 offen offset:3072 sc1
    v_mfma_f32_16x16x32_bf16 v[44:47], a[40:43], a[240:243], v[44:47]
    v_mfma_f32_16x16x32_bf16 v[72:75], a[40:43], a[244:247], v[72:75]
    v_mfma_f32_16x16x32_bf16 v[100:103], a[40:43], a[248:251], v[100:103]
    v_mfma_f32_16x16x32_bf16 v[128:131], a[40:43], a[252:255], v[128:131]
    buffer_load_dwordx4 a[16:19], v6, s[32:35], s60 offen offset:0 sc1
    v_mfma_f32_16x16x32_bf16 v[48:51], a[44:47], a[240:243], v[48:51]
    v_mfma_f32_16x16x32_bf16 v[76:79], a[44:47], a[244:247], v[76:79]
    v_mfma_f32_16x16x32_bf16 v[104:107], a[44:47], a[248:251], v[104:107]
    v_mfma_f32_16x16x32_bf16 v[132:135], a[44:47], a[252:255], v[132:135]
    buffer_load_dwordx4 a[20:23], v6, s[32:35], s60 offen offset:1024 sc1
    v_mfma_f32_16x16x32_bf16 v[52:55], a[48:51], a[240:243], v[52:55]
    v_mfma_f32_16x16x32_bf16 v[80:83], a[48:51], a[244:247], v[80:83]
    v_mfma_f32_16x16x32_bf16 v[108:111], a[48:51], a[248:251], v[108:111]
    v_mfma_f32_16x16x32_bf16 v[136:139], a[48:51], a[252:255], v[136:139]
    buffer_load_dwordx4 a[24:27], v6, s[32:35], s60 offen offset:2048 sc1
    v_mfma_f32_16x16x32_bf16 v[56:59], a[52:55], a[240:243], v[56:59]
    v_mfma_f32_16x16x32_bf16 v[84:87], a[52:55], a[244:247], v[84:87]
    v_mfma_f32_16x16x32_bf16 v[112:115], a[52:55], a[248:251], v[112:115]
    v_mfma_f32_16x16x32_bf16 v[140:143], a[52:55], a[252:255], v[140:143]
    s_waitcnt vmcnt(15)
    v_mfma_f32_16x16x32_bf16 v[32:35], a[56:59], a[128:131], v[32:35]
    s_add_u32 s60, s11, 172032
    buffer_load_dwordx4 a[28:31], v20, s[32:35], s60 offen offset:0 sc1
    v_mfma_f32_16x16x32_bf16 v[60:63], a[56:59], a[132:135], v[60:63]
    v_mfma_f32_16x16x32_bf16 v[88:91], a[56:59], a[136:139], v[88:91]
    v_mfma_f32_16x16x32_bf16 v[116:119], a[56:59], a[140:143], v[116:119]
    buffer_load_dwordx4 a[32:35], v20, s[32:35], s60 offen offset:1024 sc1
    v_mfma_f32_16x16x32_bf16 v[36:39], a[60:63], a[128:131], v[36:39]
    v_mfma_f32_16x16x32_bf16 v[64:67], a[60:63], a[132:135], v[64:67]
    v_mfma_f32_16x16x32_bf16 v[92:95], a[60:63], a[136:139], v[92:95]
    v_mfma_f32_16x16x32_bf16 v[120:123], a[60:63], a[140:143], v[120:123]
    buffer_load_dwordx4 a[36:39], v20, s[32:35], s60 offen offset:2048 sc1
    v_mfma_f32_16x16x32_bf16 v[40:43], a[64:67], a[128:131], v[40:43]
    v_mfma_f32_16x16x32_bf16 v[68:71], a[64:67], a[132:135], v[68:71]
    v_mfma_f32_16x16x32_bf16 v[96:99], a[64:67], a[136:139], v[96:99]
    v_mfma_f32_16x16x32_bf16 v[124:127], a[64:67], a[140:143], v[124:127]
    buffer_load_dwordx4 a[40:43], v20, s[32:35], s60 offen offset:3072 sc1
    v_mfma_f32_16x16x32_bf16 v[44:47], a[68:71], a[128:131], v[44:47]
    v_mfma_f32_16x16x32_bf16 v[72:75], a[68:71], a[132:135], v[72:75]
    v_mfma_f32_16x16x32_bf16 v[100:103], a[68:71], a[136:139], v[100:103]
    v_mfma_f32_16x16x32_bf16 v[128:131], a[68:71], a[140:143], v[128:131]
    buffer_load_dwordx4 a[44:47], v6, s[32:35], s60 offen offset:0 sc1
    v_mfma_f32_16x16x32_bf16 v[48:51], a[72:75], a[128:131], v[48:51]
    v_mfma_f32_16x16x32_bf16 v[76:79], a[72:75], a[132:135], v[76:79]
    v_mfma_f32_16x16x32_bf16 v[104:107], a[72:75], a[136:139], v[104:107]
    v_mfma_f32_16x16x32_bf16 v[132:135], a[72:75], a[140:143], v[132:135]
    buffer_load_dwordx4 a[48:51], v6, s[32:35], s60 offen offset:1024 sc1
    v_mfma_f32_16x16x32_bf16 v[52:55], a[76:79], a[128:131], v[52:55]
    v_mfma_f32_16x16x32_bf16 v[80:83], a[76:79], a[132:135], v[80:83]
    v_mfma_f32_16x16x32_bf16 v[108:111], a[76:79], a[136:139], v[108:111]
    v_mfma_f32_16x16x32_bf16 v[136:139], a[76:79], a[140:143], v[136:139]
    buffer_load_dwordx4 a[52:55], v6, s[32:35], s60 offen offset:2048 sc1
    v_mfma_f32_16x16x32_bf16 v[56:59], a[80:83], a[128:131], v[56:59]
    v_mfma_f32_16x16x32_bf16 v[84:87], a[80:83], a[132:135], v[84:87]
    v_mfma_f32_16x16x32_bf16 v[112:115], a[80:83], a[136:139], v[112:115]
    v_mfma_f32_16x16x32_bf16 v[140:143], a[80:83], a[140:143], v[140:143]
    s_waitcnt vmcnt(14)
    v_mfma_f32_16x16x32_bf16 v[32:35], a[84:87], a[144:147], v[32:35]
    ds_read_b64 v[160:161], v252 offset:1024
    s_add_u32 s60, s11, 344064
    buffer_load_dwordx4 a[56:59], v20, s[32:35], s60 offen offset:0 sc1
    v_mfma_f32_16x16x32_bf16 v[60:63], a[84:87], a[148:151], v[60:63]
    ds_read_b64 v[162:163], v253 offset:1024
    v_mfma_f32_16x16x32_bf16 v[88:91], a[84:87], a[152:155], v[88:91]
    ds_read_b64 v[164:165], v252 offset:3072
    v_mfma_f32_16x16x32_bf16 v[116:119], a[84:87], a[156:159], v[116:119]
    ds_read_b64 v[166:167], v253 offset:3072
    buffer_load_dwordx4 a[60:63], v20, s[32:35], s60 offen offset:1024 sc1
    v_mfma_f32_16x16x32_bf16 v[36:39], a[88:91], a[144:147], v[36:39]
    ds_read_b64 v[168:169], v252 offset:5120
    v_mfma_f32_16x16x32_bf16 v[64:67], a[88:91], a[148:151], v[64:67]
    ds_read_b64 v[170:171], v253 offset:5120
    v_mfma_f32_16x16x32_bf16 v[92:95], a[88:91], a[152:155], v[92:95]
    ds_read_b64 v[172:173], v252 offset:7168
    v_mfma_f32_16x16x32_bf16 v[120:123], a[88:91], a[156:159], v[120:123]
    ds_read_b64 v[174:175], v253 offset:7168
    buffer_load_dwordx4 a[64:67], v20, s[32:35], s60 offen offset:2048 sc1
    v_mfma_f32_16x16x32_bf16 v[40:43], a[92:95], a[144:147], v[40:43]
    v_mfma_f32_16x16x32_bf16 v[68:71], a[92:95], a[148:151], v[68:71]
    v_mfma_f32_16x16x32_bf16 v[96:99], a[92:95], a[152:155], v[96:99]
    v_mfma_f32_16x16x32_bf16 v[124:127], a[92:95], a[156:159], v[124:127]
    buffer_load_dwordx4 a[68:71], v20, s[32:35], s60 offen offset:3072 sc1
    v_mfma_f32_16x16x32_bf16 v[44:47], a[96:99], a[144:147], v[44:47]
    v_mfma_f32_16x16x32_bf16 v[72:75], a[96:99], a[148:151], v[72:75]
    v_mfma_f32_16x16x32_bf16 v[100:103], a[96:99], a[152:155], v[100:103]
    v_mfma_f32_16x16x32_bf16 v[128:131], a[96:99], a[156:159], v[128:131]
    buffer_load_dwordx4 a[72:75], v6, s[32:35], s60 offen offset:0 sc1
    v_mfma_f32_16x16x32_bf16 v[48:51], a[100:103], a[144:147], v[48:51]
    v_mfma_f32_16x16x32_bf16 v[76:79], a[100:103], a[148:151], v[76:79]
    v_mfma_f32_16x16x32_bf16 v[104:107], a[100:103], a[152:155], v[104:107]
    v_mfma_f32_16x16x32_bf16 v[132:135], a[100:103], a[156:159], v[132:135]
    buffer_load_dwordx4 a[76:79], v6, s[32:35], s60 offen offset:1024 sc1
    v_mfma_f32_16x16x32_bf16 v[52:55], a[104:107], a[144:147], v[52:55]
    v_mfma_f32_16x16x32_bf16 v[80:83], a[104:107], a[148:151], v[80:83]
    v_mfma_f32_16x16x32_bf16 v[108:111], a[104:107], a[152:155], v[108:111]
    v_mfma_f32_16x16x32_bf16 v[136:139], a[104:107], a[156:159], v[136:139]
    buffer_load_dwordx4 a[80:83], v6, s[32:35], s60 offen offset:2048 sc1
    v_mfma_f32_16x16x32_bf16 v[56:59], a[108:111], a[144:147], v[56:59]
    v_mfma_f32_16x16x32_bf16 v[84:87], a[108:111], a[148:151], v[84:87]
    v_mfma_f32_16x16x32_bf16 v[112:115], a[108:111], a[152:155], v[112:115]
    v_mfma_f32_16x16x32_bf16 v[140:143], a[108:111], a[156:159], v[140:143]
    s_waitcnt vmcnt(14) lgkmcnt(0)
    v_mfma_f32_16x16x32_bf16 v[32:35], a[0:3], v[160:163], v[32:35]
    ds_read_b64 v[176:177], v254 offset:1024
    s_add_u32 s60, s11, 401408
    buffer_load_dwordx4 a[84:87], v20, s[32:35], s60 offen offset:0 sc1
    v_mfma_f32_16x16x32_bf16 v[60:63], a[0:3], v[164:167], v[60:63]
    ds_read_b64 v[178:179], v255 offset:1024
    v_mfma_f32_16x16x32_bf16 v[88:91], a[0:3], v[168:171], v[88:91]
    ds_read_b64 v[180:181], v254 offset:3072
    v_mfma_f32_16x16x32_bf16 v[116:119], a[0:3], v[172:175], v[116:119]
    ds_read_b64 v[182:183], v255 offset:3072
    buffer_load_dwordx4 a[88:91], v20, s[32:35], s60 offen offset:1024 sc1
    v_mfma_f32_16x16x32_bf16 v[36:39], a[4:7], v[160:163], v[36:39]
    ds_read_b64 v[184:185], v254 offset:5120
    v_mfma_f32_16x16x32_bf16 v[64:67], a[4:7], v[164:167], v[64:67]
    ds_read_b64 v[186:187], v255 offset:5120
    v_mfma_f32_16x16x32_bf16 v[92:95], a[4:7], v[168:171], v[92:95]
    ds_read_b64 v[188:189], v254 offset:7168
    v_mfma_f32_16x16x32_bf16 v[120:123], a[4:7], v[172:175], v[120:123]
    ds_read_b64 v[190:191], v255 offset:7168
    buffer_load_dwordx4 a[92:95], v20, s[32:35], s60 offen offset:2048 sc1
    v_mfma_f32_16x16x32_bf16 v[40:43], a[8:11], v[160:163], v[40:43]
    v_mfma_f32_16x16x32_bf16 v[68:71], a[8:11], v[164:167], v[68:71]
    v_mfma_f32_16x16x32_bf16 v[96:99], a[8:11], v[168:171], v[96:99]
    v_mfma_f32_16x16x32_bf16 v[124:127], a[8:11], v[172:175], v[124:127]
    buffer_load_dwordx4 a[96:99], v20, s[32:35], s60 offen offset:3072 sc1
    v_mfma_f32_16x16x32_bf16 v[44:47], a[12:15], v[160:163], v[44:47]
    v_mfma_f32_16x16x32_bf16 v[72:75], a[12:15], v[164:167], v[72:75]
    v_mfma_f32_16x16x32_bf16 v[100:103], a[12:15], v[168:171], v[100:103]
    v_mfma_f32_16x16x32_bf16 v[128:131], a[12:15], v[172:175], v[128:131]
    buffer_load_dwordx4 a[100:103], v6, s[32:35], s60 offen offset:0 sc1
    v_mfma_f32_16x16x32_bf16 v[48:51], a[16:19], v[160:163], v[48:51]
    v_mfma_f32_16x16x32_bf16 v[76:79], a[16:19], v[164:167], v[76:79]
    v_mfma_f32_16x16x32_bf16 v[104:107], a[16:19], v[168:171], v[104:107]
    v_mfma_f32_16x16x32_bf16 v[132:135], a[16:19], v[172:175], v[132:135]
    buffer_load_dwordx4 a[104:107], v6, s[32:35], s60 offen offset:1024 sc1
    v_mfma_f32_16x16x32_bf16 v[52:55], a[20:23], v[160:163], v[52:55]
    v_mfma_f32_16x16x32_bf16 v[80:83], a[20:23], v[164:167], v[80:83]
    v_mfma_f32_16x16x32_bf16 v[108:111], a[20:23], v[168:171], v[108:111]
    v_mfma_f32_16x16x32_bf16 v[136:139], a[20:23], v[172:175], v[136:139]
    buffer_load_dwordx4 a[108:111], v6, s[32:35], s60 offen offset:2048 sc1
    v_mfma_f32_16x16x32_bf16 v[56:59], a[24:27], v[160:163], v[56:59]
    v_mfma_f32_16x16x32_bf16 v[84:87], a[24:27], v[164:167], v[84:87]
    v_mfma_f32_16x16x32_bf16 v[112:115], a[24:27], v[168:171], v[112:115]
    v_mfma_f32_16x16x32_bf16 v[140:143], a[24:27], v[172:175], v[140:143]
    s_waitcnt vmcnt(14) lgkmcnt(0)
    v_mfma_f32_16x16x32_bf16 v[32:35], a[28:31], v[176:179], v[32:35]
    ds_read_b64 v[160:161], v252 offset:9216
    s_add_u32 s60, s11, 573440
    buffer_load_dwordx4 a[0:3], v20, s[32:35], s60 offen offset:0 sc1
    v_mfma_f32_16x16x32_bf16 v[60:63], a[28:31], v[180:183], v[60:63]
    ds_read_b64 v[162:163], v253 offset:9216
    v_mfma_f32_16x16x32_bf16 v[88:91], a[28:31], v[184:187], v[88:91]
    ds_read_b64 v[164:165], v252 offset:11264
    v_mfma_f32_16x16x32_bf16 v[116:119], a[28:31], v[188:191], v[116:119]
    ds_read_b64 v[166:167], v253 offset:11264
    buffer_load_dwordx4 a[4:7], v20, s[32:35], s60 offen offset:1024 sc1
    v_mfma_f32_16x16x32_bf16 v[36:39], a[32:35], v[176:179], v[36:39]
    ds_read_b64 v[168:169], v252 offset:13312
    v_mfma_f32_16x16x32_bf16 v[64:67], a[32:35], v[180:183], v[64:67]
    ds_read_b64 v[170:171], v253 offset:13312
    v_mfma_f32_16x16x32_bf16 v[92:95], a[32:35], v[184:187], v[92:95]
    ds_read_b64 v[172:173], v252 offset:15360
    v_mfma_f32_16x16x32_bf16 v[120:123], a[32:35], v[188:191], v[120:123]
    ds_read_b64 v[174:175], v253 offset:15360
    buffer_load_dwordx4 a[8:11], v20, s[32:35], s60 offen offset:2048 sc1
    v_mfma_f32_16x16x32_bf16 v[40:43], a[36:39], v[176:179], v[40:43]
    v_mfma_f32_16x16x32_bf16 v[68:71], a[36:39], v[180:183], v[68:71]
    v_mfma_f32_16x16x32_bf16 v[96:99], a[36:39], v[184:187], v[96:99]
    v_mfma_f32_16x16x32_bf16 v[124:127], a[36:39], v[188:191], v[124:127]
    buffer_load_dwordx4 a[12:15], v20, s[32:35], s60 offen offset:3072 sc1
    v_mfma_f32_16x16x32_bf16 v[44:47], a[40:43], v[176:179], v[44:47]
    v_mfma_f32_16x16x32_bf16 v[72:75], a[40:43], v[180:183], v[72:75]
    v_mfma_f32_16x16x32_bf16 v[100:103], a[40:43], v[184:187], v[100:103]
    v_mfma_f32_16x16x32_bf16 v[128:131], a[40:43], v[188:191], v[128:131]
    buffer_load_dwordx4 a[16:19], v6, s[32:35], s60 offen offset:0 sc1
    v_mfma_f32_16x16x32_bf16 v[48:51], a[44:47], v[176:179], v[48:51]
    v_mfma_f32_16x16x32_bf16 v[76:79], a[44:47], v[180:183], v[76:79]
    v_mfma_f32_16x16x32_bf16 v[104:107], a[44:47], v[184:187], v[104:107]
    v_mfma_f32_16x16x32_bf16 v[132:135], a[44:47], v[188:191], v[132:135]
    buffer_load_dwordx4 a[20:23], v6, s[32:35], s60 offen offset:1024 sc1
    v_mfma_f32_16x16x32_bf16 v[52:55], a[48:51], v[176:179], v[52:55]
    v_mfma_f32_16x16x32_bf16 v[80:83], a[48:51], v[180:183], v[80:83]
    v_mfma_f32_16x16x32_bf16 v[108:111], a[48:51], v[184:187], v[108:111]
    v_mfma_f32_16x16x32_bf16 v[136:139], a[48:51], v[188:191], v[136:139]
    buffer_load_dwordx4 a[24:27], v6, s[32:35], s60 offen offset:2048 sc1
    v_mfma_f32_16x16x32_bf16 v[56:59], a[52:55], v[176:179], v[56:59]
    v_mfma_f32_16x16x32_bf16 v[84:87], a[52:55], v[180:183], v[84:87]
    v_mfma_f32_16x16x32_bf16 v[112:115], a[52:55], v[184:187], v[112:115]
    v_mfma_f32_16x16x32_bf16 v[140:143], a[52:55], v[188:191], v[140:143]
    s_waitcnt vmcnt(14) lgkmcnt(0)
    v_mfma_f32_16x16x32_bf16 v[32:35], a[56:59], v[160:163], v[32:35]
    ds_read_b64 v[176:177], v254 offset:9216
    buffer_load_dword v28, v25, s[44:47], s65 offen sc1
    v_mfma_f32_16x16x32_bf16 v[60:63], a[56:59], v[164:167], v[60:63]
    ds_read_b64 v[178:179], v255 offset:9216
    v_mfma_f32_16x16x32_bf16 v[88:91], a[56:59], v[168:171], v[88:91]
    ds_read_b64 v[180:181], v254 offset:11264
    v_mfma_f32_16x16x32_bf16 v[116:119], a[56:59], v[172:175], v[116:119]
    ds_read_b64 v[182:183], v255 offset:11264
    s_add_u32 s60, s11, 630784
    buffer_load_dwordx4 a[28:31], v20, s[32:35], s60 offen offset:0 sc1
    v_mfma_f32_16x16x32_bf16 v[36:39], a[60:63], v[160:163], v[36:39]
    ds_read_b64 v[184:185], v254 offset:13312
    v_mfma_f32_16x16x32_bf16 v[64:67], a[60:63], v[164:167], v[64:67]
    ds_read_b64 v[186:187], v255 offset:13312
    v_mfma_f32_16x16x32_bf16 v[92:95], a[60:63], v[168:171], v[92:95]
    ds_read_b64 v[188:189], v254 offset:15360
    buffer_load_dwordx4 a[32:35], v20, s[32:35], s60 offen offset:1024 sc1
    v_mfma_f32_16x16x32_bf16 v[120:123], a[60:63], v[172:175], v[120:123]
    ds_read_b64 v[190:191], v255 offset:15360
    v_mfma_f32_16x16x32_bf16 v[40:43], a[64:67], v[160:163], v[40:43]
    v_mfma_f32_16x16x32_bf16 v[68:71], a[64:67], v[164:167], v[68:71]
    v_mfma_f32_16x16x32_bf16 v[96:99], a[64:67], v[168:171], v[96:99]
    buffer_load_dwordx4 a[36:39], v20, s[32:35], s60 offen offset:2048 sc1
    v_mfma_f32_16x16x32_bf16 v[124:127], a[64:67], v[172:175], v[124:127]
    v_mfma_f32_16x16x32_bf16 v[44:47], a[68:71], v[160:163], v[44:47]
    v_mfma_f32_16x16x32_bf16 v[72:75], a[68:71], v[164:167], v[72:75]
    buffer_load_dwordx4 a[40:43], v20, s[32:35], s60 offen offset:3072 sc1
    v_mfma_f32_16x16x32_bf16 v[100:103], a[68:71], v[168:171], v[100:103]
    v_mfma_f32_16x16x32_bf16 v[128:131], a[68:71], v[172:175], v[128:131]
    v_mfma_f32_16x16x32_bf16 v[48:51], a[72:75], v[160:163], v[48:51]
    buffer_load_dwordx4 a[44:47], v6, s[32:35], s60 offen offset:0 sc1
    v_mfma_f32_16x16x32_bf16 v[76:79], a[72:75], v[164:167], v[76:79]
    v_mfma_f32_16x16x32_bf16 v[104:107], a[72:75], v[168:171], v[104:107]
    v_mfma_f32_16x16x32_bf16 v[132:135], a[72:75], v[172:175], v[132:135]
    v_mfma_f32_16x16x32_bf16 v[52:55], a[76:79], v[160:163], v[52:55]
    buffer_load_dwordx4 a[48:51], v6, s[32:35], s60 offen offset:1024 sc1
    v_mfma_f32_16x16x32_bf16 v[80:83], a[76:79], v[164:167], v[80:83]
    v_mfma_f32_16x16x32_bf16 v[108:111], a[76:79], v[168:171], v[108:111]
    v_mfma_f32_16x16x32_bf16 v[136:139], a[76:79], v[172:175], v[136:139]
    buffer_load_dwordx4 a[52:55], v6, s[32:35], s60 offen offset:2048 sc1
    v_mfma_f32_16x16x32_bf16 v[56:59], a[80:83], v[160:163], v[56:59]
    v_mfma_f32_16x16x32_bf16 v[84:87], a[80:83], v[164:167], v[84:87]
    v_mfma_f32_16x16x32_bf16 v[112:115], a[80:83], v[168:171], v[112:115]
    v_mfma_f32_16x16x32_bf16 v[140:143], a[80:83], v[172:175], v[140:143]
    s_waitcnt vmcnt(15) lgkmcnt(0)
    v_mfma_f32_16x16x32_bf16 v[32:35], a[84:87], v[176:179], v[32:35]
    ds_read_b64 v[160:161], v252 offset:17408
    s_add_u32 s60, s11, 802816
    buffer_load_dwordx4 a[56:59], v20, s[32:35], s60 offen offset:0 sc1
    v_mfma_f32_16x16x32_bf16 v[60:63], a[84:87], v[180:183], v[60:63]
    ds_read_b64 v[162:163], v253 offset:17408
    v_mfma_f32_16x16x32_bf16 v[88:91], a[84:87], v[184:187], v[88:91]
    ds_read_b64 v[164:165], v252 offset:19456
    v_mfma_f32_16x16x32_bf16 v[116:119], a[84:87], v[188:191], v[116:119]
    ds_read_b64 v[166:167], v253 offset:19456
    buffer_load_dwordx4 a[60:63], v20, s[32:35], s60 offen offset:1024 sc1
    v_mfma_f32_16x16x32_bf16 v[36:39], a[88:91], v[176:179], v[36:39]
    ds_read_b64 v[168:169], v252 offset:21504
    v_mfma_f32_16x16x32_bf16 v[64:67], a[88:91], v[180:183], v[64:67]
    ds_read_b64 v[170:171], v253 offset:21504
    v_mfma_f32_16x16x32_bf16 v[92:95], a[88:91], v[184:187], v[92:95]
    ds_read_b64 v[172:173], v252 offset:23552
    v_mfma_f32_16x16x32_bf16 v[120:123], a[88:91], v[188:191], v[120:123]
    ds_read_b64 v[174:175], v253 offset:23552
    buffer_load_dwordx4 a[64:67], v20, s[32:35], s60 offen offset:2048 sc1
    v_mfma_f32_16x16x32_bf16 v[40:43], a[92:95], v[176:179], v[40:43]
    v_mfma_f32_16x16x32_bf16 v[68:71], a[92:95], v[180:183], v[68:71]
    v_mfma_f32_16x16x32_bf16 v[96:99], a[92:95], v[184:187], v[96:99]
    v_mfma_f32_16x16x32_bf16 v[124:127], a[92:95], v[188:191], v[124:127]
    buffer_load_dwordx4 a[68:71], v20, s[32:35], s60 offen offset:3072 sc1
    v_mfma_f32_16x16x32_bf16 v[44:47], a[96:99], v[176:179], v[44:47]
    v_mfma_f32_16x16x32_bf16 v[72:75], a[96:99], v[180:183], v[72:75]
    v_mfma_f32_16x16x32_bf16 v[100:103], a[96:99], v[184:187], v[100:103]
    v_mfma_f32_16x16x32_bf16 v[128:131], a[96:99], v[188:191], v[128:131]
    buffer_load_dwordx4 a[72:75], v6, s[32:35], s60 offen offset:0 sc1
    v_mfma_f32_16x16x32_bf16 v[48:51], a[100:103], v[176:179], v[48:51]
    v_mfma_f32_16x16x32_bf16 v[76:79], a[100:103], v[180:183], v[76:79]
    v_mfma_f32_16x16x32_bf16 v[104:107], a[100:103], v[184:187], v[104:107]
    v_mfma_f32_16x16x32_bf16 v[132:135], a[100:103], v[188:191], v[132:135]
    buffer_load_dwordx4 a[76:79], v6, s[32:35], s60 offen offset:1024 sc1
    v_mfma_f32_16x16x32_bf16 v[52:55], a[104:107], v[176:179], v[52:55]
    v_mfma_f32_16x16x32_bf16 v[80:83], a[104:107], v[180:183], v[80:83]
    v_mfma_f32_16x16x32_bf16 v[108:111], a[104:107], v[184:187], v[108:111]
    v_mfma_f32_16x16x32_bf16 v[136:139], a[104:107], v[188:191], v[136:139]
    buffer_load_dwordx4 a[80:83], v6, s[32:35], s60 offen offset:2048 sc1
    v_mfma_f32_16x16x32_bf16 v[56:59], a[108:111], v[176:179], v[56:59]
    v_mfma_f32_16x16x32_bf16 v[84:87], a[108:111], v[180:183], v[84:87]
    v_mfma_f32_16x16x32_bf16 v[112:115], a[108:111], v[184:187], v[112:115]
    v_mfma_f32_16x16x32_bf16 v[140:143], a[108:111], v[188:191], v[140:143]
    s_waitcnt vmcnt(15) lgkmcnt(0)
    v_mfma_f32_16x16x32_bf16 v[32:35], a[0:3], v[160:163], v[32:35]
    ds_read_b64 v[176:177], v254 offset:17408
    s_add_u32 s60, s11, 860160
    buffer_load_dwordx4 a[84:87], v20, s[32:35], s60 offen offset:0 sc1
    v_mfma_f32_16x16x32_bf16 v[60:63], a[0:3], v[164:167], v[60:63]
    ds_read_b64 v[178:179], v255 offset:17408
    v_mfma_f32_16x16x32_bf16 v[88:91], a[0:3], v[168:171], v[88:91]
    ds_read_b64 v[180:181], v254 offset:19456
    v_mfma_f32_16x16x32_bf16 v[116:119], a[0:3], v[172:175], v[116:119]
    ds_read_b64 v[182:183], v255 offset:19456
    buffer_load_dwordx4 a[88:91], v20, s[32:35], s60 offen offset:1024 sc1
    v_mfma_f32_16x16x32_bf16 v[36:39], a[4:7], v[160:163], v[36:39]
    ds_read_b64 v[184:185], v254 offset:21504
    v_mfma_f32_16x16x32_bf16 v[64:67], a[4:7], v[164:167], v[64:67]
    ds_read_b64 v[186:187], v255 offset:21504
    v_mfma_f32_16x16x32_bf16 v[92:95], a[4:7], v[168:171], v[92:95]
    ds_read_b64 v[188:189], v254 offset:23552
    v_mfma_f32_16x16x32_bf16 v[120:123], a[4:7], v[172:175], v[120:123]
    ds_read_b64 v[190:191], v255 offset:23552
    buffer_load_dwordx4 a[92:95], v20, s[32:35], s60 offen offset:2048 sc1
    v_mfma_f32_16x16x32_bf16 v[40:43], a[8:11], v[160:163], v[40:43]
    v_mfma_f32_16x16x32_bf16 v[68:71], a[8:11], v[164:167], v[68:71]
    v_mfma_f32_16x16x32_bf16 v[96:99], a[8:11], v[168:171], v[96:99]
    v_mfma_f32_16x16x32_bf16 v[124:127], a[8:11], v[172:175], v[124:127]
    buffer_load_dwordx4 a[96:99], v20, s[32:35], s60 offen offset:3072 sc1
    v_mfma_f32_16x16x32_bf16 v[44:47], a[12:15], v[160:163], v[44:47]
    v_mfma_f32_16x16x32_bf16 v[72:75], a[12:15], v[164:167], v[72:75]
    v_mfma_f32_16x16x32_bf16 v[100:103], a[12:15], v[168:171], v[100:103]
    v_mfma_f32_16x16x32_bf16 v[128:131], a[12:15], v[172:175], v[128:131]
    buffer_load_dwordx4 a[100:103], v6, s[32:35], s60 offen offset:0 sc1
    v_mfma_f32_16x16x32_bf16 v[48:51], a[16:19], v[160:163], v[48:51]
    v_mfma_f32_16x16x32_bf16 v[76:79], a[16:19], v[164:167], v[76:79]
    v_mfma_f32_16x16x32_bf16 v[104:107], a[16:19], v[168:171], v[104:107]
    v_mfma_f32_16x16x32_bf16 v[132:135], a[16:19], v[172:175], v[132:135]
    buffer_load_dwordx4 a[104:107], v6, s[32:35], s60 offen offset:1024 sc1
    v_mfma_f32_16x16x32_bf16 v[52:55], a[20:23], v[160:163], v[52:55]
    v_mfma_f32_16x16x32_bf16 v[80:83], a[20:23], v[164:167], v[80:83]
    v_mfma_f32_16x16x32_bf16 v[108:111], a[20:23], v[168:171], v[108:111]
    v_mfma_f32_16x16x32_bf16 v[136:139], a[20:23], v[172:175], v[136:139]
    buffer_load_dwordx4 a[108:111], v6, s[32:35], s60 offen offset:2048 sc1
    v_mfma_f32_16x16x32_bf16 v[56:59], a[24:27], v[160:163], v[56:59]
    v_mfma_f32_16x16x32_bf16 v[84:87], a[24:27], v[164:167], v[84:87]
    v_mfma_f32_16x16x32_bf16 v[112:115], a[24:27], v[168:171], v[112:115]
    v_mfma_f32_16x16x32_bf16 v[140:143], a[24:27], v[172:175], v[140:143]
    s_waitcnt vmcnt(21)
    s_waitcnt vmcnt(14) lgkmcnt(0)
    v_cmp_ne_u32 vcc, s49, v28
    s_nop 3
    s_cbranch_vccnz L_FA_pd
L_FA_pd_go:
    v_mfma_f32_16x16x32_bf16 v[32:35], a[28:31], v[176:179], v[32:35]
    ds_read_b64 v[160:161], v252 offset:25600
    buffer_load_dwordx2 v[192:193], v20, s[36:39], s62 offen offset:0 sc1
    v_mfma_f32_16x16x32_bf16 v[60:63], a[28:31], v[180:183], v[60:63]
    ds_read_b64 v[162:163], v253 offset:25600
    v_mfma_f32_16x16x32_bf16 v[88:91], a[28:31], v[184:187], v[88:91]
    ds_read_b64 v[164:165], v252 offset:27648
    v_mfma_f32_16x16x32_bf16 v[116:119], a[28:31], v[188:191], v[116:119]
    ds_read_b64 v[166:167], v253 offset:27648
    buffer_load_dwordx2 v[194:195], v20, s[36:39], s62 offen offset:1024 sc1
    v_mfma_f32_16x16x32_bf16 v[36:39], a[32:35], v[176:179], v[36:39]
    ds_read_b64 v[168:169], v252 offset:29696
    v_mfma_f32_16x16x32_bf16 v[64:67], a[32:35], v[180:183], v[64:67]
    ds_read_b64 v[170:171], v253 offset:29696
    v_mfma_f32_16x16x32_bf16 v[92:95], a[32:35], v[184:187], v[92:95]
    ds_read_b64 v[172:173], v252 offset:31744
    v_mfma_f32_16x16x32_bf16 v[120:123], a[32:35], v[188:191], v[120:123]
    ds_read_b64 v[174:175], v253 offset:31744
    buffer_load_dwordx2 v[196:197], v20, s[36:39], s62 offen offset:2048 sc1
    v_mfma_f32_16x16x32_bf16 v[40:43], a[36:39], v[176:179], v[40:43]
    v_mfma_f32_16x16x32_bf16 v[68:71], a[36:39], v[180:183], v[68:71]
    v_mfma_f32_16x16x32_bf16 v[96:99], a[36:39], v[184:187], v[96:99]
    v_mfma_f32_16x16x32_bf16 v[124:127], a[36:39], v[188:191], v[124:127]
    buffer_load_dwordx2 v[198:199], v20, s[36:39], s62 offen offset:3072 sc1
    v_mfma_f32_16x16x32_bf16 v[44:47], a[40:43], v[176:179], v[44:47]
    v_mfma_f32_16x16x32_bf16 v[72:75], a[40:43], v[180:183], v[72:75]
    v_mfma_f32_16x16x32_bf16 v[100:103], a[40:43], v[184:187], v[100:103]
    v_mfma_f32_16x16x32_bf16 v[128:131], a[40:43], v[188:191], v[128:131]
    buffer_load_dwordx2 v[200:201], v6, s[36:39], s62 offen offset:0 sc1
    v_mfma_f32_16x16x32_bf16 v[48:51], a[44:47], v[176:179], v[48:51]
    v_mfma_f32_16x16x32_bf16 v[76:79], a[44:47], v[180:183], v[76:79]
    v_mfma_f32_16x16x32_bf16 v[104:107], a[44:47], v[184:187], v[104:107]
    v_mfma_f32_16x16x32_bf16 v[132:135], a[44:47], v[188:191], v[132:135]
    buffer_load_dwordx2 v[202:203], v6, s[36:39], s62 offen offset:1024 sc1
    v_mfma_f32_16x16x32_bf16 v[52:55], a[48:51], v[176:179], v[52:55]
    v_mfma_f32_16x16x32_bf16 v[80:83], a[48:51], v[180:183], v[80:83]
    v_mfma_f32_16x16x32_bf16 v[108:111], a[48:51], v[184:187], v[108:111]
    v_mfma_f32_16x16x32_bf16 v[136:139], a[48:51], v[188:191], v[136:139]
    buffer_load_dwordx2 v[204:205], v6, s[36:39], s62 offen offset:2048 sc1
    v_mfma_f32_16x16x32_bf16 v[56:59], a[52:55], v[176:179], v[56:59]
    v_mfma_f32_16x16x32_bf16 v[84:87], a[52:55], v[180:183], v[84:87]
    v_mfma_f32_16x16x32_bf16 v[112:115], a[52:55], v[184:187], v[112:115]
    v_mfma_f32_16x16x32_bf16 v[140:143], a[52:55], v[188:191], v[140:143]
    s_add_u32 s28, s24, 16777216
    s_addc_u32 s29, s25, 0
    s_mov_b32 s30, 1441792
    s_mov_b32 s31, 0x20000
    s_waitcnt vmcnt(14) lgkmcnt(0)
    v_mfma_f32_16x16x32_bf16 v[32:35], a[56:59], v[160:163], v[32:35]
    ds_read_b64 v[176:177], v254 offset:25600
    buffer_load_dwordx4 a[192:195], v20, s[28:31], s101 offen offset:0 sc1
    v_mfma_f32_16x16x32_bf16 v[60:63], a[56:59], v[164:167], v[60:63]
    ds_read_b64 v[178:179], v255 offset:25600
    v_mfma_f32_16x16x32_bf16 v[88:91], a[56:59], v[168:171], v[88:91]
    ds_read_b64 v[180:181], v254 offset:27648
    v_mfma_f32_16x16x32_bf16 v[116:119], a[56:59], v[172:175], v[116:119]
    ds_read_b64 v[182:183], v255 offset:27648
    v_mfma_f32_16x16x32_bf16 v[36:39], a[60:63], v[160:163], v[36:39]
    ds_read_b64 v[184:185], v254 offset:29696
    v_mfma_f32_16x16x32_bf16 v[64:67], a[60:63], v[164:167], v[64:67]
    ds_read_b64 v[186:187], v255 offset:29696
    v_mfma_f32_16x16x32_bf16 v[92:95], a[60:63], v[168:171], v[92:95]
    ds_read_b64 v[188:189], v254 offset:31744
    buffer_load_dwordx4 a[196:199], v20, s[28:31], s101 offen offset:1024 sc1
    v_mfma_f32_16x16x32_bf16 v[120:123], a[60:63], v[172:175], v[120:123]
    ds_read_b64 v[190:191], v255 offset:31744
    v_mfma_f32_16x16x32_bf16 v[40:43], a[64:67], v[160:163], v[40:43]
    v_mfma_f32_16x16x32_bf16 v[68:71], a[64:67], v[164:167], v[68:71]
    v_mfma_f32_16x16x32_bf16 v[96:99], a[64:67], v[168:171], v[96:99]
    v_mfma_f32_16x16x32_bf16 v[124:127], a[64:67], v[172:175], v[124:127]
    v_mfma_f32_16x16x32_bf16 v[44:47], a[68:71], v[160:163], v[44:47]
    v_mfma_f32_16x16x32_bf16 v[72:75], a[68:71], v[164:167], v[72:75]
    buffer_load_dwordx4 a[200:203], v20, s[28:31], s101 offen offset:2048 sc1
    v_mfma_f32_16x16x32_bf16 v[100:103], a[68:71], v[168:171], v[100:103]
    v_mfma_f32_16x16x32_bf16 v[128:131], a[68:71], v[172:175], v[128:131]
    v_mfma_f32_16x16x32_bf16 v[48:51], a[72:75], v[160:163], v[48:51]
    v_mfma_f32_16x16x32_bf16 v[76:79], a[72:75], v[164:167], v[76:79]
    v_mfma_f32_16x16x32_bf16 v[104:107], a[72:75], v[168:171], v[104:107]
    v_mfma_f32_16x16x32_bf16 v[132:135], a[72:75], v[172:175], v[132:135]
    v_mfma_f32_16x16x32_bf16 v[52:55], a[76:79], v[160:163], v[52:55]
    buffer_load_dwordx4 a[204:207], v20, s[28:31], s101 offen offset:3072 sc1
    s_add_u32 s101, s101, 32768
    v_mfma_f32_16x16x32_bf16 v[80:83], a[76:79], v[164:167], v[80:83]
    v_mfma_f32_16x16x32_bf16 v[108:111], a[76:79], v[168:171], v[108:111]
    v_mfma_f32_16x16x32_bf16 v[136:139], a[76:79], v[172:175], v[136:139]
    v_mfma_f32_16x16x32_bf16 v[56:59], a[80:83], v[160:163], v[56:59]
    v_mfma_f32_16x16x32_bf16 v[84:87], a[80:83], v[164:167], v[84:87]
    v_mfma_f32_16x16x32_bf16 v[112:115], a[80:83], v[168:171], v[112:115]
    v_mfma_f32_16x16x32_bf16 v[140:143], a[80:83], v[172:175], v[140:143]
    s_waitcnt vmcnt(11) lgkmcnt(0)
    v_mfma_f32_16x16x32_bf16 v[116:119], a[84:87], v[188:191], v[116:119]
    buffer_load_dwordx4 a[128:131], v20, s[40:43], s3 offen offset:0 sc1
    v_mfma_f32_16x16x32_bf16 v[120:123], a[88:91], v[188:191], v[120:123]
    v_mfma_f32_16x16x32_bf16 v[124:127], a[92:95], v[188:191], v[124:127]
    v_mfma_f32_16x16x32_bf16 v[128:131], a[96:99], v[188:191], v[128:131]
    buffer_load_dwordx4 a[132:135], v20, s[40:43], s10 offen offset:0 sc1
    v_mfma_f32_16x16x32_bf16 v[132:135], a[100:103], v[188:191], v[132:135]
    v_mfma_f32_16x16x32_bf16 v[136:139], a[104:107], v[188:191], v[136:139]
    v_mfma_f32_16x16x32_bf16 v[140:143], a[108:111], v[188:191], v[140:143]
    buffer_load_dwordx4 a[136:139], v20, s[40:43], s100 offen offset:0 sc1
    v_mfma_f32_16x16x32_bf16 v[88:91], a[84:87], v[184:187], v[88:91]
    v_mfma_f32_16x16x32_bf16 v[92:95], a[88:91], v[184:187], v[92:95]
    v_mfma_f32_16x16x32_bf16 v[96:99], a[92:95], v[184:187], v[96:99]
    ds_write_b128 v12, v[116:119] offset:16384
    v_mfma_f32_16x16x32_bf16 v[100:103], a[96:99], v[184:187], v[100:103]
    ds_write_b128 v12, v[120:123] offset:17408
    buffer_load_dwordx4 a[140:143], v20, s[40:43], s78 offen offset:0 sc1
    v_mfma_f32_16x16x32_bf16 v[104:107], a[100:103], v[184:187], v[104:107]
    ds_write_b128 v12, v[124:127] offset:18432
    v_mfma_f32_16x16x32_bf16 v[108:111], a[104:107], v[184:187], v[108:111]
    ds_write_b128 v12, v[128:131] offset:19456
    v_mfma_f32_16x16x32_bf16 v[112:115], a[108:111], v[184:187], v[112:115]
    ds_write_b128 v12, v[132:135] offset:20480
    buffer_load_dwordx4 a[208:211], v20, s[28:31], s101 offen offset:0 sc1
    v_mfma_f32_16x16x32_bf16 v[60:63], a[84:87], v[180:183], v[60:63]
    ds_write_b128 v12, v[136:139] offset:21504
    v_mfma_f32_16x16x32_bf16 v[64:67], a[88:91], v[180:183], v[64:67]
    ds_write_b128 v12, v[140:143] offset:22528
    v_mfma_f32_16x16x32_bf16 v[68:71], a[92:95], v[180:183], v[68:71]
    ds_write_b128 v12, v[88:91] offset:8192
    buffer_load_dwordx4 a[212:215], v20, s[28:31], s101 offen offset:1024 sc1
    v_mfma_f32_16x16x32_bf16 v[72:75], a[96:99], v[180:183], v[72:75]
    ds_write_b128 v12, v[92:95] offset:9216
    v_mfma_f32_16x16x32_bf16 v[76:79], a[100:103], v[180:183], v[76:79]
    ds_write_b128 v12, v[96:99] offset:10240
    v_mfma_f32_16x16x32_bf16 v[80:83], a[104:107], v[180:183], v[80:83]
    ds_write_b128 v12, v[100:103] offset:11264
    v_mfma_f32_16x16x32_bf16 v[84:87], a[108:111], v[180:183], v[84:87]
    ds_write_b128 v12, v[104:107] offset:12288
    buffer_load_dwordx4 a[216:219], v20, s[28:31], s101 offen offset:2048 sc1
    v_mfma_f32_16x16x32_bf16 v[32:35], a[84:87], v[176:179], v[32:35]
    ds_write_b128 v12, v[108:111] offset:13312
    v_mfma_f32_16x16x32_bf16 v[36:39], a[88:91], v[176:179], v[36:39]
    ds_write_b128 v12, v[112:115] offset:14336
    v_mfma_f32_16x16x32_bf16 v[40:43], a[92:95], v[176:179], v[40:43]
    ds_write_b128 v12, v[60:63] offset:0
    buffer_load_dwordx4 a[220:223], v20, s[28:31], s101 offen offset:3072 sc1
    s_add_u32 s101, s101, 32768
    v_mfma_f32_16x16x32_bf16 v[44:47], a[96:99], v[176:179], v[44:47]
    ds_write_b128 v12, v[64:67] offset:1024
    v_mfma_f32_16x16x32_bf16 v[48:51], a[100:103], v[176:179], v[48:51]
    ds_write_b128 v12, v[68:71] offset:2048
    v_mfma_f32_16x16x32_bf16 v[52:55], a[104:107], v[176:179], v[52:55]
    ds_write_b128 v12, v[72:75] offset:3072
    v_mfma_f32_16x16x32_bf16 v[56:59], a[108:111], v[176:179], v[56:59]
    ds_write_b128 v12, v[76:79] offset:4096
    s_waitcnt vmcnt(12)
    ds_write_b128 v12, v[80:83] offset:5120
    buffer_load_dwordx4 a[144:147], v20, s[40:43], s3 offen offset:1024 sc1
    ds_write_b128 v12, v[84:87] offset:6144
    buffer_load_dwordx4 a[148:151], v20, s[40:43], s10 offen offset:1024 sc1
    v_lshlrev_b32 v208, 16, v192
    v_and_b32 v209, 0xffff0000, v192
    buffer_load_dwordx4 a[152:155], v20, s[40:43], s100 offen offset:1024 sc1
    v_lshlrev_b32 v210, 16, v193
    v_and_b32 v211, 0xffff0000, v193
    buffer_load_dwordx4 a[156:159], v20, s[40:43], s78 offen offset:1024 sc1
    v_lshlrev_b32 v212, 16, v194
    v_and_b32 v213, 0xffff0000, v194
    buffer_load_dwordx4 a[224:227], v20, s[28:31], s101 offen offset:0 sc1
    v_lshlrev_b32 v214, 16, v195
    v_and_b32 v215, 0xffff0000, v195
    buffer_load_dwordx4 a[228:231], v20, s[28:31], s101 offen offset:1024 sc1
    v_lshlrev_b32 v216, 16, v196
    v_and_b32 v217, 0xffff0000, v196
    buffer_load_dwordx4 a[232:235], v20, s[28:31], s101 offen offset:2048 sc1
    v_lshlrev_b32 v218, 16, v197
    v_and_b32 v219, 0xffff0000, v197
    buffer_load_dwordx4 a[236:239], v20, s[28:31], s101 offen offset:3072 sc1
    s_add_u32 s101, s101, 32768
    v_lshlrev_b32 v220, 16, v198
    v_and_b32 v221, 0xffff0000, v198
    buffer_load_dwordx4 a[160:163], v20, s[40:43], s3 offen offset:2048 sc1
    v_lshlrev_b32 v222, 16, v199
    v_and_b32 v223, 0xffff0000, v199
    buffer_load_dwordx4 a[164:167], v20, s[40:43], s10 offen offset:2048 sc1
    v_lshlrev_b32 v224, 16, v200
    v_and_b32 v225, 0xffff0000, v200
    buffer_load_dwordx4 a[168:171], v20, s[40:43], s100 offen offset:2048 sc1
    v_lshlrev_b32 v226, 16, v201
    v_and_b32 v227, 0xffff0000, v201
    buffer_load_dwordx4 a[172:175], v20, s[40:43], s78 offen offset:2048 sc1
    v_lshlrev_b32 v228, 16, v202
    v_and_b32 v229, 0xffff0000, v202
    v_lshlrev_b32 v230, 16, v203
    v_and_b32 v231, 0xffff0000, v203
    v_lshlrev_b32 v232, 16, v204
    v_and_b32 v233, 0xffff0000, v204
    v_lshlrev_b32 v234, 16, v205
    v_and_b32 v235, 0xffff0000, v205
    v_lshlrev_b32 v18, 16, v18
    v_pk_add_f32 v[32:33], v[32:33], v[18:19] op_sel_hi:[1,0]
    v_pk_add_f32 v[34:35], v[34:35], v[18:19] op_sel_hi:[1,0]
    v_pk_add_f32 v[36:37], v[36:37], v[18:19] op_sel_hi:[1,0]
    v_pk_add_f32 v[38:39], v[38:39], v[18:19] op_sel_hi:[1,0]
    v_pk_add_f32 v[40:41], v[40:41], v[18:19] op_sel_hi:[1,0]
    v_pk_add_f32 v[42:43], v[42:43], v[18:19] op_sel_hi:[1,0]
    v_pk_add_f32 v[44:45], v[44:45], v[18:19] op_sel_hi:[1,0]
    v_pk_add_f32 v[46:47], v[46:47], v[18:19] op_sel_hi:[1,0]
    v_pk_add_f32 v[48:49], v[48:49], v[18:19] op_sel_hi:[1,0]
    v_pk_add_f32 v[50:51], v[50:51], v[18:19] op_sel_hi:[1,0]
    v_pk_add_f32 v[52:53], v[52:53], v[18:19] op_sel_hi:[1,0]
    v_pk_add_f32 v[54:55], v[54:55], v[18:19] op_sel_hi:[1,0]
    v_pk_add_f32 v[56:57], v[56:57], v[18:19] op_sel_hi:[1,0]
    v_pk_add_f32 v[58:59], v[58:59], v[18:19] op_sel_hi:[1,0]
    s_waitcnt lgkmcnt(0)
    s_barrier
    ds_read_b128 v[60:63], v13 offset:0
    ds_read_b128 v[64:67], v14 offset:0
    ds_read_b128 v[68:71], v15 offset:0
    ds_read_b128 v[72:75], v13 offset:1024
    ds_read_b128 v[76:79], v14 offset:1024
    ds_read_b128 v[80:83], v15 offset:1024
    ds_read_b128 v[84:87], v13 offset:2048
    ds_read_b128 v[88:91], v14 offset:2048
    ds_read_b128 v[92:95], v15 offset:2048
    ds_read_b128 v[96:99], v13 offset:3072
    ds_read_b128 v[100:103], v14 offset:3072
    ds_read_b128 v[104:107], v15 offset:3072
    ds_read_b128 v[108:111], v13 offset:4096
    ds_read_b128 v[112:115], v14 offset:4096
    ds_read_b128 v[116:119], v15 offset:4096
    ds_read_b128 v[120:123], v13 offset:5120
    ds_read_b128 v[124:127], v14 offset:5120
    ds_read_b128 v[128:131], v15 offset:5120
    ds_read_b128 v[132:135], v13 offset:6144
    ds_read_b128 v[136:139], v14 offset:6144
    ds_read_b128 v[140:143], v15 offset:6144
    s_waitcnt lgkmcnt(15)
    v_pk_add_f32 v[32:33], v[32:33], v[60:61]
    v_pk_add_f32 v[34:35], v[34:35], v[62:63]
    v_pk_add_f32 v[64:65], v[64:65], v[68:69]
    v_pk_add_f32 v[66:67], v[66:67], v[70:71]
    v_pk_add_f32 v[32:33], v[32:33], v[64:65]
    v_pk_add_f32 v[34:35], v[34:35], v[66:67]
    v_pk_mul_f32 v[32:33], v[32:33], v[208:209]
    v_pk_mul_f32 v[34:35], v[34:35], v[210:211]
    v_cvt_pk_bf16_f32 v192, v32, v33
    v_cvt_pk_bf16_f32 v193, v34, v35
    v_pk_add_f32 v[36:37], v[36:37], v[72:73]
    v_pk_add_f32 v[38:39], v[38:39], v[74:75]
    v_pk_add_f32 v[76:77], v[76:77], v[80:81]
    v_pk_add_f32 v[78:79], v[78:79], v[82:83]
    v_pk_add_f32 v[36:37], v[36:37], v[76:77]
    v_pk_add_f32 v[38:39], v[38:39], v[78:79]
    v_pk_mul_f32 v[36:37], v[36:37], v[212:213]
    v_pk_mul_f32 v[38:39], v[38:39], v[214:215]
    v_cvt_pk_bf16_f32 v194, v36, v37
    v_cvt_pk_bf16_f32 v195, v38, v39
    s_waitcnt lgkmcnt(12)
    v_pk_add_f32 v[40:41], v[40:41], v[84:85]
    v_pk_add_f32 v[42:43], v[42:43], v[86:87]
    v_pk_add_f32 v[88:89], v[88:89], v[92:93]
    v_pk_add_f32 v[90:91], v[90:91], v[94:95]
    v_pk_add_f32 v[40:41], v[40:41], v[88:89]
    v_pk_add_f32 v[42:43], v[42:43], v[90:91]
    v_pk_mul_f32 v[40:41], v[40:41], v[216:217]
    v_pk_mul_f32 v[42:43], v[42:43], v[218:219]
    v_cvt_pk_bf16_f32 v196, v40, v41
    v_cvt_pk_bf16_f32 v197, v42, v43
    s_waitcnt lgkmcnt(9)
    v_pk_add_f32 v[44:45], v[44:45], v[96:97]
    v_pk_add_f32 v[46:47], v[46:47], v[98:99]
    v_pk_add_f32 v[100:101], v[100:101], v[104:105]
    v_pk_add_f32 v[102:103], v[102:103], v[106:107]
    v_pk_add_f32 v[44:45], v[44:45], v[100:101]
    v_pk_add_f32 v[46:47], v[46:47], v[102:103]
    v_pk_mul_f32 v[44:45], v[44:45], v[220:221]
    v_pk_mul_f32 v[46:47], v[46:47], v[222:223]
    v_cvt_pk_bf16_f32 v198, v44, v45
    v_cvt_pk_bf16_f32 v199, v46, v47
    s_waitcnt lgkmcnt(6)
    v_pk_add_f32 v[48:49], v[48:49], v[108:109]
    v_pk_add_f32 v[50:51], v[50:51], v[110:111]
    v_pk_add_f32 v[112:113], v[112:113], v[116:117]
    v_pk_add_f32 v[114:115], v[114:115], v[118:119]
    v_pk_add_f32 v[48:49], v[48:49], v[112:113]
    v_pk_add_f32 v[50:51], v[50:51], v[114:115]
    v_pk_mul_f32 v[48:49], v[48:49], v[224:225]
    v_pk_mul_f32 v[50:51], v[50:51], v[226:227]
    v_cvt_pk_bf16_f32 v200, v48, v49
    v_cvt_pk_bf16_f32 v201, v50, v51
    s_waitcnt lgkmcnt(3)
    v_pk_add_f32 v[52:53], v[52:53], v[120:121]
    v_pk_add_f32 v[54:55], v[54:55], v[122:123]
    v_pk_add_f32 v[124:125], v[124:125], v[128:129]
    v_pk_add_f32 v[126:127], v[126:127], v[130:131]
    v_pk_add_f32 v[52:53], v[52:53], v[124:125]
    v_pk_add_f32 v[54:55], v[54:55], v[126:127]
    v_pk_mul_f32 v[52:53], v[52:53], v[228:229]
    v_pk_mul_f32 v[54:55], v[54:55], v[230:231]
    v_cvt_pk_bf16_f32 v202, v52, v53
    v_cvt_pk_bf16_f32 v203, v54, v55
    s_waitcnt lgkmcnt(0)
    v_pk_add_f32 v[56:57], v[56:57], v[132:133]
    v_pk_add_f32 v[58:59], v[58:59], v[134:135]
    v_pk_add_f32 v[136:137], v[136:137], v[140:141]
    v_pk_add_f32 v[138:139], v[138:139], v[142:143]
    v_pk_add_f32 v[56:57], v[56:57], v[136:137]
    v_pk_add_f32 v[58:59], v[58:59], v[138:139]
    v_pk_mul_f32 v[56:57], v[56:57], v[232:233]
    v_pk_mul_f32 v[58:59], v[58:59], v[234:235]
    v_cvt_pk_bf16_f32 v204, v56, v57
    v_cvt_pk_bf16_f32 v205, v58, v59
    s_bitcmp1_b32 s74, 0
    s_cbranch_scc1 L_FA_odd
    buffer_store_dwordx4 v[192:195], v20, s[40:43], s64 offen offset:0 sc1
    buffer_store_dwordx4 v[196:199], v20, s[40:43], s64 offen offset:1024 sc1
    buffer_store_dwordx4 v[200:203], v20, s[40:43], s64 offen offset:2048 sc1
    buffer_store_dwordx2 v[204:205], v20, s[40:43], s64 offen offset:3072 sc1
    s_branch L_FA_hd
L_FA_odd:
    buffer_store_dwordx2 v[192:193], v20, s[40:43], s64 offen offset:8 sc1
    buffer_store_dwordx4 v[194:197], v20, s[40:43], s64 offen offset:1024 sc1
    buffer_store_dwordx4 v[198:201], v20, s[40:43], s64 offen offset:2048 sc1
    buffer_store_dwordx4 v[202:205], v20, s[40:43], s64 offen offset:3072 sc1
L_FA_hd:
L_F_p3:
    buffer_load_dwordx4 a[240:243], v20, s[28:31], s101 offen offset:0 sc1
    buffer_load_dwordx4 a[244:247], v20, s[28:31], s101 offen offset:1024 sc1
    buffer_load_dwordx4 a[248:251], v20, s[28:31], s101 offen offset:2048 sc1
    buffer_load_dwordx4 a[252:255], v20, s[28:31], s101 offen offset:3072 sc1
    s_mul_i32 s65, s48, 98304
    s_add_u32 s101, s101, s65
    s_add_u32 s101, s101, 425984
    buffer_load_dwordx4 a[176:179], v20, s[40:43], s3 offen offset:3072 sc1
    buffer_load_dwordx4 a[180:183], v20, s[40:43], s10 offen offset:3072 sc1
    buffer_load_dwordx4 a[184:187], v20, s[40:43], s100 offen offset:3072 sc1
    buffer_load_dwordx4 a[188:191], v20, s[40:43], s78 offen offset:3072 sc1
    s_waitcnt vmcnt(8)
    s_mov_b64 exec, 1
    buffer_store_dword v29, v30, s[44:47], s66 offen sc1
    s_mov_b64 exec, -1
    v_mfma_f32_16x16x32_bf16 v[32:35], a[192:195], a[128:131], 0
    v_mfma_f32_16x16x32_bf16 v[48:51], a[192:195], a[132:135], 0
    v_mfma_f32_16x16x32_bf16 v[64:67], a[192:195], a[136:139], 0
    v_mfma_f32_16x16x32_bf16 v[80:83], a[192:195], a[140:143], 0
    buffer_load_dwordx4 a[0:3], v20, s[28:31], s101 offen offset:0 sc1
    v_mfma_f32_16x16x32_bf16 v[36:39], a[196:199], a[128:131], 0
    v_mfma_f32_16x16x32_bf16 v[52:55], a[196:199], a[132:135], 0
    v_mfma_f32_16x16x32_bf16 v[68:71], a[196:199], a[136:139], 0
    v_mfma_f32_16x16x32_bf16 v[84:87], a[196:199], a[140:143], 0
    buffer_load_dwordx4 a[4:7], v20, s[28:31], s101 offen offset:1024 sc1
    v_mfma_f32_16x16x32_bf16 v[40:43], a[200:203], a[128:131], 0
    v_mfma_f32_16x16x32_bf16 v[56:59], a[200:203], a[132:135], 0
    v_mfma_f32_16x16x32_bf16 v[72:75], a[200:203], a[136:139], 0
    v_mfma_f32_16x16x32_bf16 v[88:91], a[200:203], a[140:143], 0
    buffer_load_dwordx4 a[8:11], v20, s[28:31], s101 offen offset:2048 sc1
    v_mfma_f32_16x16x32_bf16 v[44:47], a[204:207], a[128:131], 0
    v_mfma_f32_16x16x32_bf16 v[60:63], a[204:207], a[132:135], 0
    v_mfma_f32_16x16x32_bf16 v[76:79], a[204:207], a[136:139], 0
    v_mfma_f32_16x16x32_bf16 v[92:95], a[204:207], a[140:143], 0
    buffer_load_dwordx4 a[12:15], v20, s[28:31], s101 offen offset:3072 sc1
    s_add_u32 s101, s101, 32768
    v_mfma_f32_16x16x32_bf16 v[32:35], a[208:211], a[144:147], v[32:35]
    v_mfma_f32_16x16x32_bf16 v[48:51], a[208:211], a[148:151], v[48:51]
    v_mfma_f32_16x16x32_bf16 v[64:67], a[208:211], a[152:155], v[64:67]
    v_mfma_f32_16x16x32_bf16 v[80:83], a[208:211], a[156:159], v[80:83]
    buffer_load_dwordx4 a[16:19], v20, s[28:31], s101 offen offset:0 sc1
    v_mfma_f32_16x16x32_bf16 v[36:39], a[212:215], a[144:147], v[36:39]
    v_mfma_f32_16x16x32_bf16 v[52:55], a[212:215], a[148:151], v[52:55]
    v_mfma_f32_16x16x32_bf16 v[68:71], a[212:215], a[152:155], v[68:71]
    v_mfma_f32_16x16x32_bf16 v[84:87], a[212:215], a[156:159], v[84:87]
    buffer_load_dwordx4 a[20:23], v20, s[28:31], s101 offen offset:1024 sc1
    v_mfma_f32_16x16x32_bf16 v[40:43], a[216:219], a[144:147], v[40:43]
    v_mfma_f32_16x16x32_bf16 v[56:59], a[216:219], a[148:151], v[56:59]
    v_mfma_f32_16x16x32_bf16 v[72:75], a[216:219], a[152:155], v[72:75]
    v_mfma_f32_16x16x32_bf16 v[88:91], a[216:219], a[156:159], v[88:91]
    buffer_load_dwordx4 a[24:27], v20, s[28:31], s101 offen offset:2048 sc1
    v_mfma_f32_16x16x32_bf16 v[44:47], a[220:223], a[144:147], v[44:47]
    v_mfma_f32_16x16x32_bf16 v[60:63], a[220:223], a[148:151], v[60:63]
    v_mfma_f32_16x16x32_bf16 v[76:79], a[220:223], a[152:155], v[76:79]
    v_mfma_f32_16x16x32_bf16 v[92:95], a[220:223], a[156:159], v[92:95]
    buffer_load_dwordx4 a[28:31], v20, s[28:31], s101 offen offset:3072 sc1
    s_add_u32 s101, s101, 32768
    v_mfma_f32_16x16x32_bf16 v[32:35], a[224:227], a[160:163], v[32:35]
    v_mfma_f32_16x16x32_bf16 v[48:51], a[224:227], a[164:167], v[48:51]
    v_mfma_f32_16x16x32_bf16 v[64:67], a[224:227], a[168:171], v[64:67]
    v_mfma_f32_16x16x32_bf16 v[80:83], a[224:227], a[172:175], v[80:83]
    buffer_load_dwordx4 a[32:35], v20, s[28:31], s101 offen offset:0 sc1
    v_mfma_f32_16x16x32_bf16 v[36:39], a[228:231], a[160:163], v[36:39]
    v_mfma_f32_16x16x32_bf16 v[52:55], a[228:231], a[164:167], v[52:55]
    v_mfma_f32_16x16x32_bf16 v[68:71], a[228:231], a[168:171], v[68:71]
    v_mfma_f32_16x16x32_bf16 v[84:87], a[228:231], a[172:175], v[84:87]
    buffer_load_dwordx4 a[36:39], v20, s[28:31], s101 offen offset:1024 sc1
    v_mfma_f32_16x16x32_bf16 v[40:43], a[232:235], a[160:163], v[40:43]
    v_mfma_f32_16x16x32_bf16 v[56:59], a[232:235], a[164:167], v[56:59]
    v_mfma_f32_16x16x32_bf16 v[72:75], a[232:235], a[168:171], v[72:75]
    v_mfma_f32_16x16x32_bf16 v[88:91], a[232:235], a[172:175], v[88:91]
    buffer_load_dwordx4 a[40:43], v20, s[28:31], s101 offen offset:2048 sc1
    v_mfma_f32_16x16x32_bf16 v[44:47], a[236:239], a[160:163], v[44:47]
    v_mfma_f32_16x16x32_bf16 v[60:63], a[236:239], a[164:167], v[60:63]
    v_mfma_f32_16x16x32_bf16 v[76:79], a[236:239], a[168:171], v[76:79]
    v_mfma_f32_16x16x32_bf16 v[92:95], a[236:239], a[172:175], v[92:95]
    buffer_load_dwordx4 a[44:47], v20, s[28:31], s101 offen offset:3072 sc1
    s_add_u32 s101, s101, 32768
    s_waitcnt vmcnt(13)
    v_mfma_f32_16x16x32_bf16 v[32:35], a[240:243], a[176:179], v[32:35]
    v_mfma_f32_16x16x32_bf16 v[48:51], a[240:243], a[180:183], v[48:51]
    v_mfma_f32_16x16x32_bf16 v[64:67], a[240:243], a[184:187], v[64:67]
    v_mfma_f32_16x16x32_bf16 v[80:83], a[240:243], a[188:191], v[80:83]
    buffer_load_dwordx4 a[48:51], v20, s[28:31], s101 offen offset:0 sc1
    v_mfma_f32_16x16x32_bf16 v[36:39], a[244:247], a[176:179], v[36:39]
    v_mfma_f32_16x16x32_bf16 v[52:55], a[244:247], a[180:183], v[52:55]
    v_mfma_f32_16x16x32_bf16 v[68:71], a[244:247], a[184:187], v[68:71]
    v_mfma_f32_16x16x32_bf16 v[84:87], a[244:247], a[188:191], v[84:87]
    buffer_load_dwordx4 a[52:55], v20, s[28:31], s101 offen offset:1024 sc1
    v_mfma_f32_16x16x32_bf16 v[40:43], a[248:251], a[176:179], v[40:43]
    v_mfma_f32_16x16x32_bf16 v[56:59], a[248:251], a[180:183], v[56:59]
    v_mfma_f32_16x16x32_bf16 v[72:75], a[248:251], a[184:187], v[72:75]
    v_mfma_f32_16x16x32_bf16 v[88:91], a[248:251], a[188:191], v[88:91]
    buffer_load_dwordx4 a[56:59], v20, s[28:31], s101 offen offset:2048 sc1
    v_mfma_f32_16x16x32_bf16 v[44:47], a[252:255], a[176:179], v[44:47]
    v_mfma_f32_16x16x32_bf16 v[60:63], a[252:255], a[180:183], v[60:63]
    v_mfma_f32_16x16x32_bf16 v[76:79], a[252:255], a[184:187], v[76:79]
    v_mfma_f32_16x16x32_bf16 v[92:95], a[252:255], a[188:191], v[92:95]
    buffer_load_dwordx4 a[60:63], v20, s[28:31], s101 offen offset:3072 sc1
    s_add_u32 s101, s101, 32768
    buffer_load_dwordx4 a[64:67], v20, s[28:31], s101 offen offset:0 sc1
    buffer_load_dwordx4 a[68:71], v20, s[28:31], s101 offen offset:1024 sc1
    buffer_load_dwordx4 a[72:75], v20, s[28:31], s101 offen offset:2048 sc1
    buffer_load_dwordx4 a[76:79], v20, s[28:31], s101 offen offset:3072 sc1
    s_add_u32 s101, s101, 32768
    buffer_load_dwordx4 a[80:83], v20, s[28:31], s101 offen offset:0 sc1
    buffer_load_dwordx4 a[84:87], v20, s[28:31], s101 offen offset:1024 sc1
    buffer_load_dwordx4 a[88:91], v20, s[28:31], s101 offen offset:2048 sc1
    buffer_load_dwordx4 a[92:95], v20, s[28:31], s101 offen offset:3072 sc1
    s_add_u32 s101, s101, 32768
    s_add_u32 s3, s3, s71
    s_add_u32 s10, s10, s71
    s_add_u32 s100, s100, s71
    s_add_u32 s78, s78, s71
    s_mov_b32 s36, s4
    s_mov_b32 s37, s5
    s_mov_b32 s38, 2097152
    s_mov_b32 s39, 0x20000
    s_mov_b32 s32, s20
    s_mov_b32 s33, s21
    s_mov_b32 s34, 2097152
    s_mov_b32 s35, 0x20000
    buffer_load_dwordx4 v[224:227], v11, s[36:39], s79 offen
    buffer_load_dwordx4 v[228:231], v11, s[36:39], s80 offen
    s_barrier
    s_mov_b64 exec, 65535
    buffer_load_dword v28, v27, s[44:47], s69 offen sc1
    s_mov_b64 exec, -1
    buffer_load_dwordx4 a[96:99], v20, s[28:31], s101 offen offset:0 sc1
    buffer_load_dwordx4 a[100:103], v20, s[28:31], s101 offen offset:1024 sc1
    buffer_load_dwordx4 a[104:107], v20, s[28:31], s101 offen offset:2048 sc1
    buffer_load_dwordx4 a[108:111], v20, s[28:31], s101 offen offset:3072 sc1
    s_add_u32 s101, s101, 32768
    s_waitcnt vmcnt(4)
    s_mov_b64 exec, 65535
    v_cmp_ne_u32 vcc, s49, v28
    s_nop 3
    s_cbranch_vccnz L_F_ph
L_F_ph_go:
    s_mov_b64 exec, -1
    buffer_load_dwordx4 v[96:99], v20, s[40:43], s3 offen offset:0 sc1
    buffer_load_dwordx4 v[100:103], v20, s[40:43], s10 offen offset:0 sc1
    buffer_load_dwordx4 v[104:107], v20, s[40:43], s100 offen offset:0 sc1
    buffer_load_dwordx4 v[108:111], v20, s[40:43], s78 offen offset:0 sc1
    buffer_load_dwordx4 v[112:115], v20, s[40:43], s3 offen offset:1024 sc1
    buffer_load_dwordx4 v[116:119], v20, s[40:43], s10 offen offset:1024 sc1
    buffer_load_dwordx4 v[120:123], v20, s[40:43], s100 offen offset:1024 sc1
    buffer_load_dwordx4 v[124:127], v20, s[40:43], s78 offen offset:1024 sc1
    buffer_load_dwordx4 v[128:131], v20, s[40:43], s3 offen offset:2048 sc1
    buffer_load_dwordx4 v[132:135], v20, s[40:43], s10 offen offset:2048 sc1
    buffer_load_dwordx4 v[136:139], v20, s[40:43], s100 offen offset:2048 sc1
    buffer_load_dwordx4 v[140:143], v20, s[40:43], s78 offen offset:2048 sc1
    buffer_load_dwordx4 v[144:147], v20, s[40:43], s3 offen offset:3072 sc1
    buffer_load_dwordx4 v[148:151], v20, s[40:43], s10 offen offset:3072 sc1
    buffer_load_dwordx4 v[152:155], v20, s[40:43], s100 offen offset:3072 sc1
    buffer_load_dwordx4 v[156:159], v20, s[40:43], s78 offen offset:3072 sc1
    buffer_load_dwordx4 v[160:163], v6, s[40:43], s3 offen offset:0 sc1
    buffer_load_dwordx4 v[164:167], v6, s[40:43], s10 offen offset:0 sc1
    buffer_load_dwordx4 v[168:171], v6, s[40:43], s100 offen offset:0 sc1
    buffer_load_dwordx4 v[172:175], v6, s[40:43], s78 offen offset:0 sc1
    buffer_load_dwordx4 v[176:179], v6, s[40:43], s3 offen offset:1024 sc1
    buffer_load_dwordx4 v[180:183], v6, s[40:43], s10 offen offset:1024 sc1
    buffer_load_dwordx4 v[184:187], v6, s[40:43], s100 offen offset:1024 sc1
    buffer_load_dwordx4 v[188:191], v6, s[40:43], s78 offen offset:1024 sc1
    buffer_load_dwordx4 v[192:195], v6, s[40:43], s3 offen offset:2048 sc1
    buffer_load_dwordx4 v[196:199], v6, s[40:43], s10 offen offset:2048 sc1
    buffer_load_dwordx4 v[200:203], v6, s[40:43], s100 offen offset:2048 sc1
    buffer_load_dwordx4 v[204:207], v6, s[40:43], s78 offen offset:2048 sc1
    v_lshlrev_b32 v208, 16, v224
    v_and_b32 v209, 0xffff0000, v224
    v_lshlrev_b32 v210, 16, v225
    v_and_b32 v211, 0xffff0000, v225
    v_lshlrev_b32 v212, 16, v226
    v_and_b32 v213, 0xffff0000, v226
    v_lshlrev_b32 v214, 16, v227
    v_and_b32 v215, 0xffff0000, v227
    v_lshlrev_b32 v216, 16, v228
    v_and_b32 v217, 0xffff0000, v228
    v_lshlrev_b32 v218, 16, v229
    v_and_b32 v219, 0xffff0000, v229
    v_lshlrev_b32 v220, 16, v230
    v_and_b32 v221, 0xffff0000, v230
    v_lshlrev_b32 v222, 16, v231
    v_and_b32 v223, 0xffff0000, v231
    s_waitcnt vmcnt(27)
    v_mfma_f32_16x16x32_bf16 v[32:35], a[0:3], v[96:99], v[32:35]
    v_mfma_f32_16x16x32_bf16 v[36:39], a[4:7], v[96:99], v[36:39]
    v_mfma_f32_16x16x32_bf16 v[40:43], a[8:11], v[96:99], v[40:43]
    v_mfma_f32_16x16x32_bf16 v[44:47], a[12:15], v[96:99], v[44:47]
    s_waitcnt vmcnt(26)
    v_mfma_f32_16x16x32_bf16 v[48:51], a[0:3], v[100:103], v[48:51]
    v_mfma_f32_16x16x32_bf16 v[52:55], a[4:7], v[100:103], v[52:55]
    v_mfma_f32_16x16x32_bf16 v[56:59], a[8:11], v[100:103], v[56:59]
    v_mfma_f32_16x16x32_bf16 v[60:63], a[12:15], v[100:103], v[60:63]
    s_waitcnt vmcnt(25)
    v_mfma_f32_16x16x32_bf16 v[64:67], a[0:3], v[104:107], v[64:67]
    v_mfma_f32_16x16x32_bf16 v[68:71], a[4:7], v[104:107], v[68:71]
    v_mfma_f32_16x16x32_bf16 v[72:75], a[8:11], v[104:107], v[72:75]
    v_mfma_f32_16x16x32_bf16 v[76:79], a[12:15], v[104:107], v[76:79]
    s_waitcnt vmcnt(24)
    v_mfma_f32_16x16x32_bf16 v[80:83], a[0:3], v[108:111], v[80:83]
    v_mfma_f32_16x16x32_bf16 v[84:87], a[4:7], v[108:111], v[84:87]
    v_mfma_f32_16x16x32_bf16 v[88:91], a[8:11], v[108:111], v[88:91]
    v_mfma_f32_16x16x32_bf16 v[92:95], a[12:15], v[108:111], v[92:95]
    s_waitcnt vmcnt(23)
    v_mfma_f32_16x16x32_bf16 v[32:35], a[16:19], v[112:115], v[32:35]
    v_mfma_f32_16x16x32_bf16 v[36:39], a[20:23], v[112:115], v[36:39]
    v_mfma_f32_16x16x32_bf16 v[40:43], a[24:27], v[112:115], v[40:43]
    v_mfma_f32_16x16x32_bf16 v[44:47], a[28:31], v[112:115], v[44:47]
    s_waitcnt vmcnt(22)
    v_mfma_f32_16x16x32_bf16 v[48:51], a[16:19], v[116:119], v[48:51]
    v_mfma_f32_16x16x32_bf16 v[52:55], a[20:23], v[116:119], v[52:55]
    v_mfma_f32_16x16x32_bf16 v[56:59], a[24:27], v[116:119], v[56:59]
    v_mfma_f32_16x16x32_bf16 v[60:63], a[28:31], v[116:119], v[60:63]
    s_waitcnt vmcnt(21)
    v_mfma_f32_16x16x32_bf16 v[64:67], a[16:19], v[120:123], v[64:67]
    v_mfma_f32_16x16x32_bf16 v[68:71], a[20:23], v[120:123], v[68:71]
    v_mfma_f32_16x16x32_bf16 v[72:75], a[24:27], v[120:123], v[72:75]
    v_mfma_f32_16x16x32_bf16 v[76:79], a[28:31], v[120:123], v[76:79]
    s_waitcnt vmcnt(20)
    v_mfma_f32_16x16x32_bf16 v[80:83], a[16:19], v[124:127], v[80:83]
    v_mfma_f32_16x16x32_bf16 v[84:87], a[20:23], v[124:127], v[84:87]
    v_mfma_f32_16x16x32_bf16 v[88:91], a[24:27], v[124:127], v[88:91]
    v_mfma_f32_16x16x32_bf16 v[92:95], a[28:31], v[124:127], v[92:95]
    s_waitcnt vmcnt(19)
    v_mfma_f32_16x16x32_bf16 v[32:35], a[32:35], v[128:131], v[32:35]
    v_mfma_f32_16x16x32_bf16 v[36:39], a[36:39], v[128:131], v[36:39]
    v_mfma_f32_16x16x32_bf16 v[40:43], a[40:43], v[128:131], v[40:43]
    v_mfma_f32_16x16x32_bf16 v[44:47], a[44:47], v[128:131], v[44:47]
    s_waitcnt vmcnt(18)
    v_mfma_f32_16x16x32_bf16 v[48:51], a[32:35], v[132:135], v[48:51]
    v_mfma_f32_16x16x32_bf16 v[52:55], a[36:39], v[132:135], v[52:55]
    v_mfma_f32_16x16x32_bf16 v[56:59], a[40:43], v[132:135], v[56:59]
    v_mfma_f32_16x16x32_bf16 v[60:63], a[44:47], v[132:135], v[60:63]
    s_waitcnt vmcnt(17)
    v_mfma_f32_16x16x32_bf16 v[64:67], a[32:35], v[136:139], v[64:67]
    v_mfma_f32_16x16x32_bf16 v[68:71], a[36:39], v[136:139], v[68:71]
    v_mfma_f32_16x16x32_bf16 v[72:75], a[40:43], v[136:139], v[72:75]
    v_mfma_f32_16x16x32_bf16 v[76:79], a[44:47], v[136:139], v[76:79]
    s_waitcnt vmcnt(16)
    v_mfma_f32_16x16x32_bf16 v[80:83], a[32:35], v[140:143], v[80:83]
    v_mfma_f32_16x16x32_bf16 v[84:87], a[36:39], v[140:143], v[84:87]
    v_mfma_f32_16x16x32_bf16 v[88:91], a[40:43], v[140:143], v[88:91]
    v_mfma_f32_16x16x32_bf16 v[92:95], a[44:47], v[140:143], v[92:95]
    s_waitcnt vmcnt(15)
    v_mfma_f32_16x16x32_bf16 v[32:35], a[48:51], v[144:147], v[32:35]
    v_mfma_f32_16x16x32_bf16 v[36:39], a[52:55], v[144:147], v[36:39]
    v_mfma_f32_16x16x32_bf16 v[40:43], a[56:59], v[144:147], v[40:43]
    v_mfma_f32_16x16x32_bf16 v[44:47], a[60:63], v[144:147], v[44:47]
    s_waitcnt vmcnt(14)
    v_mfma_f32_16x16x32_bf16 v[48:51], a[48:51], v[148:151], v[48:51]
    v_mfma_f32_16x16x32_bf16 v[52:55], a[52:55], v[148:151], v[52:55]
    v_mfma_f32_16x16x32_bf16 v[56:59], a[56:59], v[148:151], v[56:59]
    v_mfma_f32_16x16x32_bf16 v[60:63], a[60:63], v[148:151], v[60:63]
    s_waitcnt vmcnt(13)
    v_mfma_f32_16x16x32_bf16 v[64:67], a[48:51], v[152:155], v[64:67]
    v_mfma_f32_16x16x32_bf16 v[68:71], a[52:55], v[152:155], v[68:71]
    v_mfma_f32_16x16x32_bf16 v[72:75], a[56:59], v[152:155], v[72:75]
    v_mfma_f32_16x16x32_bf16 v[76:79], a[60:63], v[152:155], v[76:79]
    s_waitcnt vmcnt(12)
    v_mfma_f32_16x16x32_bf16 v[80:83], a[48:51], v[156:159], v[80:83]
    v_mfma_f32_16x16x32_bf16 v[84:87], a[52:55], v[156:159], v[84:87]
    v_mfma_f32_16x16x32_bf16 v[88:91], a[56:59], v[156:159], v[88:91]
    v_mfma_f32_16x16x32_bf16 v[92:95], a[60:63], v[156:159], v[92:95]
    s_waitcnt vmcnt(11)
    v_mfma_f32_16x16x32_bf16 v[32:35], a[64:67], v[160:163], v[32:35]
    v_mfma_f32_16x16x32_bf16 v[36:39], a[68:71], v[160:163], v[36:39]
    v_mfma_f32_16x16x32_bf16 v[40:43], a[72:75], v[160:163], v[40:43]
    v_mfma_f32_16x16x32_bf16 v[44:47], a[76:79], v[160:163], v[44:47]
    s_waitcnt vmcnt(10)
    v_mfma_f32_16x16x32_bf16 v[48:51], a[64:67], v[164:167], v[48:51]
    v_mfma_f32_16x16x32_bf16 v[52:55], a[68:71], v[164:167], v[52:55]
    v_mfma_f32_16x16x32_bf16 v[56:59], a[72:75], v[164:167], v[56:59]
    v_mfma_f32_16x16x32_bf16 v[60:63], a[76:79], v[164:167], v[60:63]
    s_waitcnt vmcnt(9)
    v_mfma_f32_16x16x32_bf16 v[64:67], a[64:67], v[168:171], v[64:67]
    v_mfma_f32_16x16x32_bf16 v[68:71], a[68:71], v[168:171], v[68:71]
    v_mfma_f32_16x16x32_bf16 v[72:75], a[72:75], v[168:171], v[72:75]
    v_mfma_f32_16x16x32_bf16 v[76:79], a[76:79], v[168:171], v[76:79]
    s_waitcnt vmcnt(8)
    v_mfma_f32_16x16x32_bf16 v[80:83], a[64:67], v[172:175], v[80:83]
    v_mfma_f32_16x16x32_bf16 v[84:87], a[68:71], v[172:175], v[84:87]
    v_mfma_f32_16x16x32_bf16 v[88:91], a[72:75], v[172:175], v[88:91]
    v_mfma_f32_16x16x32_bf16 v[92:95], a[76:79], v[172:175], v[92:95]
    s_waitcnt vmcnt(7)
    v_mfma_f32_16x16x32_bf16 v[32:35], a[80:83], v[176:179], v[32:35]
    v_mfma_f32_16x16x32_bf16 v[36:39], a[84:87], v[176:179], v[36:39]
    v_mfma_f32_16x16x32_bf16 v[40:43], a[88:91], v[176:179], v[40:43]
    v_mfma_f32_16x16x32_bf16 v[44:47], a[92:95], v[176:179], v[44:47]
    s_waitcnt vmcnt(6)
    v_mfma_f32_16x16x32_bf16 v[48:51], a[80:83], v[180:183], v[48:51]
    v_mfma_f32_16x16x32_bf16 v[52:55], a[84:87], v[180:183], v[52:55]
    v_mfma_f32_16x16x32_bf16 v[56:59], a[88:91], v[180:183], v[56:59]
    v_mfma_f32_16x16x32_bf16 v[60:63], a[92:95], v[180:183], v[60:63]
    s_waitcnt vmcnt(5)
    v_mfma_f32_16x16x32_bf16 v[64:67], a[80:83], v[184:187], v[64:67]
    v_mfma_f32_16x16x32_bf16 v[68:71], a[84:87], v[184:187], v[68:71]
    v_mfma_f32_16x16x32_bf16 v[72:75], a[88:91], v[184:187], v[72:75]
    v_mfma_f32_16x16x32_bf16 v[76:79], a[92:95], v[184:187], v[76:79]
    s_waitcnt vmcnt(4)
    v_mfma_f32_16x16x32_bf16 v[80:83], a[80:83], v[188:191], v[80:83]
    v_mfma_f32_16x16x32_bf16 v[84:87], a[84:87], v[188:191], v[84:87]
    v_mfma_f32_16x16x32_bf16 v[88:91], a[88:91], v[188:191], v[88:91]
    v_mfma_f32_16x16x32_bf16 v[92:95], a[92:95], v[188:191], v[92:95]
    s_waitcnt vmcnt(3)
    v_mfma_f32_16x16x32_bf16 v[32:35], a[96:99], v[192:195], v[32:35]
    v_mfma_f32_16x16x32_bf16 v[36:39], a[100:103], v[192:195], v[36:39]
    v_mfma_f32_16x16x32_bf16 v[40:43], a[104:107], v[192:195], v[40:43]
    v_mfma_f32_16x16x32_bf16 v[44:47], a[108:111], v[192:195], v[44:47]
    s_waitcnt vmcnt(2)
    v_mfma_f32_16x16x32_bf16 v[48:51], a[96:99], v[196:199], v[48:51]
    s_nop 2
    ds_write_b128 v8, v[32:35] offset:0
    v_mfma_f32_16x16x32_bf16 v[52:55], a[100:103], v[196:199], v[52:55]
    ds_write_b128 v8, v[36:39] offset:64
    v_mfma_f32_16x16x32_bf16 v[56:59], a[104:107], v[196:199], v[56:59]
    ds_write_b128 v8, v[40:43] offset:128
    v_mfma_f32_16x16x32_bf16 v[60:63], a[108:111], v[196:199], v[60:63]
    ds_write_b128 v8, v[44:47] offset:192
    s_waitcnt vmcnt(1)
    v_mfma_f32_16x16x32_bf16 v[64:67], a[96:99], v[200:203], v[64:67]
    ds_write_b128 v8, v[48:51] offset:4352
    v_mfma_f32_16x16x32_bf16 v[68:71], a[100:103], v[200:203], v[68:71]
    ds_write_b128 v8, v[52:55] offset:4416
    v_mfma_f32_16x16x32_bf16 v[72:75], a[104:107], v[200:203], v[72:75]
    ds_write_b128 v8, v[56:59] offset:4480
    v_mfma_f32_16x16x32_bf16 v[76:79], a[108:111], v[200:203], v[76:79]
    ds_write_b128 v8, v[60:63] offset:4544
    s_waitcnt vmcnt(0)
    v_mfma_f32_16x16x32_bf16 v[80:83], a[96:99], v[204:207], v[80:83]
    ds_write_b128 v8, v[64:67] offset:8704
    v_mfma_f32_16x16x32_bf16 v[84:87], a[100:103], v[204:207], v[84:87]
    ds_write_b128 v8, v[68:71] offset:8768
    v_mfma_f32_16x16x32_bf16 v[88:91], a[104:107], v[204:207], v[88:91]
    ds_write_b128 v8, v[72:75] offset:8832
    v_mfma_f32_16x16x32_bf16 v[92:95], a[108:111], v[204:207], v[92:95]
    ds_write_b128 v8, v[76:79] offset:8896
    s_nop 0
    ds_write_b128 v8, v[80:83] offset:13056
    s_nop 0
    ds_write_b128 v8, v[84:87] offset:13120
    s_nop 0
    ds_write_b128 v8, v[88:91] offset:13184
    s_nop 0
    ds_write_b128 v8, v[92:95] offset:13248
    s_waitcnt lgkmcnt(0)
    s_barrier
    ds_read_b128 v[96:99], v9 offset:0
    ds_read_b128 v[100:103], v9 offset:16
    ds_read_b128 v[104:107], v9 offset:33792
    ds_read_b128 v[108:111], v9 offset:33808
    ds_read_b128 v[112:115], v10 offset:0
    ds_read_b128 v[116:119], v10 offset:16
    ds_read_b128 v[120:123], v10 offset:33792
    ds_read_b128 v[124:127], v10 offset:33808
    ds_read_b128 v[128:131], v9 offset:2176
    ds_read_b128 v[132:135], v9 offset:2192
    ds_read_b128 v[136:139], v9 offset:35968
    ds_read_b128 v[140:143], v9 offset:35984
    ds_read_b128 v[144:147], v10 offset:2176
    ds_read_b128 v[148:151], v10 offset:2192
    ds_read_b128 v[152:155], v10 offset:35968
    ds_read_b128 v[156:159], v10 offset:35984
    s_waitcnt lgkmcnt(8)
    v_pk_add_f32 v[96:97], v[96:97], v[104:105]
    v_pk_add_f32 v[98:99], v[98:99], v[106:107]
    v_pk_add_f32 v[100:101], v[100:101], v[108:109]
    v_pk_add_f32 v[102:103], v[102:103], v[110:111]
    v_pk_add_f32 v[112:113], v[112:113], v[120:121]
    v_pk_add_f32 v[114:115], v[114:115], v[122:123]
    v_pk_add_f32 v[116:117], v[116:117], v[124:125]
    v_pk_add_f32 v[118:119], v[118:119], v[126:127]
    v_pk_add_f32 v[96:97], v[96:97], v[208:209]
    v_pk_add_f32 v[98:99], v[98:99], v[210:211]
    v_pk_add_f32 v[100:101], v[100:101], v[212:213]
    v_pk_add_f32 v[102:103], v[102:103], v[214:215]
    v_pk_add_f32 v[96:97], v[96:97], v[112:113]
    v_pk_add_f32 v[98:99], v[98:99], v[114:115]
    v_pk_add_f32 v[100:101], v[100:101], v[116:117]
    v_pk_add_f32 v[102:103], v[102:103], v[118:119]
    v_cvt_pk_bf16_f32 v224, v96, v97
    v_cvt_pk_bf16_f32 v225, v98, v99
    v_cvt_pk_bf16_f32 v226, v100, v101
    v_cvt_pk_bf16_f32 v227, v102, v103
    buffer_store_dwordx4 v[224:227], v11, s[32:35], s79 offen sc1
    s_waitcnt lgkmcnt(0)
    v_pk_add_f32 v[128:129], v[128:129], v[136:137]
    v_pk_add_f32 v[130:131], v[130:131], v[138:139]
    v_pk_add_f32 v[132:133], v[132:133], v[140:141]
    v_pk_add_f32 v[134:135], v[134:135], v[142:143]
    v_pk_add_f32 v[144:145], v[144:145], v[152:153]
    v_pk_add_f32 v[146:147], v[146:147], v[154:155]
    v_pk_add_f32 v[148:149], v[148:149], v[156:157]
    v_pk_add_f32 v[150:151], v[150:151], v[158:159]
    v_pk_add_f32 v[128:129], v[128:129], v[216:217]
    v_pk_add_f32 v[130:131], v[130:131], v[218:219]
    v_pk_add_f32 v[132:133], v[132:133], v[220:221]
    v_pk_add_f32 v[134:135], v[134:135], v[222:223]
    v_pk_add_f32 v[128:129], v[128:129], v[144:145]
    v_pk_add_f32 v[130:131], v[130:131], v[146:147]
    v_pk_add_f32 v[132:133], v[132:133], v[148:149]
    v_pk_add_f32 v[134:135], v[134:135], v[150:151]
    v_cvt_pk_bf16_f32 v228, v128, v129
    v_cvt_pk_bf16_f32 v229, v130, v131
    v_cvt_pk_bf16_f32 v230, v132, v133
    v_cvt_pk_bf16_f32 v231, v134, v135
    buffer_store_dwordx4 v[228:231], v11, s[32:35], s80 offen sc1
    s_endpgm
L_FA_h2:
    s_sleep 2
    buffer_load_dword v28, v26, s[44:47], s68 offen sc1
    s_add_u32 s70, s70, 1
    s_waitcnt vmcnt(0)
    v_cmp_ne_u32 vcc, s49, v28
    s_nop 3
    s_cmp_gt_u32 s70, 100000
    s_cbranch_scc1 L_FA_h2_go
    s_cbranch_vccnz L_FA_h2
    s_branch L_FA_h2_go
L_FA_pd:
    s_sleep 2
    buffer_load_dword v28, v25, s[44:47], s65 offen sc1
    s_add_u32 s70, s70, 1
    s_waitcnt vmcnt(0)
    v_cmp_ne_u32 vcc, s49, v28
    s_nop 3
    s_cmp_gt_u32 s70, 100000
    s_cbranch_scc1 L_FA_pd_go
    s_cbranch_vccnz L_FA_pd
    s_branch L_FA_pd_go
L_F_B43_nspin:
    s_sleep 4
    global_load_dword v21, v22, s[22:23] sc1
    s_add_u32 s101, s101, 1
    s_waitcnt vmcnt(0)
    v_cmp_eq_u32 vcc, 0, v21
    s_nop 3
    s_cmp_gt_u32 s101, 100000
    s_cbranch_scc1 L_F_B43_nspin_go
    s_cbranch_vccnz L_F_B43_nspin
    s_branch L_F_B43_nspin_go
L_F_B43_slow0:
    s_sleep 1
    buffer_load_dwordx4 v[208:211], v134, s[32:35], s66 offen offset:0 sc1
    buffer_load_dwordx4 v[212:215], v134, s[32:35], s67 offen offset:0 sc1
    buffer_load_dwordx4 v[216:219], v134, s[32:35], s68 offen offset:0 sc1
    buffer_load_dwordx4 v[220:223], v134, s[32:35], s69 offen offset:0 sc1
    s_add_u32 s71, s71, 1
    s_waitcnt vmcnt(0)
    v_xor_b32 v209, s49, v209
    v_xor_b32 v211, s49, v211
    v_xor_b32 v213, s49, v213
    v_xor_b32 v215, s49, v215
    v_xor_b32 v217, s49, v217
    v_xor_b32 v219, s49, v219
    v_xor_b32 v221, s49, v221
    v_xor_b32 v223, s49, v223
    v_or3_b32 v209, v209, v211, v213
    v_or3_b32 v215, v215, v217, v219
    v_or3_b32 v209, v209, v221, v223
    v_or_b32 v209, v209, v215
    v_cmp_ne_u32 vcc, 0, v209
    s_nop 3
    s_cmp_gt_u32 s71, 100000
    s_cbranch_scc1 L_F_B43_slow0_go
    s_cbranch_vccnz L_F_B43_slow0
    s_branch L_F_B43_slow0_go
L_F_B43_slow1:
    s_sleep 1
    buffer_load_dwordx4 v[208:211], v134, s[32:35], s66 offen offset:1024 sc1
    buffer_load_dwordx4 v[212:215], v134, s[32:35], s67 offen offset:1024 sc1
    buffer_load_dwordx4 v[216:219], v134, s[32:35], s68 offen offset:1024 sc1
    buffer_load_dwordx4 v[220:223], v134, s[32:35], s69 offen offset:1024 sc1
    s_add_u32 s71, s71, 1
    s_waitcnt vmcnt(0)
    v_xor_b32 v209, s49, v209
    v_xor_b32 v211, s49, v211
    v_xor_b32 v213, s49, v213
    v_xor_b32 v215, s49, v215
    v_xor_b32 v217, s49, v217
    v_xor_b32 v219, s49, v219
    v_xor_b32 v221, s49, v221
    v_xor_b32 v223, s49, v223
    v_or3_b32 v209, v209, v211, v213
    v_or3_b32 v215, v215, v217, v219
    v_or3_b32 v209, v209, v221, v223
    v_or_b32 v209, v209, v215
    v_cmp_ne_u32 vcc, 0, v209
    s_nop 3
    s_cmp_gt_u32 s71, 100000
    s_cbranch_scc1 L_F_B43_slow1_go
    s_cbranch_vccnz L_F_B43_slow1
    s_branch L_F_B43_slow1_go
L_F_ehB43:
    s_sleep 2
    buffer_load_dword v27, v26, s[44:47], s100 offen offset:0 sc1
    s_add_u32 s10, s10, 1
    s_waitcnt vmcnt(0)
    v_cmp_ne_u32 vcc, s49, v27
    s_nop 3
    s_cmp_gt_u32 s10, 100000
    s_cbranch_scc1 L_F_ehB43_go
    s_cbranch_vccnz L_F_ehB43
    s_branch L_F_ehB43_go
L_F_B34_nspin:
    s_sleep 4
    global_load_dword v21, v22, s[22:23] sc1
    s_add_u32 s101, s101, 1
    s_waitcnt vmcnt(0)
    v_cmp_eq_u32 vcc, 0, v21
    s_nop 3
    s_cmp_gt_u32 s101, 100000
    s_cbranch_scc1 L_F_B34_nspin_go
    s_cbranch_vccnz L_F_B34_nspin
    s_branch L_F_B34_nspin_go
L_F_B34_slow0:
    s_sleep 1
    buffer_load_dwordx4 v[208:211], v134, s[32:35], s66 offen offset:0 sc1
    buffer_load_dwordx4 v[212:215], v134, s[32:35], s67 offen offset:0 sc1
    buffer_load_dwordx4 v[216:219], v134, s[32:35], s68 offen offset:0 sc1
    buffer_load_dwordx4 v[220:223], v134, s[32:35], s69 offen offset:0 sc1
    s_add_u32 s71, s71, 1
    s_waitcnt vmcnt(0)
    v_xor_b32 v209, s49, v209
    v_xor_b32 v211, s49, v211
    v_xor_b32 v213, s49, v213
    v_xor_b32 v215, s49, v215
    v_xor_b32 v217, s49, v217
    v_xor_b32 v219, s49, v219
    v_xor_b32 v221, s49, v221
    v_xor_b32 v223, s49, v223
    v_or3_b32 v209, v209, v211, v213
    v_or3_b32 v215, v215, v217, v219
    v_or3_b32 v209, v209, v221, v223
    v_or_b32 v209, v209, v215
    v_cmp_ne_u32 vcc, 0, v209
    s_nop 3
    s_cmp_gt_u32 s71, 100000
    s_cbranch_scc1 L_F_B34_slow0_go
    s_cbranch_vccnz L_F_B34_slow0
    s_branch L_F_B34_slow0_go
L_F_B34_slow1:
    s_sleep 1
    buffer_load_dwordx4 v[208:211], v134, s[32:35], s66 offen offset:1024 sc1
    buffer_load_dwordx4 v[212:215], v134, s[32:35], s67 offen offset:1024 sc1
    buffer_load_dwordx4 v[216:219], v134, s[32:35], s68 offen offset:1024 sc1
    buffer_load_dwordx4 v[220:223], v134, s[32:35], s69 offen offset:1024 sc1
    s_add_u32 s71, s71, 1
    s_waitcnt vmcnt(0)
    v_xor_b32 v209, s49, v209
    v_xor_b32 v211, s49, v211
    v_xor_b32 v213, s49, v213
    v_xor_b32 v215, s49, v215
    v_xor_b32 v217, s49, v217
    v_xor_b32 v219, s49, v219
    v_xor_b32 v221, s49, v221
    v_xor_b32 v223, s49, v223
    v_or3_b32 v209, v209, v211, v213
    v_or3_b32 v215, v215, v217, v219
    v_or3_b32 v209, v209, v221, v223
    v_or_b32 v209, v209, v215
    v_cmp_ne_u32 vcc, 0, v209
    s_nop 3
    s_cmp_gt_u32 s71, 100000
    s_cbranch_scc1 L_F_B34_slow1_go
    s_cbranch_vccnz L_F_B34_slow1
    s_branch L_F_B34_slow1_go
L_F_ehB34:
    s_sleep 2
    buffer_load_dword v27, v26, s[44:47], s100 offen offset:0 sc1
    s_add_u32 s10, s10, 1
    s_waitcnt vmcnt(0)
    v_cmp_ne_u32 vcc, s49, v27
    s_nop 3
    s_cmp_gt_u32 s10, 100000
    s_cbranch_scc1 L_F_ehB34_go
    s_cbranch_vccnz L_F_ehB34
    s_branch L_F_ehB34_go
L_F_A_nspin:
    s_sleep 4
    global_load_dword v21, v22, s[22:23] sc1
    s_add_u32 s101, s101, 1
    s_waitcnt vmcnt(0)
    v_cmp_eq_u32 vcc, 0, v21
    s_nop 3
    s_cmp_gt_u32 s101, 100000
    s_cbranch_scc1 L_F_A_nspin_go
    s_cbranch_vccnz L_F_A_nspin
    s_branch L_F_A_nspin_go
L_F_A_rs:
    s_sleep 1
    buffer_load_dwordx4 v[160:163], v164, s[44:47], 0 offen sc1
    s_add_u32 s66, s66, 1
    s_waitcnt vmcnt(0)
    v_xor_b32 v161, s49, v161
    v_xor_b32 v163, s49, v163
    v_or_b32 v161, v161, v163
    v_cmp_ne_u32 vcc, 0, v161
    s_nop 3
    s_cmp_gt_u32 s66, 100000
    s_cbranch_scc1 L_F_A_rs_go
    s_cbranch_vccnz L_F_A_rs
    s_branch L_F_A_rs_go
L_F_ehA:
    s_sleep 2
    buffer_load_dword v27, v26, s[44:47], s100 offen offset:0 sc1
    s_add_u32 s10, s10, 1
    s_waitcnt vmcnt(0)
    v_cmp_ne_u32 vcc, s49, v27
    s_nop 3
    s_cmp_gt_u32 s10, 100000
    s_cbranch_scc1 L_F_ehA_go
    s_cbranch_vccnz L_F_ehA
    s_branch L_F_ehA_go
L_F_ph:
    s_sleep 4
    buffer_load_dword v28, v27, s[44:47], s69 offen sc1
    s_add_u32 s70, s70, 1
    s_waitcnt vmcnt(0)
    v_cmp_ne_u32 vcc, s49, v28
    s_nop 3
    s_cmp_gt_u32 s70, 100000
    s_cbranch_scc1 L_F_ph_go
    s_cbranch_vccnz L_F_ph
    s_branch L_F_ph_go
L_F_end:
    s_endpgm
.section .rodata,"a"
.p2align 6
.amdhsa_kernel parallel_sum__sliding_local_dilated__mixer_gmlp__prompt_kernel
  .amdhsa_next_free_vgpr 512
  .amdhsa_next_free_sgpr 102
  .amdhsa_accum_offset 256
  .amdhsa_group_segment_fixed_size 0
  .amdhsa_kernarg_size 88
  .amdhsa_user_sgpr_count 2
  .amdhsa_user_sgpr_kernarg_segment_ptr 1
  .amdhsa_system_sgpr_workgroup_id_x 1
.end_amdhsa_kernel
```
